```python
import torch

def _softmax(x, axis=-1):
    return torch.softmax(x, dim=axis)
def _gelu(x):
    return torch.nn.functional.gelu(x, approximate="tanh")
def _silu(x):
    return torch.nn.functional.silu(x)
def _sigmoid(x):
    return torch.sigmoid(x)
def _layernorm(x, axis=-1, eps=1e-5):
    m = x.mean(dim=axis, keepdim=True)
    v = x.var(dim=axis, keepdim=True, unbiased=False)
    return (x - m) / torch.sqrt(v + eps)
def _scatter_add(tgt, idx, src, axis=0):
    return tgt.clone().index_add_(axis, idx, src)
def _segment_sum(src, seg, n):
    out = torch.zeros((n,) + src.shape[1:], dtype=src.dtype)
    return out.index_add_(0, seg, src)
def _pad(x, pw):
    flat = tuple(v for pair in reversed(pw) for v in pair)
    return torch.nn.functional.pad(x, flat)

kernel_name = 'parallel_sum__ssm_conv_s5__geglu_ffn__prompt'

def setup_inputs():

    _w = (lambda a: (lambda t: t.to(torch.bfloat16) if t.is_floating_point() else t)(torch.as_tensor(a)))
    def _A_setup():
        B, S, D = 1, 2048, 640
        P = D
        Lambda_re = -0.5 * (lambda _x: torch.exp(torch.as_tensor(_x)))((lambda *s: torch.randn(*s, dtype=torch.bfloat16) * 0.8)(P))
        Lambda_im = (lambda *s: torch.randn(*s, dtype=torch.bfloat16) * 0.8)(P) * 1.0
        B_re = (lambda *s: torch.randn(*s, dtype=torch.bfloat16) * 0.8)(P, D) * (D ** -0.5)
        B_im = (lambda *s: torch.randn(*s, dtype=torch.bfloat16) * 0.8)(P, D) * (D ** -0.5)
        C_re = (lambda *s: torch.randn(*s, dtype=torch.bfloat16) * 0.8)(D, P) * (P ** -0.5)
        C_im = (lambda *s: torch.randn(*s, dtype=torch.bfloat16) * 0.8)(D, P) * (P ** -0.5)
        log_dt = (lambda *s: torch.randn(*s, dtype=torch.bfloat16) * 0.8)(P) * 0.3 - 2.0
        Dskip = (lambda *s: torch.randn(*s, dtype=torch.bfloat16) * 0.8)(D)
        return {
            "x": _w((lambda *s: torch.randn(*s, dtype=torch.bfloat16) * 0.05)(B, S, D)),
            "Lambda_re": _w(Lambda_re),
            "Lambda_im": _w(Lambda_im),
            "B_re": _w(B_re),
            "B_im": _w(B_im),
            "C_re": _w(C_re),
            "C_im": _w(C_im),
            "log_dt": _w(log_dt),
            "Dskip": _w(Dskip),
        }
    _A_in = _A_setup()

    def _B_setup():
        B, S, D, F = 1, 2048, 640, 1536
        return {
            "x": _w((lambda *s: torch.randn(*s, dtype=torch.bfloat16) * 0.05)(B, S, D)),
            "w_gate": _w((lambda *s: torch.randn(*s, dtype=torch.bfloat16) * 0.05)(D, F)),
            "w_up": _w((lambda *s: torch.randn(*s, dtype=torch.bfloat16) * 0.05)(D, F)),
            "w_down": _w((lambda *s: torch.randn(*s, dtype=torch.bfloat16) * 0.05)(F, D)),
        }
    _B_in = _B_setup()

    return {
        "A_x": _A_in["x"],
        "A_Lambda_re": _A_in["Lambda_re"],
        "A_Lambda_im": _A_in["Lambda_im"],
        "A_B_re": _A_in["B_re"],
        "A_B_im": _A_in["B_im"],
        "A_C_re": _A_in["C_re"],
        "A_C_im": _A_in["C_im"],
        "A_log_dt": _A_in["log_dt"],
        "A_Dskip": _A_in["Dskip"],
        "B_x": _B_in["x"],
        "B_w_gate": _B_in["w_gate"],
        "B_w_up": _B_in["w_up"],
        "B_w_down": _B_in["w_down"],
    }

def reference(A_x, A_Lambda_re, A_Lambda_im, A_B_re, A_B_im, A_C_re, A_C_im, A_log_dt, A_Dskip, B_x, B_w_gate, B_w_up, B_w_down):
    def _A_ref(x, Lambda_re, Lambda_im, B_re, B_im, C_re, C_im, log_dt, Dskip):
        Bsz, L, H = x.shape
        Lam = Lambda_re + 1j * Lambda_im
        Bmat = B_re + 1j * B_im
        Cmat = C_re + 1j * C_im
        dt = torch.exp(log_dt)
        Lam_bar = torch.exp(dt * Lam)
        B_bar = ((Lam_bar - 1.0) / Lam)[:, None] * Bmat
        Bu = torch.einsum("bld,pd->blp", x + 0j, B_bar)
        h = torch.zeros_like(Bu[:, 0, :])
        hs = []
        for t in range(L):
            h = Lam_bar[None, :] * h + Bu[:, t, :]
            hs.append(h)
        hseq = torch.stack(hs, 1)
        y = 2.0 * torch.einsum("blp,dp->bld", hseq, Cmat).real + x * Dskip[None, None, :]
        return y

    def _B_ref(x, w_gate, w_up, w_down):
        return (_gelu(x @ w_gate) * (x @ w_up)) @ w_down

    x = A_x
    xn = _layernorm(x, axis=-1)
    return x + _A_ref(xn, A_Lambda_re, A_Lambda_im, A_B_re, A_B_im, A_C_re, A_C_im, A_log_dt, A_Dskip) + _B_ref(xn, B_w_gate, B_w_up, B_w_down)
```

```asm
; @launch grid=(256,1,1) block=(512,1,1) lds=163840
.amdgcn_target "amdgcn-amd-amdhsa--gfx950"
.text
.globl parallel_sum__ssm_conv_s5__geglu_ffn__prompt_kernel
.p2align 8
.type parallel_sum__ssm_conv_s5__geglu_ffn__prompt_kernel,@function
parallel_sum__ssm_conv_s5__geglu_ffn__prompt_kernel:
    s_cmp_ge_u32 s2, 256
    s_cbranch_scc1 parallel_sum__ssm_conv_s5__geglu_ffn__prompt_kernel_end
    s_load_dwordx16 s[64:79], s[0:1], 0
    s_load_dwordx16 s[80:95], s[0:1], 64
    v_lshrrev_b32 v1, 6, v0
    v_and_b32 v2, 63, v0
    v_readfirstlane_b32 s21, v1
    v_lshrrev_b32 v5, 4, v2
    s_and_b32 s22, s21, 3
    s_and_b32 s16, s22, 1
    s_lshr_b32 s17, s22, 1
    s_lshl_b32 s44, s2, 3
    s_add_u32 s44, s44, s21
    s_cmp_lg_u32 s44, 4
    s_cbranch_scc1 parallel_sum__ssm_conv_s5__geglu_ffn__prompt_kernel_nl_1
    s_memrealtime s[44:45]
    v_mov_b32 v6, 0
    s_waitcnt lgkmcnt(0)
    s_mov_b32 s40, s92
    s_mov_b32 s41, s93
    s_mov_b32 s42, 0x100
    s_mov_b32 s43, 0x00020000
    s_or_b32 s44, s44, 1
    v_mov_b32 v8, s44
    buffer_store_dword v8, v6, s[40:43], 0 offen sc1
parallel_sum__ssm_conv_s5__geglu_ffn__prompt_kernel_nl_1:
    s_lshr_b32 s44, s2, 3
    s_bfe_u32 s45, s2, 0x20001
    s_add_u32 s46, s44, 28
    s_sub_u32 s47, s44, 4
    s_bitcmp1_b32 s2, 0
    s_cselect_b32 s46, s46, s47
    s_lshr_b32 s18, s46, 2
    s_mul_i32 s47, s45, 3
    s_add_u32 s47, s47, 4
    s_and_b32 s19, s46, 3
    s_cselect_b32 s47, s47, s45
    s_add_u32 s19, s19, s47
    s_lshl_b32 s47, s45, 2
    s_add_u32 s47, s47, s44
    s_sub_u32 s47, s47, 1
    s_max_i32 s47, s47, 0
    s_cmp_lt_i32 s46, 0
    s_cselect_b32 s18, s47, s18
    s_cselect_b32 s19, 4, s19
    s_cmp_lt_u32 s19, 5
    s_cselect_b32 s20, 1, 0
    s_mul_i32 s3, s18, 18
    s_add_u32 s3, s3, s19
    s_mul_i32 s44, s19, 18
    s_sub_u32 s44, s44, 55
    s_cmp_ge_u32 s3, 256
    s_cselect_b32 s3, s44, s3
    s_cmp_eq_u32 s2, 0
    s_cselect_b32 s3, 251, s3
    s_cmp_ge_u32 s21, 4
    s_cbranch_scc1 parallel_sum__ssm_conv_s5__geglu_ffn__prompt_kernel_dec
    v_lshrrev_b32 v94, 5, v0
    s_lshl_b32 s44, s3, 3
    v_add_u32 v12, s44, v94
    v_mul_u32_u24 v12, 1280, v12
    v_and_b32 v13, 31, v2
    v_lshl_add_u32 v92, v13, 4, v12
    v_lshl_add_u32 v93, v13, 3, v12
    s_lshl_b32 s44, s19, 7
    s_lshl_b32 s45, s22, 5
    s_add_u32 s44, s44, s45
    v_add_lshl_u32 v95, s44, v13, 1
    v_and_b32 v3, 15, v2
    v_add_u32_e64 v3, s44, v3
    s_mov_b32 s26, 0x280000
    s_mov_b32 s27, 0x00020000
    s_waitcnt lgkmcnt(0)
    s_mov_b32 s24, s64
    s_mov_b32 s25, s65
    buffer_load_dwordx4 v[32:35], v92, s[24:27], 0 offen
    buffer_load_dwordx4 v[36:39], v92, s[24:27], 0 offen offset:512
    buffer_load_dwordx2 v[40:41], v93, s[24:27], 0 offen offset:1024
    s_mov_b32 s24, s66
    s_mov_b32 s25, s67
    s_mov_b32 s26, 0x500
    s_mov_b32 s27, 0x00020000
    buffer_load_ushort v246, v95, s[24:27], 0 offen
    s_mov_b32 s24, s68
    s_mov_b32 s25, s69
    s_mov_b32 s26, 0x500
    s_mov_b32 s27, 0x00020000
    buffer_load_ushort v247, v95, s[24:27], 0 offen
    s_mov_b32 s24, s78
    s_mov_b32 s25, s79
    s_mov_b32 s26, 0x500
    s_mov_b32 s27, 0x00020000
    buffer_load_ushort v248, v95, s[24:27], 0 offen
    s_lshl_b32 s50, s3, 2
    s_add_u32 s50, s50, s22
    s_mul_i32 s44, s50, 1366
    s_lshr_b32 s44, s44, 16
    s_mul_i32 s45, s44, 1966048
    s_mul_i32 s46, s50, 40960
    s_sub_u32 s46, s46, s45
    s_add_u32 s46, s46, 1024
    s_cmp_lt_u32 s50, 384
    s_cselect_b32 s46, s46, 0x7f000000
    s_lshl_b32 s51, s22, 10
    s_add_u32 s51, s51, 153600
    s_mov_b32 m0, s51
    v_lshrrev_b32 v96, 1, v2
    v_mul_u32_u24 v96, 1280, v96
    v_and_b32 v97, 1, v2
    v_lshl_add_u32 v96, v97, 4, v96
    s_mov_b32 s24, s88
    s_mov_b32 s25, s89
    s_mov_b32 s26, 0x1e0000
    s_mov_b32 s27, 0x00020000
    buffer_load_dwordx4 v96, s[24:27], s46 offen lds
    s_getpc_b64 s[44:45]
parallel_sum__ssm_conv_s5__geglu_ffn__prompt_kernel_pc_2:
    s_sub_u32 s44, s44, parallel_sum__ssm_conv_s5__geglu_ffn__prompt_kernel_pc_2-parallel_sum__ssm_conv_s5__geglu_ffn__prompt_kernel
    s_subb_u32 s45, s45, 0
    s_lshr_b32 s46, s2, 3
    s_lshl_b32 s46, s46, 2
    s_add_u32 s46, s46, s22
    v_lshl_add_u32 v96, v2, 7, s46
    v_lshlrev_b32 v96, 7, v96
    v_min_u32 v96, parallel_sum__ssm_conv_s5__geglu_ffn__prompt_kernel_end-parallel_sum__ssm_conv_s5__geglu_ffn__prompt_kernel, v96
    v_mov_b32 v97, s45
    v_add_co_u32 v96, vcc, s44, v96
    s_nop 1
    v_addc_co_u32 v97, vcc, 0, v97, vcc
    s_mov_b64 exec, 7
    global_load_dword v249, v[96:97], off
    s_mov_b64 exec, -1
    s_cmp_eq_u32 s16, 0
    s_cselect_b64 s[44:45], s[84:85], s[86:87]
    s_cselect_b64 s[46:47], s[70:71], s[72:73]
    s_cmp_eq_u32 s20, 1
    s_cselect_b64 s[36:37], s[46:47], s[44:45]
    s_mov_b32 s44, 1966080
    s_cselect_b32 s38, 819200, s44
    s_movk_i32 s44, 3072
    s_cselect_b32 s44, 128, s44
    s_movk_i32 s45, 128
    s_cselect_b32 s45, 81920, s45
    s_cselect_b32 s46, 0, 10
    s_lshl_b32 s47, s19, 1
    s_add_u32 s47, s47, s17
    s_sub_u32 s47, s47, s46
    s_mul_i32 s45, s45, s47
    s_mov_b32 s39, 0x00020000
    s_mul_i32 s46, s18, 43
    v_min_u32 v96, 42, v2
    v_add_u32 v96, s46, v96
    v_min_u32 v96, 639, v96
    v_mul_u32_u24 v96, s44, v96
    buffer_load_dword v250, v96, s[36:39], s45 offen
    s_branch parallel_sum__ssm_conv_s5__geglu_ffn__prompt_kernel_comp
parallel_sum__ssm_conv_s5__geglu_ffn__prompt_kernel_dec:
    s_setprio 3
    s_cmp_eq_u32 s2, 0
    s_cbranch_scc1 parallel_sum__ssm_conv_s5__geglu_ffn__prompt_kernel_spare
    v_lshrrev_b32 v3, 3, v2
    v_and_b32 v4, 7, v2
    v_xor_b32 v6, v4, v5
    v_xor_b32 v7, 4, v6
    v_lshrrev_b32 v12, 5, v2
    v_mul_u32_u24 v12, 36, v12
    v_and_b32 v13, 1, v3
    v_mad_u32_u24 v12, v13, 18, v12
    v_and_b32 v8, 1, v5
    v_add_u32 v12, v12, v8
    s_mul_i32 s44, s16, 72
    s_lshl_b32 s45, s17, 1
    s_add_u32 s44, s44, s45
    s_lshl_b32 s45, s22, 3
    s_cmp_eq_u32 s20, 1
    s_cselect_b32 s44, s44, s45
    s_cselect_b64 vcc, -1, 0
    s_mov_b32 s45, 40960
    s_cselect_b32 s55, 5120, s45
    s_mov_b32 s45, 1966080
    s_cselect_b32 s34, 819200, s45
    s_mov_b32 s45, 23552
    s_cselect_b32 s56, 9216, s45
    s_mov_b32 s45, 196608
    s_cselect_b32 s57, 128, s45
    s_movk_i32 s45, 128
    s_cselect_b32 s46, 81920, s45
    s_cselect_b32 s47, 0, 10
    v_cndmask_b32 v12, v3, v12, vcc
    v_lshlrev_b32 v8, 1, v8
    v_xor_b32_e64 v8, v4, v8
    v_mul_u32_u24 v14, 1280, v3
    v_mul_u32_u24 v15, 3072, v3
    v_lshl_add_u32 v14, v6, 4, v14
    v_lshl_add_u32 v15, v8, 4, v15
    v_cndmask_b32 v10, v15, v14, vcc
    v_xor_b32 v11, 64, v10
    s_mul_i32 s45, s18, 144
    s_add_u32 s44, s44, s45
    v_add_u32 v12, s44, v12
    v_mul_u32_u24 v12, 1280, v12
    s_lshl_b32 s44, s16, 2
    v_xor_b32 v13, s44, v6
    v_lshl_add_u32 v18, v13, 4, v12
    s_lshl_b32 s44, s19, 1
    s_add_u32 s44, s44, s17
    s_sub_u32 s44, s44, s47
    s_mul_i32 s59, s44, s46
    s_sub_u32 s44, s18, 5
    s_cmp_lt_u32 s44, 5
    s_cselect_b32 s45, 5, 0
    s_cselect_b32 s46, -9, 1
    s_sub_u32 s51, s18, s45
    s_lshl_b32 s60, s45, 7
    s_mul_i32 s44, s45, s57
    s_add_u32 s59, s59, s44
    s_lshl_b32 s53, s46, 7
    s_mul_i32 s54, s46, s57
    s_add_u32 s58, s56, 4096
    s_lshl_b32 s61, s22, 10
    s_lshl_b32 s62, s22, 13
    s_add_u32 s62, s62, 18432
    s_mov_b32 s35, 0x00020000
    s_mov_b32 s26, 0x280000
    s_mov_b32 s27, 0x00020000
    s_waitcnt lgkmcnt(0)
    s_mov_b32 s24, s64
    s_mov_b32 s25, s65
    s_cmp_eq_u32 s16, 0
    s_cselect_b64 s[44:45], s[84:85], s[86:87]
    s_cselect_b64 s[46:47], s[70:71], s[72:73]
    s_cmp_eq_u32 s20, 1
    s_cselect_b64 s[32:33], s[46:47], s[44:45]
    s_add_u32 m0, s61, 102400
    s_mov_b32 s63, s60
    buffer_load_dwordx4 v18, s[24:27], s63 offen lds
    s_mov_b32 s28, s94
    s_mov_b32 s29, s95
    s_mov_b32 s30, 0x1800000
    s_mov_b32 s31, 0x00020000
    s_mov_b32 s40, s92
    s_mov_b32 s41, s93
    s_mov_b32 s42, 0x100
    s_mov_b32 s43, 0x00020000
    v_and_b32 v12, 15, v2
    v_bfe_u32 v13, v2, 1, 3
    v_xor_b32 v13, v5, v13
    v_lshlrev_b32 v13, 4, v13
    v_lshl_add_u32 v20, v12, 7, v13
    v_xor_b32 v21, 64, v20
    v_lshrrev_b32 v13, 2, v12
    v_lshl_add_u32 v13, v5, 3, v13
    v_lshlrev_b32 v13, 7, v13
    v_and_b32 v14, 3, v2
    s_add_u32 m0, m0, 4096
    s_add_u32 s63, s63, s55
    buffer_load_dwordx4 v18, s[24:27], s63 offen lds
    v_lshl_add_u32 v13, v14, 3, v13
    v_bfe_u32 v14, v2, 3, 2
    s_lshl_b32 s44, s16, 1
    v_xor_b32 v15, s44, v14
    v_lshl_add_u32 v22, v15, 5, v13
    s_lshl_b32 s44, s16, 12
    v_add_u32 v23, s44, v20
    s_lshl_b32 s45, s17, 14
    s_add_u32 s45, s45, 18432
    s_cmp_eq_u32 s20, 1
    s_cselect_b64 vcc, -1, 0
    s_cselect_b32 s44, 64, 32
    s_nop 0
    v_cndmask_b32 v22, v22, v23, vcc
    v_add_u32 v22, s45, v22
    v_xor_b32 v23, s44, v22
    s_add_u32 s45, s51, 2
    s_mul_i32 s44, s45, 43
    s_add_u32 m0, m0, 4096
    s_add_u32 s63, s63, s55
    buffer_load_dwordx4 v18, s[24:27], s63 offen lds
    s_lshr_b32 s44, s44, 7
    s_mul_i32 s44, s44, 3
    s_sub_u32 s44, s45, s44
    s_mul_i32 s44, s44, 51200
    v_add_u32 v22, s44, v22
    v_add_u32 v23, s44, v23
    v_lshrrev_b32 v14, 2, v12
    v_mov_b32 v13, 0x3f803f80
    v_cmp_eq_u32 vcc, 0, v14
    s_nop 1
    v_cndmask_b32 v28, 0, v13, vcc
    v_cndmask_b32 v29, 0, v13, vcc
    v_cndmask_b32 v30, 0, v13, vcc
    v_cndmask_b32 v31, 0, v13, vcc
    v_cmp_eq_u32 vcc, 1, v14
    s_nop 1
    v_cndmask_b32 v32, 0, v13, vcc
    v_cndmask_b32 v33, 0, v13, vcc
    s_add_u32 m0, m0, 4096
    s_add_u32 s63, s63, s55
    buffer_load_dwordx4 v18, s[24:27], s63 offen lds
    v_cndmask_b32 v34, 0, v13, vcc
    v_cndmask_b32 v35, 0, v13, vcc
    v_cmp_eq_u32 vcc, 2, v14
    s_nop 1
    v_cndmask_b32 v36, 0, v13, vcc
    v_cndmask_b32 v37, 0, v13, vcc
    v_cndmask_b32 v38, 0, v13, vcc
    v_cndmask_b32 v39, 0, v13, vcc
    v_cmp_eq_u32 vcc, 3, v14
    s_nop 1
    v_cndmask_b32 v40, 0, v13, vcc
    v_cndmask_b32 v41, 0, v13, vcc
    v_cndmask_b32 v42, 0, v13, vcc
    v_cndmask_b32 v43, 0, v13, vcc
    s_mul_i32 s7, s19, 20480
    s_lshl_b32 s44, s22, 9
    s_add_u32 s7, s7, s44
    s_add_u32 s7, s7, 0xed0000
    s_add_u32 m0, m0, 4096
    s_add_u32 s63, s63, s55
    s_cmp_ge_u32 s22, 2
    s_cbranch_scc1 parallel_sum__ssm_conv_s5__geglu_ffn__prompt_kernel_skA_3
    buffer_load_dwordx4 v18, s[24:27], s63 offen lds
parallel_sum__ssm_conv_s5__geglu_ffn__prompt_kernel_skA_3:
    s_lshl_b32 s44, s18, 11
    s_add_u32 s6, s7, s44
    v_lshlrev_b32 v24, 3, v2
    v_mov_b32 v6, 0
    s_add_u32 s52, s51, 1
    s_lshl_b32 s44, s2, 2
    s_add_u32 s44, s44, s22
    s_mov_b64 s[92:93], s[88:89]
    s_mov_b32 s94, 1966080
    s_mov_b32 s45, s44
    s_sub_u32 s47, s44, 552
    s_cmp_ge_u32 s44, 552
    s_cselect_b64 s[92:93], s[74:75], s[92:93]
    s_cselect_b32 s94, 819200, s94
    s_cselect_b32 s45, s47, s45
    s_sub_u32 s47, s44, 788
    s_cmp_ge_u32 s44, 788
    s_cselect_b64 s[92:93], s[76:77], s[92:93]
    s_cselect_b32 s94, 819200, s94
    s_cselect_b32 s45, s47, s45
    s_add_u32 m0, s62, 102400
    s_mov_b32 s63, s59
    buffer_load_dwordx4 v10, s[32:35], s63 offen offset:0 lds
    s_mov_b32 s95, 0x00020000
    s_mul_i32 s45, s45, 28
    v_min_u32 v98, 27, v2
    v_add_lshl_u32 v98, s45, v98, 7
    v_lshlrev_b32 v9, 4, v2
    s_and_b32 s44, s2, 1
    s_lshl_b32 s8, s44, 4
    s_lshr_b32 s45, s2, 3
    s_and_b32 s44, s2, 6
    s_lshl_b32 s44, s44, 1
    s_add_u32 s8, s8, s44
    s_lshr_b32 s46, s45, 3
    s_add_u32 s8, s8, s46
    s_and_b32 s9, s45, 7
    s_mul_i32 s46, s8, 88
    s_mul_i32 s44, s22, 12
    s_add_u32 s44, s44, 40
    s_add_u32 s45, s46, s44
    s_add_u32 s63, s63, s56
    buffer_load_dwordx4 v11, s[32:35], s63 offen offset:1024 lds
    s_lshl_b32 s84, s45, 12
    s_mul_i32 s44, s22, 10
    s_add_u32 s44, s44, 0
    s_add_u32 s45, s46, s44
    s_lshl_b32 s85, s45, 12
    s_mul_i32 s70, s22, 491520
    s_lshl_b32 s44, s9, 7
    s_add_u32 s70, s70, s44
    s_lshl_b32 s67, s9, 2
    s_add_u32 s67, s67, s22
    s_mul_i32 s68, s67, 3
    s_mul_i32 s67, s67, 12288
    s_add_u32 s67, s67, 0xb00000
    s_mul_i32 s69, s9, -61440
    s_add_u32 s69, s69, 586752
    s_mul_i32 s87, s9, -48
    s_add_u32 s87, s87, 512
    s_mul_i32 s44, s9, 81920
    s_add_u32 s63, s63, s56
    buffer_load_dwordx4 v10, s[32:35], s63 offen offset:2048 lds
    s_mul_i32 s45, s22, 5
    s_lshr_b32 s82, s45, 1
    s_lshl_b32 s86, s82, 7
    s_add_u32 s86, s86, s44
    s_add_u32 s45, s45, 1
    s_lshr_b32 s45, s45, 1
    s_lshl_b32 s66, s45, 7
    s_add_u32 s66, s66, s44
    s_lshl_b32 s44, s8, 2
    s_mul_i32 s45, s44, 57
    s_lshr_b32 s46, s45, 9
    s_add_u32 s44, s44, 3
    s_mul_i32 s45, s44, 57
    s_lshr_b32 s83, s45, 9
    s_sub_u32 s83, s83, s46
    s_lshl_b32 s83, s83, 14
    s_lshl_b32 s46, s46, 14
    s_add_u32 s46, s46, 0x1030000
    s_add_u32 s63, s63, s56
    buffer_load_dwordx4 v11, s[32:35], s63 offen offset:3072 lds
    s_mul_i32 s44, s22, 1536
    s_add_u32 s78, s46, s44
    s_lshl_b32 s44, s82, 8
    s_add_u32 s79, s46, s44
    s_add_u32 s79, s79, 6144
    s_mul_i32 s73, s22, 10240
    v_min_u32 v12, 35, v2
    s_mul_i32 s44, s22, 36
    v_add_u32 v1, s44, v12
    v_and_b32 v13, 1, v12
    v_mul_u32_u24 v13, 18, v13
    v_lshrrev_b32 v14, 1, v12
    v_add3_u32 v13, v13, v14, s44
    s_cmp_eq_u32 s20, 1
    s_cselect_b64 vcc, -1, 0
    s_mul_i32 s44, s18, 144
    s_lshl_b32 s45, s8, 6
    v_cndmask_b32 v13, v1, v13, vcc
    s_add_u32 m0, m0, 4096
    s_add_u32 s63, s63, s58
    buffer_load_dwordx4 v10, s[32:35], s63 offen offset:0 lds
    v_add_u32 v13, s44, v13
    v_min_u32 v13, 0x7ff, v13
    s_lshl_b32 s46, s22, 4
    s_add_u32 s45, s45, s46
    s_sub_u32 s46, s45, 48
    v_add_u32 v14, s46, v2
    v_cmp_eq_u32 vcc, 3, v5
    v_and_b32 v15, 31, v2
    v_lshrrev_b32 v12, 5, v2
    v_cndmask_b32 v13, v13, v14, vcc
    v_subrev_u32 v14, 36, v2
    v_cmp_gt_u32 vcc, 3, v14
    v_add_lshl_u32 v14, s68, v14, 3
    s_nop 0
    v_cndmask_b32 v13, v13, v14, vcc
    v_lshlrev_b32_e64 v4, 4, v13
    v_mul_u32_u24 v13, 10240, v12
    v_lshl_add_u32 v25, v15, 4, v13
    s_add_u32 s63, s63, s56
    buffer_load_dwordx4 v11, s[32:35], s63 offen offset:1024 lds
    v_lshl_add_u32 v13, v15, 1, v12
    s_lshl_b32 s44, s22, 8
    s_add_u32 s44, s44, 161920
    v_lshl_add_u32 v26, v13, 2, s44
    v_lshrrev_b32 v13, 3, v2
    v_mul_u32_u24 v13, 1280, v13
    v_and_b32 v14, 7, v2
    v_lshlrev_b32 v15, 1, v5
    v_xor_b32 v15, v14, v15
    v_lshl_add_u32 v0, v15, 4, v13
    v_xor_b32 v14, v14, v5
    v_lshl_add_u32 v254, v14, 4, v13
    v_xor_b32 v255, 64, v254
    v_lshrrev_b32 v13, 2, v2
    v_lshlrev_b32 v13, 7, v13
    v_and_b32_e64 v14, 3, v2
    v_lshl_add_u32 v13, v14, 3, v13
    v_bfe_u32 v14, v2, 3, 2
    s_add_u32 s63, s63, s56
    buffer_load_dwordx4 v10, s[32:35], s63 offen offset:2048 lds
    v_lshl_add_u32 v13, v14, 5, v13
    v_add_u32 v3, s73, v13
    v_xor_b32 v7, 32, v3
    v_xor_b32 v16, 64, v3
    v_xor_b32 v17, 96, v3
    v_add_u32 v19, s73, v9
    s_mul_i32 s71, s45, 1280
    s_lshl_b32 s44, s9, 7
    s_add_u32 s71, s71, s44
    s_lshl_b32 s72, s22, 11
    s_add_u32 s72, s72, 153600
    v_and_b32 v12, 15, v2
    v_lshlrev_b32 v13, 7, v12
    v_lshl_add_u32 v13, v5, 3, v13
    v_bfe_u32 v14, v2, 1, 2
    v_lshl_add_u32 v13, v14, 5, v13
    v_add_u32 v100, s72, v13
    v_xor_b32 v101, 32, v100
    s_add_u32 s63, s63, s56
    buffer_load_dwordx4 v11, s[32:35], s63 offen offset:3072 lds
    s_add_u32 s60, s60, 128
    s_add_u32 s59, s59, s57
    v_xor_b32_e64 v102, 64, v100
    v_xor_b32 v103, 96, v100
    v_mul_u32_u24 v12, 1280, v12
    v_lshl_add_u32 v96, v5, 3, v12
    v_lshl_add_u32 v97, v5, 3, s44
    s_mov_b32 s36, s80
    s_mov_b32 s37, s81
    s_mov_b32 s38, 0x500
    s_mov_b32 s39, 0x00020000
    s_lshl_b32 s44, s87, 1
    buffer_load_dwordx2 v[86:87], v97, s[36:39], 0 offen offset:0
    buffer_load_dwordx2 v[88:89], v97, s[36:39], 0 offen offset:32
    buffer_load_dwordx2 v[90:91], v97, s[36:39], 0 offen offset:64
    buffer_load_dwordx2 v[92:93], v97, s[36:39], 0 offen offset:96
    buffer_load_dwordx2 v[94:95], v97, s[36:39], s44 offen
    s_add_u32 s44, s44, s71
    buffer_load_dwordx2 v[84:85], v96, s[24:27], s44 offen
    s_mov_b32 s36, s88
    s_mov_b32 s37, s89
    s_mov_b32 s38, 0x1e0000
    s_mov_b32 s39, 0x00020000
    s_add_u32 m0, s61, 0
    s_mov_b32 s63, s60
    buffer_load_dwordx4 v18, s[24:27], s63 offen lds
    s_add_u32 m0, m0, 4096
    s_add_u32 s63, s63, s55
    buffer_load_dwordx4 v18, s[24:27], s63 offen lds
    s_add_u32 m0, m0, 4096
    s_add_u32 s63, s63, s55
    buffer_load_dwordx4 v18, s[24:27], s63 offen lds
    s_add_u32 m0, m0, 4096
    s_add_u32 s63, s63, s55
    buffer_load_dwordx4 v18, s[24:27], s63 offen lds
    s_add_u32 m0, m0, 4096
    s_add_u32 s63, s63, s55
    s_cmp_ge_u32 s22, 2
    s_cbranch_scc1 parallel_sum__ssm_conv_s5__geglu_ffn__prompt_kernel_skA_4
    buffer_load_dwordx4 v18, s[24:27], s63 offen lds
parallel_sum__ssm_conv_s5__geglu_ffn__prompt_kernel_skA_4:
    s_add_u32 m0, s62, 0
    s_mov_b32 s63, s59
    buffer_load_dwordx4 v10, s[32:35], s63 offen offset:0 lds
    s_add_u32 s63, s63, s56
    buffer_load_dwordx4 v11, s[32:35], s63 offen offset:1024 lds
    s_waitcnt vmcnt(12)
    s_setprio 0
    s_barrier
    s_add_u32 s63, s63, s56
    buffer_load_dwordx4 v10, s[32:35], s63 offen offset:2048 lds
    s_add_u32 s63, s63, s56
    buffer_load_dwordx4 v11, s[32:35], s63 offen offset:3072 lds
    s_add_u32 m0, m0, 4096
    s_add_u32 s63, s63, s58
    buffer_load_dwordx4 v10, s[32:35], s63 offen offset:0 lds
    s_add_u32 s63, s63, s56
    buffer_load_dwordx4 v11, s[32:35], s63 offen offset:1024 lds
    s_add_u32 s63, s63, s56
    buffer_load_dwordx4 v10, s[32:35], s63 offen offset:2048 lds
    s_add_u32 s63, s63, s56
    buffer_load_dwordx4 v11, s[32:35], s63 offen offset:3072 lds
    s_add_u32 s60, s60, 128
    s_add_u32 s59, s59, s57
    s_add_u32 m0, s61, 51200
    s_mov_b32 s63, s60
    buffer_load_dwordx4 v18, s[24:27], s63 offen lds
    s_add_u32 m0, m0, 4096
    s_add_u32 s63, s63, s55
    buffer_load_dwordx4 v18, s[24:27], s63 offen lds
    s_add_u32 m0, m0, 4096
    s_add_u32 s63, s63, s55
    buffer_load_dwordx4 v18, s[24:27], s63 offen lds
    s_add_u32 m0, m0, 4096
    s_add_u32 s63, s63, s55
    buffer_load_dwordx4 v18, s[24:27], s63 offen lds
    s_add_u32 m0, m0, 4096
    s_add_u32 s63, s63, s55
    s_cmp_ge_u32 s22, 2
    s_cbranch_scc1 parallel_sum__ssm_conv_s5__geglu_ffn__prompt_kernel_skA_5
    buffer_load_dwordx4 v18, s[24:27], s63 offen lds
parallel_sum__ssm_conv_s5__geglu_ffn__prompt_kernel_skA_5:
    s_add_u32 m0, s62, 51200
    s_mov_b32 s63, s59
    buffer_load_dwordx4 v10, s[32:35], s63 offen offset:0 lds
    s_add_u32 s63, s63, s56
    buffer_load_dwordx4 v11, s[32:35], s63 offen offset:1024 lds
    s_add_u32 s63, s63, s56
    buffer_load_dwordx4 v10, s[32:35], s63 offen offset:2048 lds
    s_add_u32 s63, s63, s56
    buffer_load_dwordx4 v11, s[32:35], s63 offen offset:3072 lds
    s_add_u32 m0, m0, 4096
    s_add_u32 s63, s63, s58
    buffer_load_dwordx4 v10, s[32:35], s63 offen offset:0 lds
    s_add_u32 s63, s63, s56
    buffer_load_dwordx4 v11, s[32:35], s63 offen offset:1024 lds
    s_add_u32 s63, s63, s56
    buffer_load_dwordx4 v10, s[32:35], s63 offen offset:2048 lds
    s_add_u32 s63, s63, s56
    buffer_load_dwordx4 v11, s[32:35], s63 offen offset:3072 lds
    s_add_u32 s60, s60, 128
    s_add_u32 s59, s59, s57
    s_waitcnt vmcnt(12)
    v_lshlrev_b32_e64 v12, 3, v2
    v_add_u32 v12, 161792, v12
    ds_read_b32 v240, v12
    ds_read_b32 v242, v12 offset:4
    s_cmp_lg_u32 s51, 0
    s_cbranch_scc1 parallel_sum__ssm_conv_s5__geglu_ffn__prompt_kernel_c_6
    s_call_b64 s[14:15], parallel_sum__ssm_conv_s5__geglu_ffn__prompt_kernel_sread
parallel_sum__ssm_conv_s5__geglu_ffn__prompt_kernel_c_6:
    s_waitcnt lgkmcnt(0)
    s_barrier
    s_add_u32 m0, s61, 102400
    s_mov_b32 s63, s60
    buffer_load_dwordx4 v18, s[24:27], s63 offen lds
    s_add_u32 m0, m0, 4096
    s_add_u32 s63, s63, s55
    buffer_load_dwordx4 v18, s[24:27], s63 offen lds
    s_add_u32 m0, m0, 4096
    s_add_u32 s63, s63, s55
    buffer_load_dwordx4 v18, s[24:27], s63 offen lds
    s_add_u32 m0, m0, 4096
    s_add_u32 s63, s63, s55
    buffer_load_dwordx4 v18, s[24:27], s63 offen lds
    s_add_u32 m0, m0, 4096
    s_add_u32 s63, s63, s55
    s_cmp_ge_u32 s22, 2
    s_cbranch_scc1 parallel_sum__ssm_conv_s5__geglu_ffn__prompt_kernel_skA_8
    buffer_load_dwordx4 v18, s[24:27], s63 offen lds
parallel_sum__ssm_conv_s5__geglu_ffn__prompt_kernel_skA_8:
    s_add_u32 m0, s62, 102400
    s_mov_b32 s63, s59
    buffer_load_dwordx4 v10, s[32:35], s63 offen offset:0 lds
    s_add_u32 s63, s63, s56
    buffer_load_dwordx4 v11, s[32:35], s63 offen offset:1024 lds
    s_add_u32 s63, s63, s56
    buffer_load_dwordx4 v10, s[32:35], s63 offen offset:2048 lds
    s_add_u32 s63, s63, s56
    buffer_load_dwordx4 v11, s[32:35], s63 offen offset:3072 lds
    s_add_u32 m0, m0, 4096
    s_add_u32 s63, s63, s58
    buffer_load_dwordx4 v10, s[32:35], s63 offen offset:0 lds
    s_add_u32 s63, s63, s56
    buffer_load_dwordx4 v11, s[32:35], s63 offen offset:1024 lds
    s_add_u32 s63, s63, s56
    buffer_load_dwordx4 v10, s[32:35], s63 offen offset:2048 lds
    s_add_u32 s63, s63, s56
    buffer_load_dwordx4 v11, s[32:35], s63 offen offset:3072 lds
    s_add_u32 s60, s60, 128
    s_add_u32 s59, s59, s57
    s_waitcnt vmcnt(12)
    buffer_load_dword v8, v6, s[40:43], 0 offen sc1
    s_cmp_lg_u32 s51, 1
    s_cbranch_scc1 parallel_sum__ssm_conv_s5__geglu_ffn__prompt_kernel_c_9
    s_call_b64 s[14:15], parallel_sum__ssm_conv_s5__geglu_ffn__prompt_kernel_sread
parallel_sum__ssm_conv_s5__geglu_ffn__prompt_kernel_c_9:
    s_cmp_lg_u32 s52, 1
    s_cbranch_scc1 parallel_sum__ssm_conv_s5__geglu_ffn__prompt_kernel_c_10
    s_call_b64 s[14:15], parallel_sum__ssm_conv_s5__geglu_ffn__prompt_kernel_spub
parallel_sum__ssm_conv_s5__geglu_ffn__prompt_kernel_c_10:
    s_waitcnt lgkmcnt(0)
    s_barrier
    s_add_u32 m0, s61, 0
    s_mov_b32 s63, s60
    buffer_load_dwordx4 v18, s[24:27], s63 offen lds
    v_lshlrev_b32_e64 v124, 16, v86
    v_and_b32 v125, 0xffff0000, v86
    s_add_u32 m0, m0, 4096
    s_add_u32 s63, s63, s55
    buffer_load_dwordx4 v18, s[24:27], s63 offen lds
    v_lshlrev_b32 v126, 16, v87
    v_and_b32 v127, 0xffff0000, v87
    s_add_u32 m0, m0, 4096
    s_add_u32 s63, s63, s55
    buffer_load_dwordx4 v18, s[24:27], s63 offen lds
    v_lshlrev_b32 v128, 16, v88
    v_and_b32 v129, 0xffff0000, v88
    s_add_u32 m0, m0, 4096
    s_add_u32 s63, s63, s55
    buffer_load_dwordx4 v18, s[24:27], s63 offen lds
    v_lshlrev_b32 v130, 16, v89
    v_and_b32 v131, 0xffff0000, v89
    s_add_u32 m0, m0, 4096
    s_add_u32 s63, s63, s55
    s_cmp_ge_u32 s22, 2
    s_cbranch_scc1 parallel_sum__ssm_conv_s5__geglu_ffn__prompt_kernel_skA_11
    buffer_load_dwordx4 v18, s[24:27], s63 offen lds
parallel_sum__ssm_conv_s5__geglu_ffn__prompt_kernel_skA_11:
    v_lshlrev_b32 v132, 16, v90
    v_and_b32 v133, 0xffff0000, v90
    s_add_u32 m0, s62, 0
    s_mov_b32 s63, s59
    buffer_load_dwordx4 v10, s[32:35], s63 offen offset:0 lds
    v_lshlrev_b32 v134, 16, v91
    v_and_b32 v135, 0xffff0000, v91
    s_add_u32 s63, s63, s56
    buffer_load_dwordx4 v11, s[32:35], s63 offen offset:1024 lds
    v_lshlrev_b32 v136, 16, v92
    v_and_b32 v137, 0xffff0000, v92
    s_add_u32 s63, s63, s56
    buffer_load_dwordx4 v10, s[32:35], s63 offen offset:2048 lds
    v_lshlrev_b32 v138, 16, v93
    v_and_b32 v139, 0xffff0000, v93
    s_add_u32 s63, s63, s56
    buffer_load_dwordx4 v11, s[32:35], s63 offen offset:3072 lds
    v_lshlrev_b32_e64 v140, 16, v94
    v_and_b32 v141, 0xffff0000, v94
    s_add_u32 m0, m0, 4096
    s_add_u32 s63, s63, s58
    buffer_load_dwordx4 v10, s[32:35], s63 offen offset:0 lds
    v_lshlrev_b32 v142, 16, v95
    v_and_b32 v143, 0xffff0000, v95
    s_add_u32 s63, s63, s56
    buffer_load_dwordx4 v11, s[32:35], s63 offen offset:1024 lds
    s_add_u32 s63, s63, s56
    buffer_load_dwordx4 v10, s[32:35], s63 offen offset:2048 lds
    s_add_u32 s63, s63, s56
    buffer_load_dwordx4 v11, s[32:35], s63 offen offset:3072 lds
    s_add_u32 s60, s60, s53
    s_add_u32 s59, s59, s54
    s_waitcnt vmcnt(13)
    buffer_load_dword v99, v98, s[92:95], 0 offen
    s_cmp_lg_u32 s51, 2
    s_cbranch_scc1 parallel_sum__ssm_conv_s5__geglu_ffn__prompt_kernel_c_12
    s_call_b64 s[14:15], parallel_sum__ssm_conv_s5__geglu_ffn__prompt_kernel_sread
parallel_sum__ssm_conv_s5__geglu_ffn__prompt_kernel_c_12:
    s_cmp_lg_u32 s52, 2
    s_cbranch_scc1 parallel_sum__ssm_conv_s5__geglu_ffn__prompt_kernel_c_13
    s_call_b64 s[14:15], parallel_sum__ssm_conv_s5__geglu_ffn__prompt_kernel_spub
parallel_sum__ssm_conv_s5__geglu_ffn__prompt_kernel_c_13:
    s_waitcnt lgkmcnt(0)
    s_barrier
    s_add_u32 m0, s61, 51200
    s_mov_b32 s63, s60
    buffer_load_dwordx4 v18, s[24:27], s63 offen lds
    s_add_u32 m0, m0, 4096
    s_add_u32 s63, s63, s55
    buffer_load_dwordx4 v18, s[24:27], s63 offen lds
    s_add_u32 m0, m0, 4096
    s_add_u32 s63, s63, s55
    buffer_load_dwordx4 v18, s[24:27], s63 offen lds
    s_add_u32 m0, m0, 4096
    s_add_u32 s63, s63, s55
    buffer_load_dwordx4 v18, s[24:27], s63 offen lds
    s_add_u32 m0, m0, 4096
    s_add_u32 s63, s63, s55
    s_cmp_ge_u32 s22, 2
    s_cbranch_scc1 parallel_sum__ssm_conv_s5__geglu_ffn__prompt_kernel_skA_14
    buffer_load_dwordx4 v18, s[24:27], s63 offen lds
parallel_sum__ssm_conv_s5__geglu_ffn__prompt_kernel_skA_14:
    s_add_u32 m0, s62, 51200
    s_mov_b32 s63, s59
    buffer_load_dwordx4 v10, s[32:35], s63 offen offset:0 lds
    s_add_u32 s63, s63, s56
    buffer_load_dwordx4 v11, s[32:35], s63 offen offset:1024 lds
    s_add_u32 s63, s63, s56
    buffer_load_dwordx4 v10, s[32:35], s63 offen offset:2048 lds
    s_add_u32 s63, s63, s56
    buffer_load_dwordx4 v11, s[32:35], s63 offen offset:3072 lds
    s_add_u32 m0, m0, 4096
    s_add_u32 s63, s63, s58
    buffer_load_dwordx4 v10, s[32:35], s63 offen offset:0 lds
    s_add_u32 s63, s63, s56
    buffer_load_dwordx4 v11, s[32:35], s63 offen offset:1024 lds
    s_add_u32 s63, s63, s56
    buffer_load_dwordx4 v10, s[32:35], s63 offen offset:2048 lds
    s_add_u32 s63, s63, s56
    buffer_load_dwordx4 v11, s[32:35], s63 offen offset:3072 lds
    s_add_u32 s60, s60, 128
    s_add_u32 s59, s59, s57
    s_waitcnt vmcnt(13)
    s_mov_b32 m0, s72
    s_add_u32 s44, s71, 9216
    buffer_load_dwordx4 v0, s[24:27], s71 offen lds
    buffer_load_dwordx4 v0, s[24:27], s44 offen offset:1024 lds
    s_mov_b32 s5, 0
parallel_sum__ssm_conv_s5__geglu_ffn__prompt_kernel_tg_15:
    v_cmp_eq_u32 vcc, 0, v8
    s_add_u32 s5, s5, 1
    s_nop 3
    s_cbranch_vccz parallel_sum__ssm_conv_s5__geglu_ffn__prompt_kernel_tgo_16
    s_cmp_ge_u32 s5, 0x20000
    s_cbranch_scc1 parallel_sum__ssm_conv_s5__geglu_ffn__prompt_kernel_tgo_16
    s_sleep 2
    buffer_load_dword v8, v6, s[40:43], 0 offen sc1
    s_waitcnt vmcnt(0)
    s_branch parallel_sum__ssm_conv_s5__geglu_ffn__prompt_kernel_tg_15
parallel_sum__ssm_conv_s5__geglu_ffn__prompt_kernel_tgo_16:
    v_readfirstlane_b32 s4, v8
    s_lshl_b32 s44, s3, 7
    s_add_u32 s44, s44, 0xe70000
    s_cmp_eq_u32 s22, 0
    s_cselect_b32 s44, s44, 0x7f000000
    v_mov_b32 v241, s4
    v_mov_b32 v243, s4
    s_mov_b64 exec, 0xff
    s_waitcnt lgkmcnt(0)
    buffer_store_dwordx4 v[240:243], v9, s[28:31], s44 offen sc1
    s_mov_b64 exec, -1
    s_cmp_lg_u32 s51, 3
    s_cbranch_scc1 parallel_sum__ssm_conv_s5__geglu_ffn__prompt_kernel_c_17
    s_call_b64 s[14:15], parallel_sum__ssm_conv_s5__geglu_ffn__prompt_kernel_sread
parallel_sum__ssm_conv_s5__geglu_ffn__prompt_kernel_c_17:
    s_cmp_lg_u32 s52, 3
    s_cbranch_scc1 parallel_sum__ssm_conv_s5__geglu_ffn__prompt_kernel_c_18
    s_call_b64 s[14:15], parallel_sum__ssm_conv_s5__geglu_ffn__prompt_kernel_spub
parallel_sum__ssm_conv_s5__geglu_ffn__prompt_kernel_c_18:
    s_cmp_le_u32 s52, 3
    s_cselect_b32 s44, s6, 0x7f000000
    v_mov_b32 v237, s4
    buffer_store_dwordx2 v[236:237], v24, s[28:31], s44 offen sc1
    s_waitcnt lgkmcnt(0)
    s_barrier
    s_add_u32 m0, s61, 102400
    s_mov_b32 s63, s60
    buffer_load_dwordx4 v18, s[24:27], s63 offen lds
    s_add_u32 m0, m0, 4096
    s_add_u32 s63, s63, s55
    buffer_load_dwordx4 v18, s[24:27], s63 offen lds
    s_add_u32 m0, m0, 4096
    s_add_u32 s63, s63, s55
    buffer_load_dwordx4 v18, s[24:27], s63 offen lds
    s_add_u32 m0, m0, 4096
    s_add_u32 s63, s63, s55
    buffer_load_dwordx4 v18, s[24:27], s63 offen lds
    s_add_u32 m0, m0, 4096
    s_add_u32 s63, s63, s55
    s_cmp_ge_u32 s22, 2
    s_cbranch_scc1 parallel_sum__ssm_conv_s5__geglu_ffn__prompt_kernel_skA_19
    buffer_load_dwordx4 v18, s[24:27], s63 offen lds
parallel_sum__ssm_conv_s5__geglu_ffn__prompt_kernel_skA_19:
    s_add_u32 m0, s62, 102400
    s_mov_b32 s63, s59
    buffer_load_dwordx4 v10, s[32:35], s63 offen offset:0 lds
    s_add_u32 s63, s63, s56
    buffer_load_dwordx4 v11, s[32:35], s63 offen offset:1024 lds
    s_add_u32 s63, s63, s56
    buffer_load_dwordx4 v10, s[32:35], s63 offen offset:2048 lds
    s_add_u32 s63, s63, s56
    buffer_load_dwordx4 v11, s[32:35], s63 offen offset:3072 lds
    s_add_u32 m0, m0, 4096
    s_add_u32 s63, s63, s58
    buffer_load_dwordx4 v10, s[32:35], s63 offen offset:0 lds
    s_add_u32 s63, s63, s56
    buffer_load_dwordx4 v11, s[32:35], s63 offen offset:1024 lds
    s_add_u32 s63, s63, s56
    buffer_load_dwordx4 v10, s[32:35], s63 offen offset:2048 lds
    s_add_u32 s63, s63, s56
    buffer_load_dwordx4 v11, s[32:35], s63 offen offset:3072 lds
    s_add_u32 s60, s60, 128
    s_add_u32 s59, s59, s57
    s_waitcnt vmcnt(16)
    s_cmp_lg_u32 s51, 4
    s_cbranch_scc1 parallel_sum__ssm_conv_s5__geglu_ffn__prompt_kernel_c_20
    s_call_b64 s[14:15], parallel_sum__ssm_conv_s5__geglu_ffn__prompt_kernel_sread
parallel_sum__ssm_conv_s5__geglu_ffn__prompt_kernel_c_20:
    s_cmp_lg_u32 s52, 4
    s_cbranch_scc1 parallel_sum__ssm_conv_s5__geglu_ffn__prompt_kernel_c_21
    s_call_b64 s[14:15], parallel_sum__ssm_conv_s5__geglu_ffn__prompt_kernel_spub
parallel_sum__ssm_conv_s5__geglu_ffn__prompt_kernel_c_21:
    s_cmp_eq_u32 s52, 4
    s_cselect_b32 s44, s6, 0x7f000000
    v_mov_b32 v237, s4
    buffer_store_dwordx2 v[236:237], v24, s[28:31], s44 offen sc1
    s_waitcnt lgkmcnt(0)
    s_barrier
    s_add_u32 m0, s61, 0
    s_mov_b32 s63, s60
    buffer_load_dwordx4 v18, s[24:27], s63 offen lds
    s_add_u32 m0, m0, 4096
    s_add_u32 s63, s63, s55
    buffer_load_dwordx4 v18, s[24:27], s63 offen lds
    s_add_u32 m0, m0, 4096
    s_add_u32 s63, s63, s55
    buffer_load_dwordx4 v18, s[24:27], s63 offen lds
    s_add_u32 m0, m0, 4096
    s_add_u32 s63, s63, s55
    buffer_load_dwordx4 v18, s[24:27], s63 offen lds
    s_add_u32 m0, m0, 4096
    s_add_u32 s63, s63, s55
    s_cmp_ge_u32 s22, 2
    s_cbranch_scc1 parallel_sum__ssm_conv_s5__geglu_ffn__prompt_kernel_skA_22
    buffer_load_dwordx4 v18, s[24:27], s63 offen lds
parallel_sum__ssm_conv_s5__geglu_ffn__prompt_kernel_skA_22:
    s_add_u32 m0, s62, 0
    s_mov_b32 s63, s59
    buffer_load_dwordx4 v10, s[32:35], s63 offen offset:0 lds
    s_add_u32 s63, s63, s56
    buffer_load_dwordx4 v11, s[32:35], s63 offen offset:1024 lds
    s_add_u32 s63, s63, s56
    buffer_load_dwordx4 v10, s[32:35], s63 offen offset:2048 lds
    s_add_u32 s63, s63, s56
    buffer_load_dwordx4 v11, s[32:35], s63 offen offset:3072 lds
    s_add_u32 m0, m0, 4096
    s_add_u32 s63, s63, s58
    buffer_load_dwordx4 v10, s[32:35], s63 offen offset:0 lds
    s_add_u32 s63, s63, s56
    buffer_load_dwordx4 v11, s[32:35], s63 offen offset:1024 lds
    s_add_u32 s63, s63, s56
    buffer_load_dwordx4 v10, s[32:35], s63 offen offset:2048 lds
    s_add_u32 s63, s63, s56
    buffer_load_dwordx4 v11, s[32:35], s63 offen offset:3072 lds
    s_add_u32 s60, s60, 128
    s_add_u32 s59, s59, s57
    s_waitcnt vmcnt(13)
    ds_read_b64 v[76:77], v100
    ds_read_b64 v[78:79], v101
    ds_read_b64 v[80:81], v102
    ds_read_b64 v[82:83], v103
    s_cmp_lg_u32 s52, 5
    s_cbranch_scc1 parallel_sum__ssm_conv_s5__geglu_ffn__prompt_kernel_c_24
    s_call_b64 s[14:15], parallel_sum__ssm_conv_s5__geglu_ffn__prompt_kernel_spub
parallel_sum__ssm_conv_s5__geglu_ffn__prompt_kernel_c_24:
    s_cmp_eq_u32 s52, 5
    s_cselect_b32 s44, s6, 0x7f000000
    v_mov_b32 v237, s4
    buffer_store_dwordx2 v[236:237], v24, s[28:31], s44 offen sc1
    s_waitcnt lgkmcnt(0)
    s_barrier
    s_add_u32 m0, s61, 51200
    s_mov_b32 s63, s60
    buffer_load_dwordx4 v18, s[24:27], s63 offen lds
    v_lshlrev_b32_e64 v104, 16, v76
    v_and_b32 v105, 0xffff0000, v76
    s_add_u32 m0, m0, 4096
    s_add_u32 s63, s63, s55
    buffer_load_dwordx4 v18, s[24:27], s63 offen lds
    v_lshlrev_b32 v106, 16, v77
    v_and_b32 v107, 0xffff0000, v77
    s_add_u32 m0, m0, 4096
    s_add_u32 s63, s63, s55
    buffer_load_dwordx4 v18, s[24:27], s63 offen lds
    v_lshlrev_b32 v108, 16, v78
    v_and_b32 v109, 0xffff0000, v78
    s_add_u32 m0, m0, 4096
    s_add_u32 s63, s63, s55
    buffer_load_dwordx4 v18, s[24:27], s63 offen lds
    v_lshlrev_b32 v110, 16, v79
    v_and_b32 v111, 0xffff0000, v79
    s_add_u32 m0, m0, 4096
    s_add_u32 s63, s63, s55
    s_cmp_ge_u32 s22, 2
    s_cbranch_scc1 parallel_sum__ssm_conv_s5__geglu_ffn__prompt_kernel_skA_25
    buffer_load_dwordx4 v18, s[24:27], s63 offen lds
parallel_sum__ssm_conv_s5__geglu_ffn__prompt_kernel_skA_25:
    v_lshlrev_b32 v112, 16, v80
    v_and_b32 v113, 0xffff0000, v80
    s_add_u32 m0, s62, 51200
    s_mov_b32 s63, s59
    buffer_load_dwordx4 v10, s[32:35], s63 offen offset:0 lds
    v_lshlrev_b32 v114, 16, v81
    v_and_b32 v115, 0xffff0000, v81
    s_add_u32 s63, s63, s56
    buffer_load_dwordx4 v11, s[32:35], s63 offen offset:1024 lds
    v_lshlrev_b32 v116, 16, v82
    v_and_b32 v117, 0xffff0000, v82
    s_add_u32 s63, s63, s56
    buffer_load_dwordx4 v10, s[32:35], s63 offen offset:2048 lds
    v_lshlrev_b32 v118, 16, v83
    v_and_b32 v119, 0xffff0000, v83
    s_add_u32 s63, s63, s56
    buffer_load_dwordx4 v11, s[32:35], s63 offen offset:3072 lds
    v_lshlrev_b32 v120, 16, v84
    v_and_b32 v121, 0xffff0000, v84
    s_add_u32 m0, m0, 4096
    s_add_u32 s63, s63, s58
    buffer_load_dwordx4 v10, s[32:35], s63 offen offset:0 lds
    v_lshlrev_b32 v122, 16, v85
    v_and_b32 v123, 0xffff0000, v85
    s_add_u32 s63, s63, s56
    buffer_load_dwordx4 v11, s[32:35], s63 offen offset:1024 lds
    s_add_u32 s63, s63, s56
    buffer_load_dwordx4 v10, s[32:35], s63 offen offset:2048 lds
    s_add_u32 s63, s63, s56
    buffer_load_dwordx4 v11, s[32:35], s63 offen offset:3072 lds
    s_add_u32 s60, s60, 128
    s_add_u32 s59, s59, s57
    s_waitcnt vmcnt(13)
    s_waitcnt lgkmcnt(0)
    s_barrier
    s_add_u32 m0, s61, 102400
    s_mov_b32 s63, s60
    buffer_load_dwordx4 v18, s[24:27], s63 offen lds
    s_add_u32 m0, m0, 4096
    s_add_u32 s63, s63, s55
    buffer_load_dwordx4 v18, s[24:27], s63 offen lds
    s_add_u32 m0, m0, 4096
    s_add_u32 s63, s63, s55
    buffer_load_dwordx4 v18, s[24:27], s63 offen lds
    s_add_u32 m0, m0, 4096
    s_add_u32 s63, s63, s55
    buffer_load_dwordx4 v18, s[24:27], s63 offen lds
    s_add_u32 m0, m0, 4096
    s_add_u32 s63, s63, s55
    s_cmp_ge_u32 s22, 2
    s_cbranch_scc1 parallel_sum__ssm_conv_s5__geglu_ffn__prompt_kernel_skA_26
    buffer_load_dwordx4 v18, s[24:27], s63 offen lds
parallel_sum__ssm_conv_s5__geglu_ffn__prompt_kernel_skA_26:
    s_add_u32 m0, s62, 102400
    s_mov_b32 s63, s59
    buffer_load_dwordx4 v10, s[32:35], s63 offen offset:0 lds
    s_add_u32 s63, s63, s56
    buffer_load_dwordx4 v11, s[32:35], s63 offen offset:1024 lds
    s_add_u32 s63, s63, s56
    buffer_load_dwordx4 v10, s[32:35], s63 offen offset:2048 lds
    s_add_u32 s63, s63, s56
    buffer_load_dwordx4 v11, s[32:35], s63 offen offset:3072 lds
    s_add_u32 m0, m0, 4096
    s_add_u32 s63, s63, s58
    buffer_load_dwordx4 v10, s[32:35], s63 offen offset:0 lds
    s_add_u32 s63, s63, s56
    buffer_load_dwordx4 v11, s[32:35], s63 offen offset:1024 lds
    s_add_u32 s63, s63, s56
    buffer_load_dwordx4 v10, s[32:35], s63 offen offset:2048 lds
    s_add_u32 s63, s63, s56
    buffer_load_dwordx4 v11, s[32:35], s63 offen offset:3072 lds
    s_add_u32 s60, s60, 128
    s_add_u32 s59, s59, s57
    s_waitcnt vmcnt(12)
    s_mov_b32 s44, 0xe70000
    buffer_load_dwordx4 v[44:47], v4, s[28:31], s44 offen sc1
    s_add_u32 s44, s7, 0
    buffer_load_dwordx4 v[48:51], v25, s[28:31], s44 offen sc1
    s_add_u32 s44, s7, 2048
    buffer_load_dwordx4 v[52:55], v25, s[28:31], s44 offen sc1
    s_add_u32 s44, s7, 4096
    buffer_load_dwordx4 v[56:59], v25, s[28:31], s44 offen sc1
    s_add_u32 s44, s7, 6144
    buffer_load_dwordx4 v[60:63], v25, s[28:31], s44 offen sc1
    s_add_u32 s44, s7, 8192
    buffer_load_dwordx4 v[64:67], v25, s[28:31], s44 offen sc1
    s_waitcnt lgkmcnt(0)
    s_barrier
    s_add_u32 m0, s73, 0
    s_add_u32 s46, s70, 0
    buffer_load_dwordx4 v0, s[36:39], s46 offen offset:0 lds
    s_add_u32 s46, s70, 9216
    buffer_load_dwordx4 v0, s[36:39], s46 offen offset:1024 lds
    s_add_u32 s46, s70, 18432
    buffer_load_dwordx4 v0, s[36:39], s46 offen offset:2048 lds
    s_add_u32 s46, s70, 27648
    buffer_load_dwordx4 v0, s[36:39], s46 offen offset:3072 lds
    s_add_u32 m0, s73, 5120
    s_add_u32 s46, s70, 40960
    buffer_load_dwordx4 v0, s[36:39], s46 offen offset:0 lds
    s_add_u32 s46, s70, 50176
    buffer_load_dwordx4 v0, s[36:39], s46 offen offset:1024 lds
    s_add_u32 s46, s70, 59392
    buffer_load_dwordx4 v0, s[36:39], s46 offen offset:2048 lds
    s_add_u32 s46, s70, 68608
    buffer_load_dwordx4 v0, s[36:39], s46 offen offset:3072 lds
    s_waitcnt vmcnt(8)
    s_mov_b32 s5, 0
parallel_sum__ssm_conv_s5__geglu_ffn__prompt_kernel_sg_27:
    v_xor_b32 v68, s4, v45
    v_bitop3_b32 v68, v68, s4, v47 bitop3:0xf6
    v_bitop3_b32 v68, v68, s4, v49 bitop3:0xf6
    v_bitop3_b32 v68, v68, s4, v51 bitop3:0xf6
    v_bitop3_b32 v68, v68, s4, v53 bitop3:0xf6
    v_bitop3_b32 v68, v68, s4, v55 bitop3:0xf6
    v_bitop3_b32 v68, v68, s4, v57 bitop3:0xf6
    v_bitop3_b32 v68, v68, s4, v59 bitop3:0xf6
    v_bitop3_b32 v68, v68, s4, v61 bitop3:0xf6
    v_bitop3_b32 v68, v68, s4, v63 bitop3:0xf6
    v_bitop3_b32 v68, v68, s4, v65 bitop3:0xf6
    v_bitop3_b32 v68, v68, s4, v67 bitop3:0xf6
    v_cmp_ne_u32 vcc, 0, v68
    s_add_u32 s5, s5, 1
    s_nop 3
    s_cbranch_vccz parallel_sum__ssm_conv_s5__geglu_ffn__prompt_kernel_sgo_28
    s_cmp_ge_u32 s5, 0x20000
    s_cbranch_scc1 parallel_sum__ssm_conv_s5__geglu_ffn__prompt_kernel_sgo_28
    s_sleep 2
    s_mov_b32 s44, 0xe70000
    buffer_load_dwordx4 v[44:47], v4, s[28:31], s44 offen sc1
    s_add_u32 s44, s7, 0
    buffer_load_dwordx4 v[48:51], v25, s[28:31], s44 offen sc1
    s_add_u32 s44, s7, 2048
    buffer_load_dwordx4 v[52:55], v25, s[28:31], s44 offen sc1
    s_add_u32 s44, s7, 4096
    buffer_load_dwordx4 v[56:59], v25, s[28:31], s44 offen sc1
    s_add_u32 s44, s7, 6144
    buffer_load_dwordx4 v[60:63], v25, s[28:31], s44 offen sc1
    s_add_u32 s44, s7, 8192
    buffer_load_dwordx4 v[64:67], v25, s[28:31], s44 offen sc1
    s_waitcnt vmcnt(0)
    s_branch parallel_sum__ssm_conv_s5__geglu_ffn__prompt_kernel_sg_27
parallel_sum__ssm_conv_s5__geglu_ffn__prompt_kernel_sgo_28:
    v_rcp_f32 v45, v46
    v_add_f32 v48, v48, v52
    v_add_f32 v50, v50, v54
    v_add_f32 v48, v48, v56
    v_add_f32 v50, v50, v58
    s_add_u32 m0, s73, 4096
    s_add_u32 s46, s67, 0
    buffer_load_dwordx4 v9, s[28:31], s46 offen sc1 lds
    v_add_f32 v48, v48, v60
    v_add_f32 v50, v50, v62
    v_add_f32 v48, v48, v64
    v_add_f32 v50, v50, v66
    v_mov_b32 v72, v44
    s_add_u32 m0, s73, 9216
    s_add_u32 s46, s67, 1024
    buffer_load_dwordx4 v9, s[28:31], s46 offen sc1 lds
    v_mul_f32 v75, v46, v46
    v_permlane32_swap_b32 v48, v50
    v_mul_f32 v73, 0xc0135761, v45
    v_mul_f32 v74, v45, v45
    v_add_f32 v48, v48, v50
    v_mul_f32 v74, v74, v45
    v_mul_f32 v74, 0xbdd2d3e8, v74
    v_or_b32 v12, 48, v2
    v_lshlrev_b32_e64 v12, 2, v12
    ds_bpermute_b32 v20, v12, v44
    ds_bpermute_b32 v21, v12, v45
    v_lshlrev_b32 v68, 4, v1
    v_add_u32 v68, 153600, v68
    v_lshlrev_b32 v69, 2, v1
    v_add_u32 v69, 160768, v69
    s_waitcnt lgkmcnt(0)
    s_barrier
    ds_write_b32 v26, v48
    s_mov_b32 exec_hi, 0xf
    ds_write_b128 v68, v[72:75]
    ds_write_b32 v69, v44
    ds_write_b32 v69, v45 offset:576
    s_mov_b32 exec_hi, -1
    s_add_u32 m0, s73, 40960
    s_add_u32 s46, s70, 122880
    buffer_load_dwordx4 v0, s[36:39], s46 offen offset:0 lds
    s_add_u32 s46, s70, 132096
    buffer_load_dwordx4 v0, s[36:39], s46 offen offset:1024 lds
    s_add_u32 s46, s70, 141312
    buffer_load_dwordx4 v0, s[36:39], s46 offen offset:2048 lds
    s_add_u32 s46, s70, 150528
    buffer_load_dwordx4 v0, s[36:39], s46 offen offset:3072 lds
    s_add_u32 m0, s73, 45056
    s_add_u32 s46, s67, 3072
    buffer_load_dwordx4 v9, s[28:31], s46 offen sc1 lds
    s_add_u32 m0, s73, 46080
    s_add_u32 s46, s70, 204800
    buffer_load_dwordx4 v0, s[36:39], s46 offen offset:0 lds
    s_add_u32 s46, s70, 214016
    buffer_load_dwordx4 v0, s[36:39], s46 offen offset:1024 lds
    s_add_u32 s46, s70, 223232
    buffer_load_dwordx4 v0, s[36:39], s46 offen offset:2048 lds
    s_add_u32 s46, s70, 232448
    buffer_load_dwordx4 v0, s[36:39], s46 offen offset:3072 lds
    s_add_u32 m0, s73, 50176
    s_add_u32 s46, s67, 5120
    buffer_load_dwordx4 v9, s[28:31], s46 offen sc1 lds
    s_waitcnt lgkmcnt(0)
    s_barrier
parallel_sum__ssm_conv_s5__geglu_ffn__prompt_kernel_pre:
    s_add_u32 m0, s73, 81920
    s_add_u32 s46, s70, 286720
    buffer_load_dwordx4 v0, s[36:39], s46 offen offset:0 lds
    s_add_u32 s46, s70, 295936
    buffer_load_dwordx4 v0, s[36:39], s46 offen offset:1024 lds
    s_add_u32 s46, s70, 305152
    buffer_load_dwordx4 v0, s[36:39], s46 offen offset:2048 lds
    s_add_u32 s46, s70, 314368
    buffer_load_dwordx4 v0, s[36:39], s46 offen offset:3072 lds
    s_add_u32 m0, s73, 86016
    s_add_u32 s46, s67, 7168
    buffer_load_dwordx4 v9, s[28:31], s46 offen sc1 lds
    s_add_u32 m0, s73, 87040
    s_add_u32 s46, s70, 409600
    buffer_load_dwordx4 v0, s[36:39], s46 offen offset:0 lds
    s_add_u32 s46, s70, 418816
    buffer_load_dwordx4 v0, s[36:39], s46 offen offset:1024 lds
    s_add_u32 s46, s70, 428032
    buffer_load_dwordx4 v0, s[36:39], s46 offen offset:2048 lds
    s_add_u32 s46, s70, 437248
    buffer_load_dwordx4 v0, s[36:39], s46 offen offset:3072 lds
    s_add_u32 m0, s73, 91136
    s_add_u32 s46, s67, 10240
    buffer_load_dwordx4 v9, s[28:31], s46 offen sc1 lds
    v_pk_add_f32 v[24:25], v[104:105], v[20:21] op_sel:[0,0] op_sel_hi:[1,0] neg_lo:[0,1] neg_hi:[0,1]
    v_pk_add_f32 v[26:27], v[106:107], v[20:21] op_sel:[0,0] op_sel_hi:[1,0] neg_lo:[0,1] neg_hi:[0,1]
    v_pk_add_f32 v[28:29], v[108:109], v[20:21] op_sel:[0,0] op_sel_hi:[1,0] neg_lo:[0,1] neg_hi:[0,1]
    v_pk_add_f32 v[30:31], v[110:111], v[20:21] op_sel:[0,0] op_sel_hi:[1,0] neg_lo:[0,1] neg_hi:[0,1]
    v_pk_add_f32 v[32:33], v[112:113], v[20:21] op_sel:[0,0] op_sel_hi:[1,0] neg_lo:[0,1] neg_hi:[0,1]
    v_pk_add_f32 v[34:35], v[114:115], v[20:21] op_sel:[0,0] op_sel_hi:[1,0] neg_lo:[0,1] neg_hi:[0,1]
    v_pk_add_f32 v[36:37], v[116:117], v[20:21] op_sel:[0,0] op_sel_hi:[1,0] neg_lo:[0,1] neg_hi:[0,1]
    v_pk_add_f32 v[38:39], v[118:119], v[20:21] op_sel:[0,0] op_sel_hi:[1,0] neg_lo:[0,1] neg_hi:[0,1]
    v_pk_add_f32 v[40:41], v[120:121], v[20:21] op_sel:[0,0] op_sel_hi:[1,0] neg_lo:[0,1] neg_hi:[0,1]
    v_pk_add_f32 v[42:43], v[122:123], v[20:21] op_sel:[0,0] op_sel_hi:[1,0] neg_lo:[0,1] neg_hi:[0,1]
    v_pk_mul_f32 v[124:125], v[20:21], v[124:125] op_sel:[1,0] op_sel_hi:[1,1]
    v_pk_mul_f32 v[126:127], v[20:21], v[126:127] op_sel:[1,0] op_sel_hi:[1,1]
    v_pk_mul_f32 v[128:129], v[20:21], v[128:129] op_sel:[1,0] op_sel_hi:[1,1]
    v_pk_mul_f32 v[130:131], v[20:21], v[130:131] op_sel:[1,0] op_sel_hi:[1,1]
    v_pk_mul_f32 v[132:133], v[20:21], v[132:133] op_sel:[1,0] op_sel_hi:[1,1]
    v_pk_mul_f32 v[134:135], v[20:21], v[134:135] op_sel:[1,0] op_sel_hi:[1,1]
    v_pk_mul_f32 v[136:137], v[20:21], v[136:137] op_sel:[1,0] op_sel_hi:[1,1]
    v_pk_mul_f32 v[138:139], v[20:21], v[138:139] op_sel:[1,0] op_sel_hi:[1,1]
    v_pk_mul_f32 v[140:141], v[20:21], v[140:141] op_sel:[1,0] op_sel_hi:[1,1]
    v_pk_mul_f32 v[142:143], v[20:21], v[142:143] op_sel:[1,0] op_sel_hi:[1,1]
    v_pk_fma_f32 v[24:25], v[24:25], v[124:125], v[104:105] op_sel:[0,0,0] op_sel_hi:[1,1,1]
    v_pk_fma_f32 v[26:27], v[26:27], v[126:127], v[106:107] op_sel:[0,0,0] op_sel_hi:[1,1,1]
    v_pk_fma_f32 v[28:29], v[28:29], v[128:129], v[108:109] op_sel:[0,0,0] op_sel_hi:[1,1,1]
    v_pk_fma_f32 v[30:31], v[30:31], v[130:131], v[110:111] op_sel:[0,0,0] op_sel_hi:[1,1,1]
    v_pk_fma_f32 v[32:33], v[32:33], v[132:133], v[112:113] op_sel:[0,0,0] op_sel_hi:[1,1,1]
    v_pk_fma_f32 v[34:35], v[34:35], v[134:135], v[114:115] op_sel:[0,0,0] op_sel_hi:[1,1,1]
    v_pk_fma_f32 v[36:37], v[36:37], v[136:137], v[116:117] op_sel:[0,0,0] op_sel_hi:[1,1,1]
    v_pk_fma_f32 v[38:39], v[38:39], v[138:139], v[118:119] op_sel:[0,0,0] op_sel_hi:[1,1,1]
    v_pk_fma_f32 v[40:41], v[40:41], v[140:141], v[120:121] op_sel:[0,0,0] op_sel_hi:[1,1,1]
    v_pk_fma_f32 v[42:43], v[42:43], v[142:143], v[122:123] op_sel:[0,0,0] op_sel_hi:[1,1,1]
    s_waitcnt vmcnt(21)
    s_nop 0
    ds_read_b64_tr_b16 v[104:105], v3 offset:0
    ds_read_b64_tr_b16 v[106:107], v3 offset:2048
    ds_read_b64_tr_b16 v[108:109], v7 offset:0
    ds_read_b64_tr_b16 v[110:111], v7 offset:2048
    ds_read_b64_tr_b16 v[112:113], v16 offset:0
    ds_read_b64_tr_b16 v[114:115], v16 offset:2048
    ds_read_b64_tr_b16 v[116:117], v17 offset:0
    ds_read_b64_tr_b16 v[118:119], v17 offset:2048
    ds_read_b128 v[120:123], v19 offset:4096
    s_waitcnt lgkmcnt(0)
    s_add_u32 m0, s73, 0
    s_add_u32 s44, s70, 81920
    buffer_load_dwordx4 v0, s[36:39], s44 offen offset:0 lds
    s_waitcnt vmcnt(5)
    s_add_u32 s44, s70, 91136
    buffer_load_dwordx4 v0, s[36:39], s44 offen offset:1024 lds
    s_waitcnt vmcnt(5)
    s_add_u32 s44, s70, 100352
    buffer_load_dwordx4 v0, s[36:39], s44 offen offset:2048 lds
    s_waitcnt vmcnt(5)
    s_add_u32 s44, s70, 109568
    buffer_load_dwordx4 v0, s[36:39], s44 offen offset:3072 lds
    s_waitcnt vmcnt(5)
    s_add_u32 m0, s73, 4096
    s_add_u32 s44, s67, 2048
    buffer_load_dwordx4 v9, s[28:31], s44 offen sc1 lds
    s_waitcnt vmcnt(5)
    s_nop 0
    ds_read_b64_tr_b16 v[124:125], v3 offset:5120
    ds_read_b64_tr_b16 v[126:127], v3 offset:7168
    ds_read_b64_tr_b16 v[128:129], v7 offset:5120
    ds_read_b64_tr_b16 v[130:131], v7 offset:7168
    ds_read_b64_tr_b16 v[132:133], v16 offset:5120
    ds_read_b64_tr_b16 v[134:135], v16 offset:7168
    ds_read_b64_tr_b16 v[136:137], v17 offset:5120
    ds_read_b64_tr_b16 v[138:139], v17 offset:7168
    ds_read_b128 v[140:143], v19 offset:9216
    s_waitcnt lgkmcnt(0)
    s_add_u32 m0, s73, 5120
    s_add_u32 s44, s70, 163840
    buffer_load_dwordx4 v0, s[36:39], s44 offen offset:0 lds
    s_waitcnt vmcnt(5)
    s_add_u32 s44, s70, 173056
    buffer_load_dwordx4 v0, s[36:39], s44 offen offset:1024 lds
    s_waitcnt vmcnt(5)
    s_add_u32 s44, s70, 182272
    buffer_load_dwordx4 v0, s[36:39], s44 offen offset:2048 lds
    s_waitcnt vmcnt(5)
    s_add_u32 s44, s70, 191488
    buffer_load_dwordx4 v0, s[36:39], s44 offen offset:3072 lds
    s_waitcnt vmcnt(5)
    s_add_u32 m0, s73, 9216
    s_add_u32 s44, s67, 4096
    buffer_load_dwordx4 v9, s[28:31], s44 offen sc1 lds
    s_waitcnt vmcnt(5)
    ds_read_b64_tr_b16 v[144:145], v3 offset:40960
    ds_read_b64_tr_b16 v[146:147], v3 offset:43008
    ds_read_b64_tr_b16 v[148:149], v7 offset:40960
    ds_read_b64_tr_b16 v[150:151], v7 offset:43008
    ds_read_b64_tr_b16 v[152:153], v16 offset:40960
    ds_read_b64_tr_b16 v[154:155], v16 offset:43008
    ds_read_b64_tr_b16 v[156:157], v17 offset:40960
    ds_read_b64_tr_b16 v[158:159], v17 offset:43008
    ds_read_b128 v[160:163], v19 offset:45056
    s_waitcnt lgkmcnt(0)
    s_add_u32 m0, s73, 40960
    s_add_u32 s44, s70, 245760
    buffer_load_dwordx4 v0, s[36:39], s44 offen offset:0 lds
    s_waitcnt vmcnt(5)
    s_add_u32 s44, s70, 254976
    buffer_load_dwordx4 v0, s[36:39], s44 offen offset:1024 lds
    s_waitcnt vmcnt(5)
    s_add_u32 s44, s70, 264192
    buffer_load_dwordx4 v0, s[36:39], s44 offen offset:2048 lds
    s_waitcnt vmcnt(5)
    s_add_u32 s44, s70, 273408
    buffer_load_dwordx4 v0, s[36:39], s44 offen offset:3072 lds
    s_waitcnt vmcnt(5)
    s_add_u32 m0, s73, 45056
    s_add_u32 s44, s67, 6144
    buffer_load_dwordx4 v9, s[28:31], s44 offen sc1 lds
    s_waitcnt vmcnt(5)
    ds_read_b64_tr_b16 v[164:165], v3 offset:46080
    ds_read_b64_tr_b16 v[166:167], v3 offset:48128
    ds_read_b64_tr_b16 v[168:169], v7 offset:46080
    ds_read_b64_tr_b16 v[170:171], v7 offset:48128
    ds_read_b64_tr_b16 v[172:173], v16 offset:46080
    ds_read_b64_tr_b16 v[174:175], v16 offset:48128
    ds_read_b64_tr_b16 v[176:177], v17 offset:46080
    ds_read_b64_tr_b16 v[178:179], v17 offset:48128
    ds_read_b128 v[180:183], v19 offset:50176
    s_waitcnt lgkmcnt(0)
    s_add_u32 m0, s73, 46080
    s_add_u32 s44, s70, 327680
    buffer_load_dwordx4 v0, s[36:39], s44 offen offset:0 lds
    s_waitcnt vmcnt(5)
    s_add_u32 s44, s70, 336896
    buffer_load_dwordx4 v0, s[36:39], s44 offen offset:1024 lds
    s_waitcnt vmcnt(5)
    s_add_u32 s44, s70, 346112
    buffer_load_dwordx4 v0, s[36:39], s44 offen offset:2048 lds
    s_waitcnt vmcnt(5)
    s_add_u32 s44, s70, 355328
    buffer_load_dwordx4 v0, s[36:39], s44 offen offset:3072 lds
    s_waitcnt vmcnt(5)
    s_add_u32 m0, s73, 50176
    s_add_u32 s44, s67, 8192
    buffer_load_dwordx4 v9, s[28:31], s44 offen sc1 lds
    s_waitcnt vmcnt(5)
    v_add_u32 v3, 0x14000, v3
    v_add_u32 v7, 0x14000, v7
    v_add_u32 v16, 0x14000, v16
    v_add_u32 v17, 0x14000, v17
    v_add_u32 v19, 0x14000, v19
    ds_read_b64_tr_b16 v[184:185], v3 offset:0
    ds_read_b64_tr_b16 v[186:187], v3 offset:2048
    ds_read_b64_tr_b16 v[188:189], v7 offset:0
    ds_read_b64_tr_b16 v[190:191], v7 offset:2048
    ds_read_b64_tr_b16 v[192:193], v16 offset:0
    ds_read_b64_tr_b16 v[194:195], v16 offset:2048
    ds_read_b64_tr_b16 v[196:197], v17 offset:0
    ds_read_b64_tr_b16 v[198:199], v17 offset:2048
    ds_read_b128 v[200:203], v19 offset:4096
    s_waitcnt lgkmcnt(0)
    s_add_u32 m0, s73, 81920
    s_add_u32 s44, s70, 368640
    buffer_load_dwordx4 v0, s[36:39], s44 offen offset:0 lds
    s_waitcnt vmcnt(5)
    s_add_u32 s44, s70, 377856
    buffer_load_dwordx4 v0, s[36:39], s44 offen offset:1024 lds
    s_waitcnt vmcnt(5)
    s_add_u32 s44, s70, 387072
    buffer_load_dwordx4 v0, s[36:39], s44 offen offset:2048 lds
    s_waitcnt vmcnt(5)
    s_add_u32 s44, s70, 396288
    buffer_load_dwordx4 v0, s[36:39], s44 offen offset:3072 lds
    s_waitcnt vmcnt(5)
    s_add_u32 m0, s73, 86016
    s_add_u32 s44, s67, 9216
    buffer_load_dwordx4 v9, s[28:31], s44 offen sc1 lds
    s_waitcnt vmcnt(5)
parallel_sum__ssm_conv_s5__geglu_ffn__prompt_kernel_p2:
    s_setprio 1
    s_add_u32 s44, s22, 0
    s_and_b32 s44, s44, 3
    s_lshl_b32 s44, s44, 10
    v_add_u32 v12, s44, v9
    s_add_u32 s44, s22, 1
    s_and_b32 s44, s44, 3
    s_lshl_b32 s44, s44, 10
    v_add_u32 v13, s44, v9
    s_add_u32 s44, s22, 2
    s_and_b32 s44, s44, 3
    s_lshl_b32 s44, s44, 10
    v_add_u32 v14, s44, v9
    s_add_u32 s44, s22, 3
    s_and_b32 s44, s44, 3
    s_lshl_b32 s44, s44, 10
    v_add_u32 v15, s44, v9
    v_and_b32 v23, 15, v2
    v_and_b32 v6, 1, v5
    v_mul_u32_u24 v6, s83, v6
    v_min_u32 v8, 11, v23
    v_lshl_add_u32 v1, v8, 7, v6
    v_min_u32 v8, 5, v23
    v_lshl_add_u32 v4, v8, 7, v6
    s_add_u32 s44, s73, 0
    v_add_u32 v11, s44, v9
    v_bfe_u32 v8, v2, 1, 3
    v_xor_b32_e64 v8, v5, v8
    v_lshl_add_u32 v8, v8, 4, s44
    v_lshl_add_u32 v20, v23, 7, v8
    v_xor_b32 v21, 64, v20
    s_cmp_eq_u32 s16, 0
    s_cselect_b64 s[32:33], s[74:75], s[76:77]
    s_cselect_b64 s[40:41], s[76:77], s[74:75]
    s_mov_b32 s34, 819200
    s_mov_b32 s35, 0x00020000
    s_mov_b32 s42, 819200
    s_mov_b32 s43, 0x00020000
    s_mov_b32 s24, s90
    s_mov_b32 s25, s91
    s_mov_b32 s26, 0x500000
    s_mov_b32 s27, 0x00020000
    s_lshl_b32 s44, s8, 6
    s_lshl_b32 s45, s22, 4
    s_add_u32 s44, s44, s45
    v_add_u32 v8, s44, v23
    s_lshl_b32 s45, s9, 6
    s_lshl_b32 s87, s87, 2
    v_lshl_add_u32 v6, v5, 2, s45
    v_mul_u32_u24 v8, 640, v8
    v_add_lshl_u32 v10, v8, v6, 2
    v_add_u32 v6, 81920, v20
    v_add_u32 v8, 81920, v21
    buffer_load_dword v22, v1, s[28:31], s78 offen sc1
    s_waitcnt vmcnt(0)
    s_mov_b32 s5, 0
parallel_sum__ssm_conv_s5__geglu_ffn__prompt_kernel_g0_29:
    v_cmp_ne_u32 vcc, s4, v22
    s_add_u32 s5, s5, 1
    s_nop 3
    s_cbranch_vccz parallel_sum__ssm_conv_s5__geglu_ffn__prompt_kernel_g0o_30
    s_cmp_ge_u32 s5, 0x20000
    s_cbranch_scc1 parallel_sum__ssm_conv_s5__geglu_ffn__prompt_kernel_g0o_30
    s_sleep 3
    buffer_load_dword v22, v1, s[28:31], s78 offen sc1
    s_waitcnt vmcnt(0)
    s_branch parallel_sum__ssm_conv_s5__geglu_ffn__prompt_kernel_g0_29
parallel_sum__ssm_conv_s5__geglu_ffn__prompt_kernel_g0o_30:
    s_add_u32 s45, s84, 0
    buffer_load_dwordx4 v[204:207], v12, s[28:31], s45 offen sc1
    buffer_load_dwordx4 v[208:211], v13, s[28:31], s45 offen sc1
    buffer_load_dwordx4 v[212:215], v14, s[28:31], s45 offen sc1
    buffer_load_dwordx4 v[216:219], v15, s[28:31], s45 offen sc1
    s_add_u32 s45, s84, 4096
    buffer_load_dwordx4 v[220:223], v12, s[28:31], s45 offen sc1
    buffer_load_dwordx4 v[224:227], v13, s[28:31], s45 offen sc1
    buffer_load_dwordx4 v[228:231], v14, s[28:31], s45 offen sc1
    buffer_load_dwordx4 v[232:235], v15, s[28:31], s45 offen sc1
    s_add_u32 s45, s84, 8192
    buffer_load_dwordx4 v[236:239], v12, s[28:31], s45 offen sc1
    buffer_load_dwordx4 v[240:243], v13, s[28:31], s45 offen sc1
    buffer_load_dwordx4 v[244:247], v14, s[28:31], s45 offen sc1
    buffer_load_dwordx4 v[248:251], v15, s[28:31], s45 offen sc1
    s_cmp_eq_u32 s20, 0
    s_cbranch_scc1 parallel_sum__ssm_conv_s5__geglu_ffn__prompt_kernel_nh_31
    s_barrier
parallel_sum__ssm_conv_s5__geglu_ffn__prompt_kernel_nh_31:
    s_waitcnt vmcnt(8)
    v_mfma_f32_16x16x32_bf16 v[24:27], v[104:107], v[204:207], v[24:27]
    v_mfma_f32_16x16x32_bf16 v[28:31], v[108:111], v[204:207], v[28:31]
    v_mfma_f32_16x16x32_bf16 v[32:35], v[112:115], v[204:207], v[32:35]
    v_mfma_f32_16x16x32_bf16 v[36:39], v[116:119], v[204:207], v[36:39]
    v_mfma_f32_16x16x32_bf16 v[40:43], v[120:123], v[204:207], v[40:43]
    v_mfma_f32_16x16x32_bf16 v[44:47], v[104:107], v[208:211], 0
    v_mfma_f32_16x16x32_bf16 v[48:51], v[108:111], v[208:211], 0
    v_mfma_f32_16x16x32_bf16 v[52:55], v[112:115], v[208:211], 0
    v_mfma_f32_16x16x32_bf16 v[56:59], v[116:119], v[208:211], 0
    v_mfma_f32_16x16x32_bf16 v[60:63], v[120:123], v[208:211], 0
    v_mfma_f32_16x16x32_bf16 v[64:67], v[104:107], v[212:215], 0
    v_mfma_f32_16x16x32_bf16 v[68:71], v[108:111], v[212:215], 0
    v_mfma_f32_16x16x32_bf16 v[72:75], v[112:115], v[212:215], 0
    v_mfma_f32_16x16x32_bf16 v[76:79], v[116:119], v[212:215], 0
    v_mfma_f32_16x16x32_bf16 v[80:83], v[120:123], v[212:215], 0
    v_mfma_f32_16x16x32_bf16 v[84:87], v[104:107], v[216:219], 0
    v_mfma_f32_16x16x32_bf16 v[88:91], v[108:111], v[216:219], 0
    v_mfma_f32_16x16x32_bf16 v[92:95], v[112:115], v[216:219], 0
    v_mfma_f32_16x16x32_bf16 v[96:99], v[116:119], v[216:219], 0
    v_mfma_f32_16x16x32_bf16 v[100:103], v[120:123], v[216:219], 0
    s_waitcnt vmcnt(4)
    v_mfma_f32_16x16x32_bf16 v[24:27], v[124:127], v[220:223], v[24:27]
    s_add_u32 s45, s84, 12288
    buffer_load_dwordx4 v[204:207], v12, s[28:31], s45 offen sc1
    v_mfma_f32_16x16x32_bf16 v[28:31], v[128:131], v[220:223], v[28:31]
    v_mfma_f32_16x16x32_bf16 v[32:35], v[132:135], v[220:223], v[32:35]
    v_mfma_f32_16x16x32_bf16 v[36:39], v[136:139], v[220:223], v[36:39]
    v_add_u32 v3, 0xfffec000, v3
    v_mfma_f32_16x16x32_bf16 v[40:43], v[140:143], v[220:223], v[40:43]
    v_add_u32 v7, 0xfffec000, v7
    v_mfma_f32_16x16x32_bf16 v[44:47], v[124:127], v[224:227], v[44:47]
    buffer_load_dwordx4 v[208:211], v13, s[28:31], s45 offen sc1
    v_add_u32 v16, 0xfffec000, v16
    v_mfma_f32_16x16x32_bf16 v[48:51], v[128:131], v[224:227], v[48:51]
    v_add_u32 v17, 0xfffec000, v17
    v_mfma_f32_16x16x32_bf16 v[52:55], v[132:135], v[224:227], v[52:55]
    v_add_u32 v19, 0xfffec000, v19
    v_mfma_f32_16x16x32_bf16 v[56:59], v[136:139], v[224:227], v[56:59]
    ds_read_b64_tr_b16 v[104:105], v3 offset:0
    v_mfma_f32_16x16x32_bf16 v[60:63], v[140:143], v[224:227], v[60:63]
    ds_read_b64_tr_b16 v[106:107], v3 offset:2048
    v_mfma_f32_16x16x32_bf16 v[64:67], v[124:127], v[228:231], v[64:67]
    buffer_load_dwordx4 v[212:215], v14, s[28:31], s45 offen sc1
    ds_read_b64_tr_b16 v[108:109], v7 offset:0
    v_mfma_f32_16x16x32_bf16 v[68:71], v[128:131], v[228:231], v[68:71]
    ds_read_b64_tr_b16 v[110:111], v7 offset:2048
    v_mfma_f32_16x16x32_bf16 v[72:75], v[132:135], v[228:231], v[72:75]
    ds_read_b64_tr_b16 v[112:113], v16 offset:0
    v_mfma_f32_16x16x32_bf16 v[76:79], v[136:139], v[228:231], v[76:79]
    ds_read_b64_tr_b16 v[114:115], v16 offset:2048
    v_mfma_f32_16x16x32_bf16 v[80:83], v[140:143], v[228:231], v[80:83]
    ds_read_b64_tr_b16 v[116:117], v17 offset:0
    v_mfma_f32_16x16x32_bf16 v[84:87], v[124:127], v[232:235], v[84:87]
    buffer_load_dwordx4 v[216:219], v15, s[28:31], s45 offen sc1
    ds_read_b64_tr_b16 v[118:119], v17 offset:2048
    v_mfma_f32_16x16x32_bf16 v[88:91], v[128:131], v[232:235], v[88:91]
    ds_read_b128 v[120:123], v19 offset:4096
    v_mfma_f32_16x16x32_bf16 v[92:95], v[132:135], v[232:235], v[92:95]
    v_mfma_f32_16x16x32_bf16 v[96:99], v[136:139], v[232:235], v[96:99]
    v_mfma_f32_16x16x32_bf16 v[100:103], v[140:143], v[232:235], v[100:103]
    s_waitcnt vmcnt(4)
    s_waitcnt lgkmcnt(0)
    v_mfma_f32_16x16x32_bf16 v[24:27], v[104:107], v[236:239], v[24:27]
    s_add_u32 s45, s84, 16384
    buffer_load_dwordx4 v[124:127], v12, s[28:31], s45 offen sc1
    v_mfma_f32_16x16x32_bf16 v[28:31], v[108:111], v[236:239], v[28:31]
    v_mfma_f32_16x16x32_bf16 v[32:35], v[112:115], v[236:239], v[32:35]
    v_mfma_f32_16x16x32_bf16 v[36:39], v[116:119], v[236:239], v[36:39]
    buffer_load_dwordx4 v[128:131], v13, s[28:31], s45 offen sc1
    v_mfma_f32_16x16x32_bf16 v[40:43], v[120:123], v[236:239], v[40:43]
    v_mfma_f32_16x16x32_bf16 v[44:47], v[104:107], v[240:243], v[44:47]
    buffer_load_dwordx4 v[132:135], v14, s[28:31], s45 offen sc1
    v_mfma_f32_16x16x32_bf16 v[48:51], v[108:111], v[240:243], v[48:51]
    v_mfma_f32_16x16x32_bf16 v[52:55], v[112:115], v[240:243], v[52:55]
    v_mfma_f32_16x16x32_bf16 v[56:59], v[116:119], v[240:243], v[56:59]
    buffer_load_dwordx4 v[136:139], v15, s[28:31], s45 offen sc1
    v_mfma_f32_16x16x32_bf16 v[60:63], v[120:123], v[240:243], v[60:63]
    v_mfma_f32_16x16x32_bf16 v[64:67], v[104:107], v[244:247], v[64:67]
    s_add_u32 s45, s84, 20480
    buffer_load_dwordx4 v[140:143], v12, s[28:31], s45 offen sc1
    v_mfma_f32_16x16x32_bf16 v[68:71], v[108:111], v[244:247], v[68:71]
    v_mfma_f32_16x16x32_bf16 v[72:75], v[112:115], v[244:247], v[72:75]
    buffer_load_dwordx4 v[220:223], v13, s[28:31], s45 offen sc1
    v_mfma_f32_16x16x32_bf16 v[76:79], v[116:119], v[244:247], v[76:79]
    v_mfma_f32_16x16x32_bf16 v[80:83], v[120:123], v[244:247], v[80:83]
    v_mfma_f32_16x16x32_bf16 v[84:87], v[104:107], v[248:251], v[84:87]
    buffer_load_dwordx4 v[224:227], v14, s[28:31], s45 offen sc1
    v_mfma_f32_16x16x32_bf16 v[88:91], v[108:111], v[248:251], v[88:91]
    v_mfma_f32_16x16x32_bf16 v[92:95], v[112:115], v[248:251], v[92:95]
    buffer_load_dwordx4 v[228:231], v15, s[28:31], s45 offen sc1
    v_mfma_f32_16x16x32_bf16 v[96:99], v[116:119], v[248:251], v[96:99]
    v_mfma_f32_16x16x32_bf16 v[100:103], v[120:123], v[248:251], v[100:103]
    s_waitcnt vmcnt(8)
    v_mfma_f32_16x16x32_bf16 v[24:27], v[144:147], v[204:207], v[24:27]
    s_add_u32 s45, s84, 24576
    buffer_load_dwordx4 v[120:123], v12, s[28:31], s45 offen sc1
    v_mfma_f32_16x16x32_bf16 v[28:31], v[148:151], v[204:207], v[28:31]
    v_mfma_f32_16x16x32_bf16 v[32:35], v[152:155], v[204:207], v[32:35]
    v_mfma_f32_16x16x32_bf16 v[36:39], v[156:159], v[204:207], v[36:39]
    ds_read_b64_tr_b16 v[232:233], v3 offset:5120
    v_mfma_f32_16x16x32_bf16 v[40:43], v[160:163], v[204:207], v[40:43]
    ds_read_b64_tr_b16 v[234:235], v3 offset:7168
    v_mfma_f32_16x16x32_bf16 v[44:47], v[144:147], v[208:211], v[44:47]
    buffer_load_dwordx4 v[236:239], v13, s[28:31], s45 offen sc1
    ds_read_b64_tr_b16 v[104:105], v7 offset:5120
    v_mfma_f32_16x16x32_bf16 v[48:51], v[148:151], v[208:211], v[48:51]
    ds_read_b64_tr_b16 v[106:107], v7 offset:7168
    v_mfma_f32_16x16x32_bf16 v[52:55], v[152:155], v[208:211], v[52:55]
    ds_read_b64_tr_b16 v[108:109], v16 offset:5120
    v_mfma_f32_16x16x32_bf16 v[56:59], v[156:159], v[208:211], v[56:59]
    ds_read_b64_tr_b16 v[110:111], v16 offset:7168
    v_mfma_f32_16x16x32_bf16 v[60:63], v[160:163], v[208:211], v[60:63]
    ds_read_b64_tr_b16 v[112:113], v17 offset:5120
    v_mfma_f32_16x16x32_bf16 v[64:67], v[144:147], v[212:215], v[64:67]
    buffer_load_dwordx4 v[240:243], v14, s[28:31], s45 offen sc1
    ds_read_b64_tr_b16 v[114:115], v17 offset:7168
    v_mfma_f32_16x16x32_bf16 v[68:71], v[148:151], v[212:215], v[68:71]
    ds_read_b128 v[116:119], v19 offset:9216
    v_mfma_f32_16x16x32_bf16 v[72:75], v[152:155], v[212:215], v[72:75]
    v_mfma_f32_16x16x32_bf16 v[76:79], v[156:159], v[212:215], v[76:79]
    v_mfma_f32_16x16x32_bf16 v[80:83], v[160:163], v[212:215], v[80:83]
    v_mfma_f32_16x16x32_bf16 v[84:87], v[144:147], v[216:219], v[84:87]
    buffer_load_dwordx4 v[244:247], v15, s[28:31], s45 offen sc1
    v_mfma_f32_16x16x32_bf16 v[88:91], v[148:151], v[216:219], v[88:91]
    v_mfma_f32_16x16x32_bf16 v[92:95], v[152:155], v[216:219], v[92:95]
    v_mfma_f32_16x16x32_bf16 v[96:99], v[156:159], v[216:219], v[96:99]
    v_mfma_f32_16x16x32_bf16 v[100:103], v[160:163], v[216:219], v[100:103]
    s_waitcnt vmcnt(8)
    s_waitcnt lgkmcnt(0)
    v_mfma_f32_16x16x32_bf16 v[24:27], v[232:235], v[124:127], v[24:27]
    s_add_u32 s45, s84, 28672
    buffer_load_dwordx4 v[248:251], v12, s[28:31], s45 offen sc1
    v_mfma_f32_16x16x32_bf16 v[28:31], v[104:107], v[124:127], v[28:31]
    v_mfma_f32_16x16x32_bf16 v[32:35], v[108:111], v[124:127], v[32:35]
    v_mfma_f32_16x16x32_bf16 v[36:39], v[112:115], v[124:127], v[36:39]
    buffer_load_dwordx4 v[144:147], v13, s[28:31], s45 offen sc1
    v_mfma_f32_16x16x32_bf16 v[40:43], v[116:119], v[124:127], v[40:43]
    v_mfma_f32_16x16x32_bf16 v[44:47], v[232:235], v[128:131], v[44:47]
    buffer_load_dwordx4 v[148:151], v14, s[28:31], s45 offen sc1
    v_mfma_f32_16x16x32_bf16 v[48:51], v[104:107], v[128:131], v[48:51]
    v_mfma_f32_16x16x32_bf16 v[52:55], v[108:111], v[128:131], v[52:55]
    v_mfma_f32_16x16x32_bf16 v[56:59], v[112:115], v[128:131], v[56:59]
    buffer_load_dwordx4 v[152:155], v15, s[28:31], s45 offen sc1
    v_mfma_f32_16x16x32_bf16 v[60:63], v[116:119], v[128:131], v[60:63]
    v_mfma_f32_16x16x32_bf16 v[64:67], v[232:235], v[132:135], v[64:67]
    s_add_u32 s45, s84, 32768
    buffer_load_dwordx4 v[156:159], v12, s[28:31], s45 offen sc1
    v_mfma_f32_16x16x32_bf16 v[68:71], v[104:107], v[132:135], v[68:71]
    v_mfma_f32_16x16x32_bf16 v[72:75], v[108:111], v[132:135], v[72:75]
    buffer_load_dwordx4 v[160:163], v13, s[28:31], s45 offen sc1
    v_mfma_f32_16x16x32_bf16 v[76:79], v[112:115], v[132:135], v[76:79]
    v_mfma_f32_16x16x32_bf16 v[80:83], v[116:119], v[132:135], v[80:83]
    v_mfma_f32_16x16x32_bf16 v[84:87], v[232:235], v[136:139], v[84:87]
    buffer_load_dwordx4 v[204:207], v14, s[28:31], s45 offen sc1
    v_mfma_f32_16x16x32_bf16 v[88:91], v[104:107], v[136:139], v[88:91]
    v_mfma_f32_16x16x32_bf16 v[92:95], v[108:111], v[136:139], v[92:95]
    buffer_load_dwordx4 v[208:211], v15, s[28:31], s45 offen sc1
    v_mfma_f32_16x16x32_bf16 v[96:99], v[112:115], v[136:139], v[96:99]
    v_mfma_f32_16x16x32_bf16 v[100:103], v[116:119], v[136:139], v[100:103]
    s_waitcnt vmcnt(12)
    v_mfma_f32_16x16x32_bf16 v[24:27], v[164:167], v[140:143], v[24:27]
    buffer_load_dword v22, v4, s[28:31], s79 offen sc1
    v_mfma_f32_16x16x32_bf16 v[28:31], v[168:171], v[140:143], v[28:31]
    v_mfma_f32_16x16x32_bf16 v[32:35], v[172:175], v[140:143], v[32:35]
    v_mfma_f32_16x16x32_bf16 v[36:39], v[176:179], v[140:143], v[36:39]
    s_add_u32 s45, s84, 36864
    buffer_load_dwordx4 v[112:115], v12, s[28:31], s45 offen sc1
    ds_read_b64_tr_b16 v[212:213], v3 offset:40960
    v_mfma_f32_16x16x32_bf16 v[40:43], v[180:183], v[140:143], v[40:43]
    ds_read_b64_tr_b16 v[214:215], v3 offset:43008
    v_mfma_f32_16x16x32_bf16 v[44:47], v[164:167], v[220:223], v[44:47]
    buffer_load_dwordx4 v[116:119], v13, s[28:31], s45 offen sc1
    ds_read_b64_tr_b16 v[216:217], v7 offset:40960
    v_mfma_f32_16x16x32_bf16 v[48:51], v[168:171], v[220:223], v[48:51]
    ds_read_b64_tr_b16 v[218:219], v7 offset:43008
    v_mfma_f32_16x16x32_bf16 v[52:55], v[172:175], v[220:223], v[52:55]
    ds_read_b64_tr_b16 v[232:233], v16 offset:40960
    v_mfma_f32_16x16x32_bf16 v[56:59], v[176:179], v[220:223], v[56:59]
    buffer_load_dwordx4 v[124:127], v14, s[28:31], s45 offen sc1
    ds_read_b64_tr_b16 v[234:235], v16 offset:43008
    v_mfma_f32_16x16x32_bf16 v[60:63], v[180:183], v[220:223], v[60:63]
    ds_read_b64_tr_b16 v[104:105], v17 offset:40960
    v_mfma_f32_16x16x32_bf16 v[64:67], v[164:167], v[224:227], v[64:67]
    buffer_load_dwordx4 v[128:131], v15, s[28:31], s45 offen sc1
    ds_read_b64_tr_b16 v[106:107], v17 offset:43008
    v_mfma_f32_16x16x32_bf16 v[68:71], v[168:171], v[224:227], v[68:71]
    ds_read_b128 v[108:111], v19 offset:45056
    v_mfma_f32_16x16x32_bf16 v[72:75], v[172:175], v[224:227], v[72:75]
    s_add_u32 m0, s73, 0
    s_add_u32 s44, s86, 0
    buffer_load_dwordx4 v254, s[32:35], s44 offen offset:0 lds
    v_mfma_f32_16x16x32_bf16 v[76:79], v[176:179], v[224:227], v[76:79]
    v_mfma_f32_16x16x32_bf16 v[80:83], v[180:183], v[224:227], v[80:83]
    v_mfma_f32_16x16x32_bf16 v[84:87], v[164:167], v[228:231], v[84:87]
    s_add_u32 s44, s44, 9216
    buffer_load_dwordx4 v255, s[32:35], s44 offen offset:1024 lds
    v_mfma_f32_16x16x32_bf16 v[88:91], v[168:171], v[228:231], v[88:91]
    v_mfma_f32_16x16x32_bf16 v[92:95], v[172:175], v[228:231], v[92:95]
    s_add_u32 s44, s44, 9216
    buffer_load_dwordx4 v254, s[32:35], s44 offen offset:2048 lds
    v_mfma_f32_16x16x32_bf16 v[96:99], v[176:179], v[228:231], v[96:99]
    v_mfma_f32_16x16x32_bf16 v[100:103], v[180:183], v[228:231], v[100:103]
    s_waitcnt vmcnt(7)
    v_cmp_ne_u32 vcc, s4, v22
    s_nop 4
    s_cbranch_vccnz parallel_sum__ssm_conv_s5__geglu_ffn__prompt_kernel_late_32
    s_waitcnt lgkmcnt(0)
    v_mfma_f32_16x16x32_bf16 v[24:27], v[212:215], v[120:123], v[24:27]
    s_add_u32 s44, s44, 9216
    buffer_load_dwordx4 v255, s[32:35], s44 offen offset:3072 lds
    v_mfma_f32_16x16x32_bf16 v[28:31], v[216:219], v[120:123], v[28:31]
    v_mfma_f32_16x16x32_bf16 v[32:35], v[232:235], v[120:123], v[32:35]
    v_mfma_f32_16x16x32_bf16 v[36:39], v[104:107], v[120:123], v[36:39]
    s_add_u32 m0, m0, 4096
    s_add_u32 s44, s44, 13312
    buffer_load_dwordx4 v254, s[32:35], s44 offen offset:0 lds
    ds_read_b64_tr_b16 v[132:133], v3 offset:46080
    v_mfma_f32_16x16x32_bf16 v[40:43], v[108:111], v[120:123], v[40:43]
    ds_read_b64_tr_b16 v[134:135], v3 offset:48128
    v_mfma_f32_16x16x32_bf16 v[44:47], v[212:215], v[236:239], v[44:47]
    s_add_u32 s44, s44, 9216
    buffer_load_dwordx4 v255, s[32:35], s44 offen offset:1024 lds
    ds_read_b64_tr_b16 v[136:137], v7 offset:46080
    v_mfma_f32_16x16x32_bf16 v[48:51], v[216:219], v[236:239], v[48:51]
    ds_read_b64_tr_b16 v[138:139], v7 offset:48128
    v_mfma_f32_16x16x32_bf16 v[52:55], v[232:235], v[236:239], v[52:55]
    ds_read_b64_tr_b16 v[164:165], v16 offset:46080
    v_mfma_f32_16x16x32_bf16 v[56:59], v[104:107], v[236:239], v[56:59]
    s_add_u32 s44, s44, 9216
    buffer_load_dwordx4 v254, s[32:35], s44 offen offset:2048 lds
    ds_read_b64_tr_b16 v[166:167], v16 offset:48128
    v_mfma_f32_16x16x32_bf16 v[60:63], v[108:111], v[236:239], v[60:63]
    ds_read_b64_tr_b16 v[168:169], v17 offset:46080
    v_mfma_f32_16x16x32_bf16 v[64:67], v[212:215], v[240:243], v[64:67]
    s_add_u32 s44, s44, 9216
    buffer_load_dwordx4 v255, s[32:35], s44 offen offset:3072 lds
    ds_read_b64_tr_b16 v[170:171], v17 offset:48128
    v_mfma_f32_16x16x32_bf16 v[68:71], v[216:219], v[240:243], v[68:71]
    ds_read_b128 v[172:175], v19 offset:50176
    v_mfma_f32_16x16x32_bf16 v[72:75], v[232:235], v[240:243], v[72:75]
    s_add_u32 m0, m0, 4096
    s_add_u32 s44, s44, s69
    buffer_load_dwordx4 v254, s[32:35], s44 offen offset:0 lds
    v_mfma_f32_16x16x32_bf16 v[76:79], v[104:107], v[240:243], v[76:79]
    v_mfma_f32_16x16x32_bf16 v[80:83], v[108:111], v[240:243], v[80:83]
    v_mfma_f32_16x16x32_bf16 v[84:87], v[212:215], v[244:247], v[84:87]
    s_add_u32 s44, s44, 9216
    buffer_load_dwordx4 v255, s[32:35], s44 offen offset:1024 lds
    v_mfma_f32_16x16x32_bf16 v[88:91], v[216:219], v[244:247], v[88:91]
    v_mfma_f32_16x16x32_bf16 v[92:95], v[232:235], v[244:247], v[92:95]
    s_add_u32 m0, s73, 40960
    s_add_u32 s44, s70, 450560
    buffer_load_dwordx4 v0, s[36:39], s44 offen offset:0 lds
    v_mfma_f32_16x16x32_bf16 v[96:99], v[104:107], v[244:247], v[96:99]
    v_mfma_f32_16x16x32_bf16 v[100:103], v[108:111], v[244:247], v[100:103]
    s_waitcnt lgkmcnt(0)
    v_mfma_f32_16x16x32_bf16 v[24:27], v[184:187], v[248:251], v[24:27]
    s_add_u32 s44, s70, 459776
    buffer_load_dwordx4 v0, s[36:39], s44 offen offset:1024 lds
    v_mfma_f32_16x16x32_bf16 v[28:31], v[188:191], v[248:251], v[28:31]
    v_mfma_f32_16x16x32_bf16 v[32:35], v[192:195], v[248:251], v[32:35]
    v_mfma_f32_16x16x32_bf16 v[36:39], v[196:199], v[248:251], v[36:39]
    s_add_u32 s44, s70, 468992
    buffer_load_dwordx4 v0, s[36:39], s44 offen offset:2048 lds
    v_add_u32 v3, 0x14000, v3
    v_mfma_f32_16x16x32_bf16 v[40:43], v[200:203], v[248:251], v[40:43]
    v_add_u32 v7, 0x14000, v7
    v_mfma_f32_16x16x32_bf16 v[44:47], v[184:187], v[144:147], v[44:47]
    s_add_u32 s44, s70, 478208
    buffer_load_dwordx4 v0, s[36:39], s44 offen offset:3072 lds
    v_add_u32 v16, 0x14000, v16
    v_mfma_f32_16x16x32_bf16 v[48:51], v[188:191], v[144:147], v[48:51]
    v_add_u32 v17, 0x14000, v17
    v_mfma_f32_16x16x32_bf16 v[52:55], v[192:195], v[144:147], v[52:55]
    v_add_u32 v19, 0x14000, v19
    v_mfma_f32_16x16x32_bf16 v[56:59], v[196:199], v[144:147], v[56:59]
    s_add_u32 m0, s73, 45056
    s_add_u32 s44, s67, 11264
    buffer_load_dwordx4 v9, s[28:31], s44 offen sc1 lds
    ds_read_b64_tr_b16 v[224:225], v3 offset:0
    v_mfma_f32_16x16x32_bf16 v[60:63], v[200:203], v[144:147], v[60:63]
    ds_read_b64_tr_b16 v[226:227], v3 offset:2048
    v_mfma_f32_16x16x32_bf16 v[64:67], v[184:187], v[148:151], v[64:67]
    s_add_u32 s45, s84, 40960
    buffer_load_dwordx4 v[176:179], v12, s[28:31], s45 offen sc1
    ds_read_b64_tr_b16 v[228:229], v7 offset:0
    v_mfma_f32_16x16x32_bf16 v[68:71], v[188:191], v[148:151], v[68:71]
    ds_read_b64_tr_b16 v[230:231], v7 offset:2048
    v_mfma_f32_16x16x32_bf16 v[72:75], v[192:195], v[148:151], v[72:75]
    buffer_load_dwordx4 v[180:183], v13, s[28:31], s45 offen sc1
    ds_read_b64_tr_b16 v[212:213], v16 offset:0
    v_mfma_f32_16x16x32_bf16 v[76:79], v[196:199], v[148:151], v[76:79]
    ds_read_b64_tr_b16 v[214:215], v16 offset:2048
    v_mfma_f32_16x16x32_bf16 v[80:83], v[200:203], v[148:151], v[80:83]
    ds_read_b64_tr_b16 v[216:217], v17 offset:0
    v_mfma_f32_16x16x32_bf16 v[84:87], v[184:187], v[152:155], v[84:87]
    buffer_load_dwordx4 v[140:143], v14, s[28:31], s45 offen sc1
    ds_read_b64_tr_b16 v[218:219], v17 offset:2048
    v_mfma_f32_16x16x32_bf16 v[88:91], v[188:191], v[152:155], v[88:91]
    ds_read_b128 v[232:235], v19 offset:4096
    v_mfma_f32_16x16x32_bf16 v[92:95], v[192:195], v[152:155], v[92:95]
    buffer_load_dwordx4 v[220:223], v15, s[28:31], s45 offen sc1
    v_mfma_f32_16x16x32_bf16 v[96:99], v[196:199], v[152:155], v[96:99]
    v_mfma_f32_16x16x32_bf16 v[100:103], v[200:203], v[152:155], v[100:103]
    s_waitcnt lgkmcnt(0)
    v_mfma_f32_16x16x32_bf16 v[24:27], v[132:135], v[156:159], v[24:27]
    s_add_u32 s45, s84, 45056
    buffer_load_dwordx4 v[104:107], v12, s[28:31], s45 offen sc1
    v_mfma_f32_16x16x32_bf16 v[28:31], v[136:139], v[156:159], v[28:31]
    v_mfma_f32_16x16x32_bf16 v[32:35], v[164:167], v[156:159], v[32:35]
    v_mfma_f32_16x16x32_bf16 v[36:39], v[168:171], v[156:159], v[36:39]
    buffer_load_dwordx4 v[108:111], v13, s[28:31], s45 offen sc1
    ds_read_b64_tr_b16 v[240:241], v3 offset:5120
    v_mfma_f32_16x16x32_bf16 v[40:43], v[172:175], v[156:159], v[40:43]
    ds_read_b64_tr_b16 v[242:243], v3 offset:7168
    v_mfma_f32_16x16x32_bf16 v[44:47], v[132:135], v[160:163], v[44:47]
    buffer_load_dwordx4 v[120:123], v14, s[28:31], s45 offen sc1
    ds_read_b64_tr_b16 v[244:245], v7 offset:5120
    v_mfma_f32_16x16x32_bf16 v[48:51], v[136:139], v[160:163], v[48:51]
    ds_read_b64_tr_b16 v[246:247], v7 offset:7168
    v_mfma_f32_16x16x32_bf16 v[52:55], v[164:167], v[160:163], v[52:55]
    ds_read_b64_tr_b16 v[184:185], v16 offset:5120
    v_mfma_f32_16x16x32_bf16 v[56:59], v[168:171], v[160:163], v[56:59]
    buffer_load_dwordx4 v[236:239], v15, s[28:31], s45 offen sc1
    ds_read_b64_tr_b16 v[186:187], v16 offset:7168
    v_mfma_f32_16x16x32_bf16 v[60:63], v[172:175], v[160:163], v[60:63]
    ds_read_b64_tr_b16 v[188:189], v17 offset:5120
    v_mfma_f32_16x16x32_bf16 v[64:67], v[132:135], v[204:207], v[64:67]
    s_add_u32 s45, s85, 0
    buffer_load_dwordx4 v[196:199], v12, s[28:31], s45 offen sc1
    ds_read_b64_tr_b16 v[190:191], v17 offset:7168
    v_mfma_f32_16x16x32_bf16 v[68:71], v[136:139], v[204:207], v[68:71]
    ds_read_b128 v[192:195], v19 offset:9216
    v_mfma_f32_16x16x32_bf16 v[72:75], v[164:167], v[204:207], v[72:75]
    buffer_load_dwordx4 v[200:203], v13, s[28:31], s45 offen sc1
    v_mfma_f32_16x16x32_bf16 v[76:79], v[168:171], v[204:207], v[76:79]
    v_mfma_f32_16x16x32_bf16 v[80:83], v[172:175], v[204:207], v[80:83]
    v_mfma_f32_16x16x32_bf16 v[84:87], v[132:135], v[208:211], v[84:87]
    buffer_load_dwordx4 v[248:251], v14, s[28:31], s45 offen sc1
    v_mfma_f32_16x16x32_bf16 v[88:91], v[136:139], v[208:211], v[88:91]
    v_mfma_f32_16x16x32_bf16 v[92:95], v[164:167], v[208:211], v[92:95]
    buffer_load_dwordx4 v[144:147], v15, s[28:31], s45 offen sc1
    v_mfma_f32_16x16x32_bf16 v[96:99], v[168:171], v[208:211], v[96:99]
    v_mfma_f32_16x16x32_bf16 v[100:103], v[172:175], v[208:211], v[100:103]
    s_waitcnt vmcnt(27)
    s_waitcnt lgkmcnt(0)
    v_mfma_f32_16x16x32_bf16 v[24:27], v[224:227], v[112:115], v[24:27]
    s_add_u32 s45, s85, 4096
    buffer_load_dwordx4 v[168:171], v12, s[28:31], s45 offen sc1
    v_mfma_f32_16x16x32_bf16 v[28:31], v[228:231], v[112:115], v[28:31]
    v_mfma_f32_16x16x32_bf16 v[32:35], v[212:215], v[112:115], v[32:35]
    v_mfma_f32_16x16x32_bf16 v[36:39], v[216:219], v[112:115], v[36:39]
    buffer_load_dwordx4 v[172:175], v13, s[28:31], s45 offen sc1
    s_waitcnt vmcnt(14)
    v_add_u32 v3, 0xfffec000, v3
    v_mfma_f32_16x16x32_bf16 v[40:43], v[232:235], v[112:115], v[40:43]
    v_add_u32 v7, 0xfffec000, v7
    v_mfma_f32_16x16x32_bf16 v[44:47], v[224:227], v[116:119], v[44:47]
    buffer_load_dwordx4 v[156:159], v14, s[28:31], s45 offen sc1
    v_add_u32 v16, 0xfffec000, v16
    v_mfma_f32_16x16x32_bf16 v[48:51], v[228:231], v[116:119], v[48:51]
    v_add_u32 v17, 0xfffec000, v17
    v_mfma_f32_16x16x32_bf16 v[52:55], v[212:215], v[116:119], v[52:55]
    v_add_u32 v19, 0xfffec000, v19
    v_mfma_f32_16x16x32_bf16 v[56:59], v[216:219], v[116:119], v[56:59]
    buffer_load_dwordx4 v[160:163], v15, s[28:31], s45 offen sc1
    ds_read_b64_tr_b16 v[148:149], v3 offset:40960
    v_mfma_f32_16x16x32_bf16 v[60:63], v[232:235], v[116:119], v[60:63]
    ds_read_b64_tr_b16 v[150:151], v3 offset:43008
    v_mfma_f32_16x16x32_bf16 v[64:67], v[224:227], v[124:127], v[64:67]
    s_add_u32 m0, s73, 81920
    s_add_u32 s44, s66, 0
    buffer_load_dwordx4 v254, s[40:43], s44 offen offset:0 lds
    ds_read_b64_tr_b16 v[152:153], v7 offset:40960
    v_mfma_f32_16x16x32_bf16 v[68:71], v[228:231], v[124:127], v[68:71]
    ds_read_b64_tr_b16 v[154:155], v7 offset:43008
    v_mfma_f32_16x16x32_bf16 v[72:75], v[212:215], v[124:127], v[72:75]
    s_add_u32 s44, s44, 9216
    buffer_load_dwordx4 v255, s[40:43], s44 offen offset:1024 lds
    ds_read_b64_tr_b16 v[132:133], v16 offset:40960
    v_mfma_f32_16x16x32_bf16 v[76:79], v[216:219], v[124:127], v[76:79]
    ds_read_b64_tr_b16 v[134:135], v16 offset:43008
    v_mfma_f32_16x16x32_bf16 v[80:83], v[232:235], v[124:127], v[80:83]
    ds_read_b64_tr_b16 v[136:137], v17 offset:40960
    v_mfma_f32_16x16x32_bf16 v[84:87], v[224:227], v[128:131], v[84:87]
    s_add_u32 s44, s44, 9216
    buffer_load_dwordx4 v254, s[40:43], s44 offen offset:2048 lds
    ds_read_b64_tr_b16 v[138:139], v17 offset:43008
    v_mfma_f32_16x16x32_bf16 v[88:91], v[228:231], v[128:131], v[88:91]
    ds_read_b128 v[164:167], v19 offset:45056
    v_mfma_f32_16x16x32_bf16 v[92:95], v[212:215], v[128:131], v[92:95]
    s_add_u32 s44, s44, 9216
    buffer_load_dwordx4 v255, s[40:43], s44 offen offset:3072 lds
    v_mfma_f32_16x16x32_bf16 v[96:99], v[216:219], v[128:131], v[96:99]
    v_mfma_f32_16x16x32_bf16 v[100:103], v[232:235], v[128:131], v[100:103]
    s_waitcnt vmcnt(16)
    s_waitcnt lgkmcnt(0)
    v_mfma_f32_16x16x32_bf16 v[24:27], v[240:243], v[176:179], v[24:27]
    s_add_u32 m0, m0, 4096
    s_add_u32 s44, s44, 13312
    buffer_load_dwordx4 v254, s[40:43], s44 offen offset:0 lds
    v_mfma_f32_16x16x32_bf16 v[28:31], v[244:247], v[176:179], v[28:31]
    v_mfma_f32_16x16x32_bf16 v[32:35], v[184:187], v[176:179], v[32:35]
    v_mfma_f32_16x16x32_bf16 v[36:39], v[188:191], v[176:179], v[36:39]
    s_add_u32 s44, s44, 9216
    buffer_load_dwordx4 v255, s[40:43], s44 offen offset:1024 lds
    ds_read_b128 v[204:207], v20 offset:0
    v_mfma_f32_16x16x32_bf16 v[40:43], v[192:195], v[176:179], v[40:43]
    ds_read_b128 v[208:211], v20 offset:2048
    v_mfma_f32_16x16x32_bf16 v[44:47], v[240:243], v[180:183], v[44:47]
    s_add_u32 s44, s44, 9216
    buffer_load_dwordx4 v254, s[40:43], s44 offen offset:2048 lds
    ds_read_b128 v[224:227], v20 offset:4096
    v_mfma_f32_16x16x32_bf16 v[48:51], v[244:247], v[180:183], v[48:51]
    ds_read_b128 v[228:231], v20 offset:6144
    v_mfma_f32_16x16x32_bf16 v[52:55], v[184:187], v[180:183], v[52:55]
    ds_read_b128 v[212:215], v20 offset:8192
    v_mfma_f32_16x16x32_bf16 v[56:59], v[188:191], v[180:183], v[56:59]
    s_add_u32 s44, s44, 9216
    buffer_load_dwordx4 v255, s[40:43], s44 offen offset:3072 lds
    v_mfma_f32_16x16x32_bf16 v[60:63], v[192:195], v[180:183], v[60:63]
    v_mfma_f32_16x16x32_bf16 v[64:67], v[240:243], v[140:143], v[64:67]
    s_add_u32 m0, m0, 4096
    s_add_u32 s44, s44, s69
    buffer_load_dwordx4 v254, s[40:43], s44 offen offset:0 lds
    v_mfma_f32_16x16x32_bf16 v[68:71], v[244:247], v[140:143], v[68:71]
    v_mfma_f32_16x16x32_bf16 v[72:75], v[184:187], v[140:143], v[72:75]
    s_add_u32 s44, s44, 9216
    buffer_load_dwordx4 v255, s[40:43], s44 offen offset:1024 lds
    v_mfma_f32_16x16x32_bf16 v[76:79], v[188:191], v[140:143], v[76:79]
    v_mfma_f32_16x16x32_bf16 v[80:83], v[192:195], v[140:143], v[80:83]
    v_mfma_f32_16x16x32_bf16 v[84:87], v[240:243], v[220:223], v[84:87]
    s_add_u32 s45, s85, 8192
    buffer_load_dwordx4 v[216:219], v12, s[28:31], s45 offen sc1
    v_mfma_f32_16x16x32_bf16 v[88:91], v[244:247], v[220:223], v[88:91]
    v_mfma_f32_16x16x32_bf16 v[92:95], v[184:187], v[220:223], v[92:95]
    buffer_load_dwordx4 v[232:235], v13, s[28:31], s45 offen sc1
    v_mfma_f32_16x16x32_bf16 v[96:99], v[188:191], v[220:223], v[96:99]
    v_mfma_f32_16x16x32_bf16 v[100:103], v[192:195], v[220:223], v[100:103]
    s_waitcnt vmcnt(20)
    s_waitcnt lgkmcnt(0)
    v_mfma_f32_16x16x32_bf16 v[24:27], v[148:151], v[104:107], v[24:27]
    buffer_load_dwordx4 v[112:115], v14, s[28:31], s45 offen sc1
    v_mfma_f32_16x16x32_bf16 v[28:31], v[152:155], v[104:107], v[28:31]
    v_mfma_f32_16x16x32_bf16 v[32:35], v[132:135], v[104:107], v[32:35]
    v_mfma_f32_16x16x32_bf16 v[36:39], v[136:139], v[104:107], v[36:39]
    buffer_load_dwordx4 v[116:119], v15, s[28:31], s45 offen sc1
    ds_read_b128 v[124:127], v21 offset:0
    v_mfma_f32_16x16x32_bf16 v[40:43], v[164:167], v[104:107], v[40:43]
    ds_read_b128 v[128:131], v21 offset:2048
    v_mfma_f32_16x16x32_bf16 v[44:47], v[148:151], v[108:111], v[44:47]
    s_add_u32 m0, s73, 40960
    s_add_u32 s44, s86, 128
    buffer_load_dwordx4 v254, s[32:35], s44 offen offset:0 lds
    ds_read_b128 v[240:243], v21 offset:4096
    v_mfma_f32_16x16x32_bf16 v[48:51], v[152:155], v[108:111], v[48:51]
    ds_read_b128 v[244:247], v21 offset:6144
    v_mfma_f32_16x16x32_bf16 v[52:55], v[132:135], v[108:111], v[52:55]
    ds_read_b128 v[184:187], v21 offset:8192
    v_mfma_f32_16x16x32_bf16 v[56:59], v[136:139], v[108:111], v[56:59]
    s_add_u32 s44, s44, 9216
    buffer_load_dwordx4 v255, s[32:35], s44 offen offset:1024 lds
    v_mfma_f32_16x16x32_bf16 v[60:63], v[164:167], v[108:111], v[60:63]
    v_mfma_f32_16x16x32_bf16 v[64:67], v[148:151], v[120:123], v[64:67]
    s_add_u32 s44, s44, 9216
    buffer_load_dwordx4 v254, s[32:35], s44 offen offset:2048 lds
    v_mfma_f32_16x16x32_bf16 v[68:71], v[152:155], v[120:123], v[68:71]
    v_mfma_f32_16x16x32_bf16 v[72:75], v[132:135], v[120:123], v[72:75]
    s_add_u32 s44, s44, 9216
    buffer_load_dwordx4 v255, s[32:35], s44 offen offset:3072 lds
    v_mfma_f32_16x16x32_bf16 v[76:79], v[136:139], v[120:123], v[76:79]
    v_mfma_f32_16x16x32_bf16 v[80:83], v[164:167], v[120:123], v[80:83]
    v_mfma_f32_16x16x32_bf16 v[84:87], v[148:151], v[236:239], v[84:87]
    s_add_u32 m0, m0, 4096
    s_add_u32 s44, s44, 13312
    buffer_load_dwordx4 v254, s[32:35], s44 offen offset:0 lds
    v_mfma_f32_16x16x32_bf16 v[88:91], v[152:155], v[236:239], v[88:91]
    v_mfma_f32_16x16x32_bf16 v[92:95], v[132:135], v[236:239], v[92:95]
    s_add_u32 s44, s44, 9216
    buffer_load_dwordx4 v255, s[32:35], s44 offen offset:1024 lds
    v_mfma_f32_16x16x32_bf16 v[96:99], v[136:139], v[236:239], v[96:99]
    v_mfma_f32_16x16x32_bf16 v[100:103], v[164:167], v[236:239], v[100:103]
    s_waitcnt vmcnt(24)
    s_waitcnt lgkmcnt(0)
    v_mfma_f32_16x16x32_bf16 v[24:27], v[204:207], v[196:199], v[24:27]
    s_add_u32 s44, s44, 9216
    buffer_load_dwordx4 v254, s[32:35], s44 offen offset:2048 lds
    v_mfma_f32_16x16x32_bf16 v[28:31], v[208:211], v[196:199], v[28:31]
    v_mfma_f32_16x16x32_bf16 v[32:35], v[224:227], v[196:199], v[32:35]
    v_mfma_f32_16x16x32_bf16 v[36:39], v[228:231], v[196:199], v[36:39]
    s_add_u32 s44, s44, 9216
    buffer_load_dwordx4 v255, s[32:35], s44 offen offset:3072 lds
    v_mfma_f32_16x16x32_bf16 v[40:43], v[212:215], v[196:199], v[40:43]
    v_mfma_f32_16x16x32_bf16 v[44:47], v[204:207], v[200:203], v[44:47]
    s_add_u32 m0, m0, 4096
    s_add_u32 s44, s44, s69
    buffer_load_dwordx4 v254, s[32:35], s44 offen offset:0 lds
    v_mfma_f32_16x16x32_bf16 v[48:51], v[208:211], v[200:203], v[48:51]
    v_mfma_f32_16x16x32_bf16 v[52:55], v[224:227], v[200:203], v[52:55]
    v_mfma_f32_16x16x32_bf16 v[56:59], v[228:231], v[200:203], v[56:59]
    s_add_u32 s44, s44, 9216
    buffer_load_dwordx4 v255, s[32:35], s44 offen offset:1024 lds
    v_mfma_f32_16x16x32_bf16 v[60:63], v[212:215], v[200:203], v[60:63]
    v_mfma_f32_16x16x32_bf16 v[64:67], v[204:207], v[248:251], v[64:67]
    s_add_u32 s45, s85, 12288
    buffer_load_dwordx4 v[188:191], v12, s[28:31], s45 offen sc1
    v_mfma_f32_16x16x32_bf16 v[68:71], v[208:211], v[248:251], v[68:71]
    v_mfma_f32_16x16x32_bf16 v[72:75], v[224:227], v[248:251], v[72:75]
    buffer_load_dwordx4 v[192:195], v13, s[28:31], s45 offen sc1
    v_mfma_f32_16x16x32_bf16 v[76:79], v[228:231], v[248:251], v[76:79]
    v_mfma_f32_16x16x32_bf16 v[80:83], v[212:215], v[248:251], v[80:83]
    v_mfma_f32_16x16x32_bf16 v[84:87], v[204:207], v[144:147], v[84:87]
    buffer_load_dwordx4 v[176:179], v14, s[28:31], s45 offen sc1
    v_mfma_f32_16x16x32_bf16 v[88:91], v[208:211], v[144:147], v[88:91]
    v_mfma_f32_16x16x32_bf16 v[92:95], v[224:227], v[144:147], v[92:95]
    buffer_load_dwordx4 v[180:183], v15, s[28:31], s45 offen sc1
    v_mfma_f32_16x16x32_bf16 v[96:99], v[228:231], v[144:147], v[96:99]
    v_mfma_f32_16x16x32_bf16 v[100:103], v[212:215], v[144:147], v[100:103]
    s_waitcnt vmcnt(28)
    v_mfma_f32_16x16x32_bf16 v[24:27], v[124:127], v[168:171], v[24:27]
    s_add_u32 s45, s85, 16384
    buffer_load_dwordx4 v[140:143], v12, s[28:31], s45 offen sc1
    v_mfma_f32_16x16x32_bf16 v[28:31], v[128:131], v[168:171], v[28:31]
    v_mfma_f32_16x16x32_bf16 v[32:35], v[240:243], v[168:171], v[32:35]
    v_mfma_f32_16x16x32_bf16 v[36:39], v[244:247], v[168:171], v[36:39]
    buffer_load_dwordx4 v[220:223], v13, s[28:31], s45 offen sc1
    s_waitcnt vmcnt(20)
    ds_read_b128 v[108:111], v6 offset:0
    v_mfma_f32_16x16x32_bf16 v[40:43], v[184:187], v[168:171], v[40:43]
    ds_read_b128 v[120:123], v6 offset:2048
    v_mfma_f32_16x16x32_bf16 v[44:47], v[124:127], v[172:175], v[44:47]
    buffer_load_dwordx4 v[148:151], v14, s[28:31], s45 offen sc1
    ds_read_b128 v[236:239], v6 offset:4096
    v_mfma_f32_16x16x32_bf16 v[48:51], v[128:131], v[172:175], v[48:51]
    ds_read_b128 v[204:207], v6 offset:6144
    v_mfma_f32_16x16x32_bf16 v[52:55], v[240:243], v[172:175], v[52:55]
    ds_read_b128 v[208:211], v6 offset:8192
    v_mfma_f32_16x16x32_bf16 v[56:59], v[244:247], v[172:175], v[56:59]
    buffer_load_dwordx4 v[152:155], v15, s[28:31], s45 offen sc1
    v_mfma_f32_16x16x32_bf16 v[60:63], v[184:187], v[172:175], v[60:63]
    v_mfma_f32_16x16x32_bf16 v[64:67], v[124:127], v[156:159], v[64:67]
    s_add_u32 s45, s85, 20480
    buffer_load_dwordx4 v[132:135], v12, s[28:31], s45 offen sc1
    v_mfma_f32_16x16x32_bf16 v[68:71], v[128:131], v[156:159], v[68:71]
    v_mfma_f32_16x16x32_bf16 v[72:75], v[240:243], v[156:159], v[72:75]
    buffer_load_dwordx4 v[136:139], v13, s[28:31], s45 offen sc1
    v_mfma_f32_16x16x32_bf16 v[76:79], v[244:247], v[156:159], v[76:79]
    v_mfma_f32_16x16x32_bf16 v[80:83], v[184:187], v[156:159], v[80:83]
    v_mfma_f32_16x16x32_bf16 v[84:87], v[124:127], v[160:163], v[84:87]
    buffer_load_dwordx4 v[164:167], v14, s[28:31], s45 offen sc1
    v_mfma_f32_16x16x32_bf16 v[88:91], v[128:131], v[160:163], v[88:91]
    v_mfma_f32_16x16x32_bf16 v[92:95], v[240:243], v[160:163], v[92:95]
    buffer_load_dwordx4 v[104:107], v15, s[28:31], s45 offen sc1
    v_mfma_f32_16x16x32_bf16 v[96:99], v[244:247], v[160:163], v[96:99]
    v_mfma_f32_16x16x32_bf16 v[100:103], v[184:187], v[160:163], v[100:103]
    s_waitcnt vmcnt(22)
    s_waitcnt lgkmcnt(0)
    v_mfma_f32_16x16x32_bf16 v[24:27], v[108:111], v[216:219], v[24:27]
    s_add_u32 m0, s73, 0
    s_add_u32 s44, s66, 128
    buffer_load_dwordx4 v254, s[40:43], s44 offen offset:0 lds
    v_mfma_f32_16x16x32_bf16 v[28:31], v[120:123], v[216:219], v[28:31]
    v_mfma_f32_16x16x32_bf16 v[32:35], v[236:239], v[216:219], v[32:35]
    v_mfma_f32_16x16x32_bf16 v[36:39], v[204:207], v[216:219], v[36:39]
    s_add_u32 s44, s44, 9216
    buffer_load_dwordx4 v255, s[40:43], s44 offen offset:1024 lds
    ds_read_b128 v[200:203], v8 offset:0
    v_mfma_f32_16x16x32_bf16 v[40:43], v[208:211], v[216:219], v[40:43]
    ds_read_b128 v[248:251], v8 offset:2048
    v_mfma_f32_16x16x32_bf16 v[44:47], v[108:111], v[232:235], v[44:47]
    s_add_u32 s44, s44, 9216
    buffer_load_dwordx4 v254, s[40:43], s44 offen offset:2048 lds
    ds_read_b128 v[144:147], v8 offset:4096
    v_mfma_f32_16x16x32_bf16 v[48:51], v[120:123], v[232:235], v[48:51]
    ds_read_b128 v[124:127], v8 offset:6144
    v_mfma_f32_16x16x32_bf16 v[52:55], v[236:239], v[232:235], v[52:55]
    ds_read_b128 v[128:131], v8 offset:8192
    v_mfma_f32_16x16x32_bf16 v[56:59], v[204:207], v[232:235], v[56:59]
    s_add_u32 s44, s44, 9216
    buffer_load_dwordx4 v255, s[40:43], s44 offen offset:3072 lds
    v_mfma_f32_16x16x32_bf16 v[60:63], v[208:211], v[232:235], v[60:63]
    v_mfma_f32_16x16x32_bf16 v[64:67], v[108:111], v[112:115], v[64:67]
    s_add_u32 m0, m0, 4096
    s_add_u32 s44, s44, 13312
    buffer_load_dwordx4 v254, s[40:43], s44 offen offset:0 lds
    v_mfma_f32_16x16x32_bf16 v[68:71], v[120:123], v[112:115], v[68:71]
    v_mfma_f32_16x16x32_bf16 v[72:75], v[236:239], v[112:115], v[72:75]
    s_add_u32 s44, s44, 9216
    buffer_load_dwordx4 v255, s[40:43], s44 offen offset:1024 lds
    v_mfma_f32_16x16x32_bf16 v[76:79], v[204:207], v[112:115], v[76:79]
    v_mfma_f32_16x16x32_bf16 v[80:83], v[208:211], v[112:115], v[80:83]
    v_mfma_f32_16x16x32_bf16 v[84:87], v[108:111], v[116:119], v[84:87]
    s_add_u32 s44, s44, 9216
    buffer_load_dwordx4 v254, s[40:43], s44 offen offset:2048 lds
    v_mfma_f32_16x16x32_bf16 v[88:91], v[120:123], v[116:119], v[88:91]
    v_mfma_f32_16x16x32_bf16 v[92:95], v[236:239], v[116:119], v[92:95]
    s_add_u32 s44, s44, 9216
    buffer_load_dwordx4 v255, s[40:43], s44 offen offset:3072 lds
    v_mfma_f32_16x16x32_bf16 v[96:99], v[204:207], v[116:119], v[96:99]
    v_mfma_f32_16x16x32_bf16 v[100:103], v[208:211], v[116:119], v[100:103]
    s_waitcnt vmcnt(16)
    s_waitcnt lgkmcnt(0)
    v_mfma_f32_16x16x32_bf16 v[24:27], v[200:203], v[188:191], v[24:27]
    s_add_u32 m0, m0, 4096
    s_add_u32 s44, s44, s69
    buffer_load_dwordx4 v254, s[40:43], s44 offen offset:0 lds
    v_mfma_f32_16x16x32_bf16 v[28:31], v[248:251], v[188:191], v[28:31]
    v_mfma_f32_16x16x32_bf16 v[32:35], v[144:147], v[188:191], v[32:35]
    v_mfma_f32_16x16x32_bf16 v[36:39], v[124:127], v[188:191], v[36:39]
    s_add_u32 s44, s44, 9216
    buffer_load_dwordx4 v255, s[40:43], s44 offen offset:1024 lds
    ds_read_b128 v[172:175], v20 offset:40960
    v_mfma_f32_16x16x32_bf16 v[40:43], v[128:131], v[188:191], v[40:43]
    ds_read_b128 v[156:159], v20 offset:43008
    v_mfma_f32_16x16x32_bf16 v[44:47], v[200:203], v[192:195], v[44:47]
    s_add_u32 s45, s85, 24576
    buffer_load_dwordx4 v[224:227], v12, s[28:31], s45 offen sc1
    ds_read_b128 v[160:163], v20 offset:45056
    v_mfma_f32_16x16x32_bf16 v[48:51], v[248:251], v[192:195], v[48:51]
    ds_read_b128 v[108:111], v20 offset:47104
    v_mfma_f32_16x16x32_bf16 v[52:55], v[144:147], v[192:195], v[52:55]
    ds_read_b128 v[120:123], v20 offset:49152
    v_mfma_f32_16x16x32_bf16 v[56:59], v[124:127], v[192:195], v[56:59]
    buffer_load_dwordx4 v[228:231], v13, s[28:31], s45 offen sc1
    v_mfma_f32_16x16x32_bf16 v[60:63], v[128:131], v[192:195], v[60:63]
    v_mfma_f32_16x16x32_bf16 v[64:67], v[200:203], v[176:179], v[64:67]
    buffer_load_dwordx4 v[212:215], v14, s[28:31], s45 offen sc1
    v_mfma_f32_16x16x32_bf16 v[68:71], v[248:251], v[176:179], v[68:71]
    v_mfma_f32_16x16x32_bf16 v[72:75], v[144:147], v[176:179], v[72:75]
    buffer_load_dwordx4 v[196:199], v15, s[28:31], s45 offen sc1
    v_mfma_f32_16x16x32_bf16 v[76:79], v[124:127], v[176:179], v[76:79]
    v_mfma_f32_16x16x32_bf16 v[80:83], v[128:131], v[176:179], v[80:83]
    v_mfma_f32_16x16x32_bf16 v[84:87], v[200:203], v[180:183], v[84:87]
    s_add_u32 s45, s85, 28672
    buffer_load_dwordx4 v[240:243], v12, s[28:31], s45 offen sc1
    v_mfma_f32_16x16x32_bf16 v[88:91], v[248:251], v[180:183], v[88:91]
    v_mfma_f32_16x16x32_bf16 v[92:95], v[144:147], v[180:183], v[92:95]
    buffer_load_dwordx4 v[244:247], v13, s[28:31], s45 offen sc1
    v_mfma_f32_16x16x32_bf16 v[96:99], v[124:127], v[180:183], v[96:99]
    v_mfma_f32_16x16x32_bf16 v[100:103], v[128:131], v[180:183], v[100:103]
    s_waitcnt vmcnt(20)
    s_waitcnt lgkmcnt(0)
    v_mfma_f32_16x16x32_bf16 v[24:27], v[172:175], v[140:143], v[24:27]
    buffer_load_dwordx4 v[184:187], v14, s[28:31], s45 offen sc1
    v_mfma_f32_16x16x32_bf16 v[28:31], v[156:159], v[140:143], v[28:31]
    v_mfma_f32_16x16x32_bf16 v[32:35], v[160:163], v[140:143], v[32:35]
    v_mfma_f32_16x16x32_bf16 v[36:39], v[108:111], v[140:143], v[36:39]
    buffer_load_dwordx4 v[168:171], v15, s[28:31], s45 offen sc1
    ds_read_b128 v[232:235], v21 offset:40960
    v_mfma_f32_16x16x32_bf16 v[40:43], v[120:123], v[140:143], v[40:43]
    ds_read_b128 v[112:115], v21 offset:43008
    v_mfma_f32_16x16x32_bf16 v[44:47], v[172:175], v[220:223], v[44:47]
    s_add_u32 m0, s73, 81920
    s_add_u32 s44, s86, 256
    buffer_load_dwordx4 v254, s[32:35], s44 offen offset:0 lds
    ds_read_b128 v[116:119], v21 offset:45056
    v_mfma_f32_16x16x32_bf16 v[48:51], v[156:159], v[220:223], v[48:51]
    ds_read_b128 v[200:203], v21 offset:47104
    v_mfma_f32_16x16x32_bf16 v[52:55], v[160:163], v[220:223], v[52:55]
    ds_read_b128 v[248:251], v21 offset:49152
    v_mfma_f32_16x16x32_bf16 v[56:59], v[108:111], v[220:223], v[56:59]
    s_add_u32 s44, s44, 9216
    buffer_load_dwordx4 v255, s[32:35], s44 offen offset:1024 lds
    v_mfma_f32_16x16x32_bf16 v[60:63], v[120:123], v[220:223], v[60:63]
    v_mfma_f32_16x16x32_bf16 v[64:67], v[172:175], v[148:151], v[64:67]
    s_add_u32 s44, s44, 9216
    buffer_load_dwordx4 v254, s[32:35], s44 offen offset:2048 lds
    v_mfma_f32_16x16x32_bf16 v[68:71], v[156:159], v[148:151], v[68:71]
    v_mfma_f32_16x16x32_bf16 v[72:75], v[160:163], v[148:151], v[72:75]
    s_add_u32 s44, s44, 9216
    buffer_load_dwordx4 v255, s[32:35], s44 offen offset:3072 lds
    v_mfma_f32_16x16x32_bf16 v[76:79], v[108:111], v[148:151], v[76:79]
    v_mfma_f32_16x16x32_bf16 v[80:83], v[120:123], v[148:151], v[80:83]
    v_mfma_f32_16x16x32_bf16 v[84:87], v[172:175], v[152:155], v[84:87]
    s_add_u32 m0, m0, 4096
    s_add_u32 s44, s44, 13312
    buffer_load_dwordx4 v254, s[32:35], s44 offen offset:0 lds
    v_mfma_f32_16x16x32_bf16 v[88:91], v[156:159], v[152:155], v[88:91]
    v_mfma_f32_16x16x32_bf16 v[92:95], v[160:163], v[152:155], v[92:95]
    s_add_u32 s44, s44, 9216
    buffer_load_dwordx4 v255, s[32:35], s44 offen offset:1024 lds
    v_mfma_f32_16x16x32_bf16 v[96:99], v[108:111], v[152:155], v[96:99]
    v_mfma_f32_16x16x32_bf16 v[100:103], v[120:123], v[152:155], v[100:103]
    s_waitcnt vmcnt(24)
    s_waitcnt lgkmcnt(0)
    v_mfma_f32_16x16x32_bf16 v[24:27], v[232:235], v[132:135], v[24:27]
    s_add_u32 s44, s44, 9216
    buffer_load_dwordx4 v254, s[32:35], s44 offen offset:2048 lds
    v_mfma_f32_16x16x32_bf16 v[28:31], v[112:115], v[132:135], v[28:31]
    v_mfma_f32_16x16x32_bf16 v[32:35], v[116:119], v[132:135], v[32:35]
    v_mfma_f32_16x16x32_bf16 v[36:39], v[200:203], v[132:135], v[36:39]
    s_add_u32 s44, s44, 9216
    buffer_load_dwordx4 v255, s[32:35], s44 offen offset:3072 lds
    s_waitcnt vmcnt(16)
    ds_read_b128 v[192:195], v20 offset:0
    v_mfma_f32_16x16x32_bf16 v[40:43], v[248:251], v[132:135], v[40:43]
    ds_read_b128 v[176:179], v20 offset:2048
    v_mfma_f32_16x16x32_bf16 v[44:47], v[232:235], v[136:139], v[44:47]
    s_add_u32 m0, m0, 4096
    s_add_u32 s44, s44, s69
    buffer_load_dwordx4 v254, s[32:35], s44 offen offset:0 lds
    ds_read_b128 v[180:183], v20 offset:4096
    v_mfma_f32_16x16x32_bf16 v[48:51], v[112:115], v[136:139], v[48:51]
    ds_read_b128 v[172:175], v20 offset:6144
    v_mfma_f32_16x16x32_bf16 v[52:55], v[116:119], v[136:139], v[52:55]
    ds_read_b128 v[156:159], v20 offset:8192
    v_mfma_f32_16x16x32_bf16 v[56:59], v[200:203], v[136:139], v[56:59]
    s_add_u32 s44, s44, 9216
    buffer_load_dwordx4 v255, s[32:35], s44 offen offset:1024 lds
    v_mfma_f32_16x16x32_bf16 v[60:63], v[248:251], v[136:139], v[60:63]
    v_mfma_f32_16x16x32_bf16 v[64:67], v[232:235], v[164:167], v[64:67]
    s_add_u32 s45, s85, 32768
    buffer_load_dwordx4 v[236:239], v12, s[28:31], s45 offen sc1
    v_mfma_f32_16x16x32_bf16 v[68:71], v[112:115], v[164:167], v[68:71]
    v_mfma_f32_16x16x32_bf16 v[72:75], v[116:119], v[164:167], v[72:75]
    buffer_load_dwordx4 v[204:207], v13, s[28:31], s45 offen sc1
    v_mfma_f32_16x16x32_bf16 v[76:79], v[200:203], v[164:167], v[76:79]
    v_mfma_f32_16x16x32_bf16 v[80:83], v[248:251], v[164:167], v[80:83]
    v_mfma_f32_16x16x32_bf16 v[84:87], v[232:235], v[104:107], v[84:87]
    buffer_load_dwordx4 v[208:211], v14, s[28:31], s45 offen sc1
    v_mfma_f32_16x16x32_bf16 v[88:91], v[112:115], v[104:107], v[88:91]
    v_mfma_f32_16x16x32_bf16 v[92:95], v[116:119], v[104:107], v[92:95]
    buffer_load_dwordx4 v[216:219], v15, s[28:31], s45 offen sc1
    v_mfma_f32_16x16x32_bf16 v[96:99], v[200:203], v[104:107], v[96:99]
    v_mfma_f32_16x16x32_bf16 v[100:103], v[248:251], v[104:107], v[100:103]
    s_waitcnt vmcnt(18)
    s_waitcnt lgkmcnt(0)
    v_mfma_f32_16x16x32_bf16 v[24:27], v[192:195], v[224:227], v[24:27]
    s_add_u32 s45, s85, 36864
    buffer_load_dwordx4 v[144:147], v12, s[28:31], s45 offen sc1
    v_mfma_f32_16x16x32_bf16 v[28:31], v[176:179], v[224:227], v[28:31]
    v_mfma_f32_16x16x32_bf16 v[32:35], v[180:183], v[224:227], v[32:35]
    v_mfma_f32_16x16x32_bf16 v[36:39], v[172:175], v[224:227], v[36:39]
    ds_read_b128 v[160:163], v21 offset:0
    v_mfma_f32_16x16x32_bf16 v[40:43], v[156:159], v[224:227], v[40:43]
    ds_read_b128 v[108:111], v21 offset:2048
    v_mfma_f32_16x16x32_bf16 v[44:47], v[192:195], v[228:231], v[44:47]
    buffer_load_dwordx4 v[124:127], v13, s[28:31], s45 offen sc1
    ds_read_b128 v[120:123], v21 offset:4096
    v_mfma_f32_16x16x32_bf16 v[48:51], v[176:179], v[228:231], v[48:51]
    ds_read_b128 v[140:143], v21 offset:6144
    v_mfma_f32_16x16x32_bf16 v[52:55], v[180:183], v[228:231], v[52:55]
    ds_read_b128 v[220:223], v21 offset:8192
    v_mfma_f32_16x16x32_bf16 v[56:59], v[172:175], v[228:231], v[56:59]
    v_mfma_f32_16x16x32_bf16 v[60:63], v[156:159], v[228:231], v[60:63]
    v_mfma_f32_16x16x32_bf16 v[64:67], v[192:195], v[212:215], v[64:67]
    buffer_load_dwordx4 v[128:131], v14, s[28:31], s45 offen sc1
    v_mfma_f32_16x16x32_bf16 v[68:71], v[176:179], v[212:215], v[68:71]
    v_mfma_f32_16x16x32_bf16 v[72:75], v[180:183], v[212:215], v[72:75]
    v_mfma_f32_16x16x32_bf16 v[76:79], v[172:175], v[212:215], v[76:79]
    v_mfma_f32_16x16x32_bf16 v[80:83], v[156:159], v[212:215], v[80:83]
    v_mfma_f32_16x16x32_bf16 v[84:87], v[192:195], v[196:199], v[84:87]
    buffer_load_dwordx4 v[188:191], v15, s[28:31], s45 offen sc1
    v_mfma_f32_16x16x32_bf16 v[88:91], v[176:179], v[196:199], v[88:91]
    v_mfma_f32_16x16x32_bf16 v[92:95], v[180:183], v[196:199], v[92:95]
    v_mfma_f32_16x16x32_bf16 v[96:99], v[172:175], v[196:199], v[96:99]
    v_mfma_f32_16x16x32_bf16 v[100:103], v[156:159], v[196:199], v[100:103]
    s_waitcnt vmcnt(18)
    s_waitcnt lgkmcnt(0)
    v_mfma_f32_16x16x32_bf16 v[24:27], v[160:163], v[240:243], v[24:27]
    v_mfma_f32_16x16x32_bf16 v[28:31], v[108:111], v[240:243], v[28:31]
    v_mfma_f32_16x16x32_bf16 v[32:35], v[120:123], v[240:243], v[32:35]
    v_mfma_f32_16x16x32_bf16 v[36:39], v[140:143], v[240:243], v[36:39]
    s_waitcnt vmcnt(8)
    ds_read_b128 v[148:151], v6 offset:0
    v_mfma_f32_16x16x32_bf16 v[40:43], v[220:223], v[240:243], v[40:43]
    ds_read_b128 v[152:155], v6 offset:2048
    v_mfma_f32_16x16x32_bf16 v[44:47], v[160:163], v[244:247], v[44:47]
    ds_read_b128 v[232:235], v6 offset:4096
    v_mfma_f32_16x16x32_bf16 v[48:51], v[108:111], v[244:247], v[48:51]
    ds_read_b128 v[112:115], v6 offset:6144
    v_mfma_f32_16x16x32_bf16 v[52:55], v[120:123], v[244:247], v[52:55]
    ds_read_b128 v[116:119], v6 offset:8192
    v_mfma_f32_16x16x32_bf16 v[56:59], v[140:143], v[244:247], v[56:59]
    v_mfma_f32_16x16x32_bf16 v[60:63], v[220:223], v[244:247], v[60:63]
    v_mfma_f32_16x16x32_bf16 v[64:67], v[160:163], v[184:187], v[64:67]
    v_mfma_f32_16x16x32_bf16 v[68:71], v[108:111], v[184:187], v[68:71]
    v_mfma_f32_16x16x32_bf16 v[72:75], v[120:123], v[184:187], v[72:75]
    v_mfma_f32_16x16x32_bf16 v[76:79], v[140:143], v[184:187], v[76:79]
    v_mfma_f32_16x16x32_bf16 v[80:83], v[220:223], v[184:187], v[80:83]
    v_mfma_f32_16x16x32_bf16 v[84:87], v[160:163], v[168:171], v[84:87]
    v_mfma_f32_16x16x32_bf16 v[88:91], v[108:111], v[168:171], v[88:91]
    v_mfma_f32_16x16x32_bf16 v[92:95], v[120:123], v[168:171], v[92:95]
    v_mfma_f32_16x16x32_bf16 v[96:99], v[140:143], v[168:171], v[96:99]
    v_mfma_f32_16x16x32_bf16 v[100:103], v[220:223], v[168:171], v[100:103]
    s_waitcnt vmcnt(4)
    s_waitcnt lgkmcnt(0)
    v_mfma_f32_16x16x32_bf16 v[24:27], v[148:151], v[236:239], v[24:27]
    v_mfma_f32_16x16x32_bf16 v[28:31], v[152:155], v[236:239], v[28:31]
    v_mfma_f32_16x16x32_bf16 v[32:35], v[232:235], v[236:239], v[32:35]
    v_mfma_f32_16x16x32_bf16 v[36:39], v[112:115], v[236:239], v[36:39]
    ds_read_b128 v[200:203], v8 offset:0
    v_mfma_f32_16x16x32_bf16 v[40:43], v[116:119], v[236:239], v[40:43]
    ds_read_b128 v[248:251], v8 offset:2048
    v_mfma_f32_16x16x32_bf16 v[44:47], v[148:151], v[204:207], v[44:47]
    ds_read_b128 v[132:135], v8 offset:4096
    v_mfma_f32_16x16x32_bf16 v[48:51], v[152:155], v[204:207], v[48:51]
    ds_read_b128 v[136:139], v8 offset:6144
    v_mfma_f32_16x16x32_bf16 v[52:55], v[232:235], v[204:207], v[52:55]
    ds_read_b128 v[164:167], v8 offset:8192
    v_mfma_f32_16x16x32_bf16 v[56:59], v[112:115], v[204:207], v[56:59]
    v_mfma_f32_16x16x32_bf16 v[60:63], v[116:119], v[204:207], v[60:63]
    v_mfma_f32_16x16x32_bf16 v[64:67], v[148:151], v[208:211], v[64:67]
    v_mfma_f32_16x16x32_bf16 v[68:71], v[152:155], v[208:211], v[68:71]
    v_mfma_f32_16x16x32_bf16 v[72:75], v[232:235], v[208:211], v[72:75]
    v_mfma_f32_16x16x32_bf16 v[76:79], v[112:115], v[208:211], v[76:79]
    v_mfma_f32_16x16x32_bf16 v[80:83], v[116:119], v[208:211], v[80:83]
    v_mfma_f32_16x16x32_bf16 v[84:87], v[148:151], v[216:219], v[84:87]
    v_mfma_f32_16x16x32_bf16 v[88:91], v[152:155], v[216:219], v[88:91]
    v_mfma_f32_16x16x32_bf16 v[92:95], v[232:235], v[216:219], v[92:95]
    v_mfma_f32_16x16x32_bf16 v[96:99], v[112:115], v[216:219], v[96:99]
    v_mfma_f32_16x16x32_bf16 v[100:103], v[116:119], v[216:219], v[100:103]
    s_waitcnt vmcnt(0)
    s_waitcnt lgkmcnt(0)
    v_mfma_f32_16x16x32_bf16 v[44:47], v[200:203], v[124:127], v[44:47]
    v_mfma_f32_16x16x32_bf16 v[48:51], v[248:251], v[124:127], v[48:51]
    v_mfma_f32_16x16x32_bf16 v[52:55], v[132:135], v[124:127], v[52:55]
    v_mfma_f32_16x16x32_bf16 v[56:59], v[136:139], v[124:127], v[56:59]
    v_mfma_f32_16x16x32_bf16 v[60:63], v[164:167], v[124:127], v[60:63]
    v_mfma_f32_16x16x32_bf16 v[64:67], v[200:203], v[128:131], v[64:67]
    v_mfma_f32_16x16x32_bf16 v[68:71], v[248:251], v[128:131], v[68:71]
    v_mfma_f32_16x16x32_bf16 v[72:75], v[132:135], v[128:131], v[72:75]
    v_mfma_f32_16x16x32_bf16 v[76:79], v[136:139], v[128:131], v[76:79]
    ds_write_b128 v11, v[44:47] offset:5120
    v_mfma_f32_16x16x32_bf16 v[80:83], v[164:167], v[128:131], v[80:83]
    ds_write_b128 v11, v[48:51] offset:6144
    v_mfma_f32_16x16x32_bf16 v[84:87], v[200:203], v[188:191], v[84:87]
    ds_write_b128 v11, v[52:55] offset:7168
    v_mfma_f32_16x16x32_bf16 v[88:91], v[248:251], v[188:191], v[88:91]
    ds_write_b128 v11, v[56:59] offset:8192
    v_mfma_f32_16x16x32_bf16 v[92:95], v[132:135], v[188:191], v[92:95]
    ds_write_b128 v11, v[60:63] offset:9216
    v_mfma_f32_16x16x32_bf16 v[96:99], v[136:139], v[188:191], v[96:99]
    ds_write_b128 v11, v[64:67] offset:40960
    v_mfma_f32_16x16x32_bf16 v[100:103], v[164:167], v[188:191], v[100:103]
    ds_write_b128 v11, v[68:71] offset:41984
    v_mfma_f32_16x16x32_bf16 v[24:27], v[200:203], v[144:147], v[24:27]
    ds_write_b128 v11, v[72:75] offset:43008
    v_mfma_f32_16x16x32_bf16 v[28:31], v[248:251], v[144:147], v[28:31]
    ds_write_b128 v11, v[76:79] offset:44032
    v_mfma_f32_16x16x32_bf16 v[32:35], v[132:135], v[144:147], v[32:35]
    ds_write_b128 v11, v[80:83] offset:45056
    v_mfma_f32_16x16x32_bf16 v[36:39], v[136:139], v[144:147], v[36:39]
    ds_write_b128 v11, v[84:87] offset:46080
    v_mfma_f32_16x16x32_bf16 v[40:43], v[164:167], v[144:147], v[40:43]
    ds_write_b128 v11, v[88:91] offset:47104
    s_branch parallel_sum__ssm_conv_s5__geglu_ffn__prompt_kernel_red
parallel_sum__ssm_conv_s5__geglu_ffn__prompt_kernel_late_32:
    s_waitcnt lgkmcnt(0)
    v_mfma_f32_16x16x32_bf16 v[24:27], v[212:215], v[120:123], v[24:27]
    s_add_u32 s44, s44, 9216
    buffer_load_dwordx4 v255, s[32:35], s44 offen offset:3072 lds
    v_mfma_f32_16x16x32_bf16 v[28:31], v[216:219], v[120:123], v[28:31]
    v_mfma_f32_16x16x32_bf16 v[32:35], v[232:235], v[120:123], v[32:35]
    v_mfma_f32_16x16x32_bf16 v[36:39], v[104:107], v[120:123], v[36:39]
    s_add_u32 m0, m0, 4096
    s_add_u32 s44, s44, 13312
    buffer_load_dwordx4 v254, s[32:35], s44 offen offset:0 lds
    ds_read_b64_tr_b16 v[132:133], v3 offset:46080
    v_mfma_f32_16x16x32_bf16 v[40:43], v[108:111], v[120:123], v[40:43]
    ds_read_b64_tr_b16 v[134:135], v3 offset:48128
    v_mfma_f32_16x16x32_bf16 v[44:47], v[212:215], v[236:239], v[44:47]
    s_add_u32 s44, s44, 9216
    buffer_load_dwordx4 v255, s[32:35], s44 offen offset:1024 lds
    ds_read_b64_tr_b16 v[136:137], v7 offset:46080
    v_mfma_f32_16x16x32_bf16 v[48:51], v[216:219], v[236:239], v[48:51]
    ds_read_b64_tr_b16 v[138:139], v7 offset:48128
    v_mfma_f32_16x16x32_bf16 v[52:55], v[232:235], v[236:239], v[52:55]
    ds_read_b64_tr_b16 v[164:165], v16 offset:46080
    v_mfma_f32_16x16x32_bf16 v[56:59], v[104:107], v[236:239], v[56:59]
    s_add_u32 s44, s44, 9216
    buffer_load_dwordx4 v254, s[32:35], s44 offen offset:2048 lds
    ds_read_b64_tr_b16 v[166:167], v16 offset:48128
    v_mfma_f32_16x16x32_bf16 v[60:63], v[108:111], v[236:239], v[60:63]
    ds_read_b64_tr_b16 v[168:169], v17 offset:46080
    v_mfma_f32_16x16x32_bf16 v[64:67], v[212:215], v[240:243], v[64:67]
    s_add_u32 s44, s44, 9216
    buffer_load_dwordx4 v255, s[32:35], s44 offen offset:3072 lds
    ds_read_b64_tr_b16 v[170:171], v17 offset:48128
    v_mfma_f32_16x16x32_bf16 v[68:71], v[216:219], v[240:243], v[68:71]
    ds_read_b128 v[172:175], v19 offset:50176
    v_mfma_f32_16x16x32_bf16 v[72:75], v[232:235], v[240:243], v[72:75]
    s_add_u32 m0, m0, 4096
    s_add_u32 s44, s44, s69
    buffer_load_dwordx4 v254, s[32:35], s44 offen offset:0 lds
    v_mfma_f32_16x16x32_bf16 v[76:79], v[104:107], v[240:243], v[76:79]
    v_mfma_f32_16x16x32_bf16 v[80:83], v[108:111], v[240:243], v[80:83]
    v_mfma_f32_16x16x32_bf16 v[84:87], v[212:215], v[244:247], v[84:87]
    s_add_u32 s44, s44, 9216
    buffer_load_dwordx4 v255, s[32:35], s44 offen offset:1024 lds
    v_mfma_f32_16x16x32_bf16 v[88:91], v[216:219], v[244:247], v[88:91]
    v_mfma_f32_16x16x32_bf16 v[92:95], v[232:235], v[244:247], v[92:95]
    s_add_u32 m0, s73, 40960
    s_add_u32 s44, s70, 450560
    buffer_load_dwordx4 v0, s[36:39], s44 offen offset:0 lds
    v_mfma_f32_16x16x32_bf16 v[96:99], v[104:107], v[244:247], v[96:99]
    v_mfma_f32_16x16x32_bf16 v[100:103], v[108:111], v[244:247], v[100:103]
    s_waitcnt lgkmcnt(0)
    v_mfma_f32_16x16x32_bf16 v[24:27], v[184:187], v[248:251], v[24:27]
    buffer_load_dword v22, v4, s[28:31], s79 offen sc1
    v_mfma_f32_16x16x32_bf16 v[28:31], v[188:191], v[248:251], v[28:31]
    v_mfma_f32_16x16x32_bf16 v[32:35], v[192:195], v[248:251], v[32:35]
    v_mfma_f32_16x16x32_bf16 v[36:39], v[196:199], v[248:251], v[36:39]
    s_add_u32 s44, s70, 459776
    buffer_load_dwordx4 v0, s[36:39], s44 offen offset:1024 lds
    v_add_u32 v3, 0x14000, v3
    v_mfma_f32_16x16x32_bf16 v[40:43], v[200:203], v[248:251], v[40:43]
    v_add_u32 v7, 0x14000, v7
    v_mfma_f32_16x16x32_bf16 v[44:47], v[184:187], v[144:147], v[44:47]
    s_add_u32 s44, s70, 468992
    buffer_load_dwordx4 v0, s[36:39], s44 offen offset:2048 lds
    v_add_u32 v16, 0x14000, v16
    v_mfma_f32_16x16x32_bf16 v[48:51], v[188:191], v[144:147], v[48:51]
    v_add_u32 v17, 0x14000, v17
    v_mfma_f32_16x16x32_bf16 v[52:55], v[192:195], v[144:147], v[52:55]
    v_add_u32 v19, 0x14000, v19
    v_mfma_f32_16x16x32_bf16 v[56:59], v[196:199], v[144:147], v[56:59]
    s_add_u32 s44, s70, 478208
    buffer_load_dwordx4 v0, s[36:39], s44 offen offset:3072 lds
    ds_read_b64_tr_b16 v[224:225], v3 offset:0
    v_mfma_f32_16x16x32_bf16 v[60:63], v[200:203], v[144:147], v[60:63]
    ds_read_b64_tr_b16 v[226:227], v3 offset:2048
    v_mfma_f32_16x16x32_bf16 v[64:67], v[184:187], v[148:151], v[64:67]
    s_add_u32 m0, s73, 45056
    s_add_u32 s44, s67, 11264
    buffer_load_dwordx4 v9, s[28:31], s44 offen sc1 lds
    ds_read_b64_tr_b16 v[228:229], v7 offset:0
    v_mfma_f32_16x16x32_bf16 v[68:71], v[188:191], v[148:151], v[68:71]
    ds_read_b64_tr_b16 v[230:231], v7 offset:2048
    v_mfma_f32_16x16x32_bf16 v[72:75], v[192:195], v[148:151], v[72:75]
    s_add_u32 s45, s84, 40960
    buffer_load_dwordx4 v[176:179], v12, s[28:31], s45 offen sc1
    ds_read_b64_tr_b16 v[212:213], v16 offset:0
    v_mfma_f32_16x16x32_bf16 v[76:79], v[196:199], v[148:151], v[76:79]
    ds_read_b64_tr_b16 v[214:215], v16 offset:2048
    v_mfma_f32_16x16x32_bf16 v[80:83], v[200:203], v[148:151], v[80:83]
    ds_read_b64_tr_b16 v[216:217], v17 offset:0
    v_mfma_f32_16x16x32_bf16 v[84:87], v[184:187], v[152:155], v[84:87]
    buffer_load_dwordx4 v[180:183], v13, s[28:31], s45 offen sc1
    ds_read_b64_tr_b16 v[218:219], v17 offset:2048
    v_mfma_f32_16x16x32_bf16 v[88:91], v[188:191], v[152:155], v[88:91]
    ds_read_b128 v[232:235], v19 offset:4096
    v_mfma_f32_16x16x32_bf16 v[92:95], v[192:195], v[152:155], v[92:95]
    buffer_load_dwordx4 v[140:143], v14, s[28:31], s45 offen sc1
    v_mfma_f32_16x16x32_bf16 v[96:99], v[196:199], v[152:155], v[96:99]
    v_mfma_f32_16x16x32_bf16 v[100:103], v[200:203], v[152:155], v[100:103]
    s_waitcnt vmcnt(7)
    v_cmp_ne_u32 vcc, s4, v22
    s_nop 4
    s_cbranch_vccnz parallel_sum__ssm_conv_s5__geglu_ffn__prompt_kernel_late_33
    s_waitcnt lgkmcnt(0)
    v_mfma_f32_16x16x32_bf16 v[24:27], v[132:135], v[156:159], v[24:27]
    buffer_load_dwordx4 v[220:223], v15, s[28:31], s45 offen sc1
    v_mfma_f32_16x16x32_bf16 v[28:31], v[136:139], v[156:159], v[28:31]
    v_mfma_f32_16x16x32_bf16 v[32:35], v[164:167], v[156:159], v[32:35]
    v_mfma_f32_16x16x32_bf16 v[36:39], v[168:171], v[156:159], v[36:39]
    s_add_u32 s45, s84, 45056
    buffer_load_dwordx4 v[104:107], v12, s[28:31], s45 offen sc1
    ds_read_b64_tr_b16 v[240:241], v3 offset:5120
    v_mfma_f32_16x16x32_bf16 v[40:43], v[172:175], v[156:159], v[40:43]
    ds_read_b64_tr_b16 v[242:243], v3 offset:7168
    v_mfma_f32_16x16x32_bf16 v[44:47], v[132:135], v[160:163], v[44:47]
    buffer_load_dwordx4 v[108:111], v13, s[28:31], s45 offen sc1
    ds_read_b64_tr_b16 v[244:245], v7 offset:5120
    v_mfma_f32_16x16x32_bf16 v[48:51], v[136:139], v[160:163], v[48:51]
    ds_read_b64_tr_b16 v[246:247], v7 offset:7168
    v_mfma_f32_16x16x32_bf16 v[52:55], v[164:167], v[160:163], v[52:55]
    ds_read_b64_tr_b16 v[184:185], v16 offset:5120
    v_mfma_f32_16x16x32_bf16 v[56:59], v[168:171], v[160:163], v[56:59]
    buffer_load_dwordx4 v[120:123], v14, s[28:31], s45 offen sc1
    ds_read_b64_tr_b16 v[186:187], v16 offset:7168
    v_mfma_f32_16x16x32_bf16 v[60:63], v[172:175], v[160:163], v[60:63]
    ds_read_b64_tr_b16 v[188:189], v17 offset:5120
    v_mfma_f32_16x16x32_bf16 v[64:67], v[132:135], v[204:207], v[64:67]
    buffer_load_dwordx4 v[236:239], v15, s[28:31], s45 offen sc1
    ds_read_b64_tr_b16 v[190:191], v17 offset:7168
    v_mfma_f32_16x16x32_bf16 v[68:71], v[136:139], v[204:207], v[68:71]
    ds_read_b128 v[192:195], v19 offset:9216
    v_mfma_f32_16x16x32_bf16 v[72:75], v[164:167], v[204:207], v[72:75]
    s_add_u32 s45, s85, 0
    buffer_load_dwordx4 v[196:199], v12, s[28:31], s45 offen sc1
    v_mfma_f32_16x16x32_bf16 v[76:79], v[168:171], v[204:207], v[76:79]
    v_mfma_f32_16x16x32_bf16 v[80:83], v[172:175], v[204:207], v[80:83]
    v_mfma_f32_16x16x32_bf16 v[84:87], v[132:135], v[208:211], v[84:87]
    buffer_load_dwordx4 v[200:203], v13, s[28:31], s45 offen sc1
    v_mfma_f32_16x16x32_bf16 v[88:91], v[136:139], v[208:211], v[88:91]
    v_mfma_f32_16x16x32_bf16 v[92:95], v[164:167], v[208:211], v[92:95]
    buffer_load_dwordx4 v[248:251], v14, s[28:31], s45 offen sc1
    v_mfma_f32_16x16x32_bf16 v[96:99], v[168:171], v[208:211], v[96:99]
    v_mfma_f32_16x16x32_bf16 v[100:103], v[172:175], v[208:211], v[100:103]
    s_waitcnt lgkmcnt(0)
    v_mfma_f32_16x16x32_bf16 v[24:27], v[224:227], v[112:115], v[24:27]
    buffer_load_dwordx4 v[144:147], v15, s[28:31], s45 offen sc1
    v_mfma_f32_16x16x32_bf16 v[28:31], v[228:231], v[112:115], v[28:31]
    v_mfma_f32_16x16x32_bf16 v[32:35], v[212:215], v[112:115], v[32:35]
    v_mfma_f32_16x16x32_bf16 v[36:39], v[216:219], v[112:115], v[36:39]
    s_add_u32 s45, s85, 4096
    buffer_load_dwordx4 v[168:171], v12, s[28:31], s45 offen sc1
    s_waitcnt vmcnt(13)
    v_add_u32 v3, 0xfffec000, v3
    v_mfma_f32_16x16x32_bf16 v[40:43], v[232:235], v[112:115], v[40:43]
    v_add_u32 v7, 0xfffec000, v7
    v_mfma_f32_16x16x32_bf16 v[44:47], v[224:227], v[116:119], v[44:47]
    buffer_load_dwordx4 v[172:175], v13, s[28:31], s45 offen sc1
    v_add_u32 v16, 0xfffec000, v16
    v_mfma_f32_16x16x32_bf16 v[48:51], v[228:231], v[116:119], v[48:51]
    v_add_u32 v17, 0xfffec000, v17
    v_mfma_f32_16x16x32_bf16 v[52:55], v[212:215], v[116:119], v[52:55]
    v_add_u32 v19, 0xfffec000, v19
    v_mfma_f32_16x16x32_bf16 v[56:59], v[216:219], v[116:119], v[56:59]
    buffer_load_dwordx4 v[156:159], v14, s[28:31], s45 offen sc1
    ds_read_b64_tr_b16 v[148:149], v3 offset:40960
    v_mfma_f32_16x16x32_bf16 v[60:63], v[232:235], v[116:119], v[60:63]
    ds_read_b64_tr_b16 v[150:151], v3 offset:43008
    v_mfma_f32_16x16x32_bf16 v[64:67], v[224:227], v[124:127], v[64:67]
    buffer_load_dwordx4 v[160:163], v15, s[28:31], s45 offen sc1
    ds_read_b64_tr_b16 v[152:153], v7 offset:40960
    v_mfma_f32_16x16x32_bf16 v[68:71], v[228:231], v[124:127], v[68:71]
    ds_read_b64_tr_b16 v[154:155], v7 offset:43008
    v_mfma_f32_16x16x32_bf16 v[72:75], v[212:215], v[124:127], v[72:75]
    s_add_u32 m0, s73, 81920
    s_add_u32 s44, s66, 0
    buffer_load_dwordx4 v254, s[40:43], s44 offen offset:0 lds
    ds_read_b64_tr_b16 v[132:133], v16 offset:40960
    v_mfma_f32_16x16x32_bf16 v[76:79], v[216:219], v[124:127], v[76:79]
    ds_read_b64_tr_b16 v[134:135], v16 offset:43008
    v_mfma_f32_16x16x32_bf16 v[80:83], v[232:235], v[124:127], v[80:83]
    ds_read_b64_tr_b16 v[136:137], v17 offset:40960
    v_mfma_f32_16x16x32_bf16 v[84:87], v[224:227], v[128:131], v[84:87]
    s_add_u32 s44, s44, 9216
    buffer_load_dwordx4 v255, s[40:43], s44 offen offset:1024 lds
    ds_read_b64_tr_b16 v[138:139], v17 offset:43008
    v_mfma_f32_16x16x32_bf16 v[88:91], v[228:231], v[128:131], v[88:91]
    ds_read_b128 v[164:167], v19 offset:45056
    v_mfma_f32_16x16x32_bf16 v[92:95], v[212:215], v[128:131], v[92:95]
    s_add_u32 s44, s44, 9216
    buffer_load_dwordx4 v254, s[40:43], s44 offen offset:2048 lds
    v_mfma_f32_16x16x32_bf16 v[96:99], v[216:219], v[128:131], v[96:99]
    v_mfma_f32_16x16x32_bf16 v[100:103], v[232:235], v[128:131], v[100:103]
    s_waitcnt vmcnt(15)
    s_waitcnt lgkmcnt(0)
    v_mfma_f32_16x16x32_bf16 v[24:27], v[240:243], v[176:179], v[24:27]
    s_add_u32 s44, s44, 9216
    buffer_load_dwordx4 v255, s[40:43], s44 offen offset:3072 lds
    v_mfma_f32_16x16x32_bf16 v[28:31], v[244:247], v[176:179], v[28:31]
    v_mfma_f32_16x16x32_bf16 v[32:35], v[184:187], v[176:179], v[32:35]
    v_mfma_f32_16x16x32_bf16 v[36:39], v[188:191], v[176:179], v[36:39]
    s_add_u32 m0, m0, 4096
    s_add_u32 s44, s44, 13312
    buffer_load_dwordx4 v254, s[40:43], s44 offen offset:0 lds
    ds_read_b128 v[204:207], v20 offset:0
    v_mfma_f32_16x16x32_bf16 v[40:43], v[192:195], v[176:179], v[40:43]
    ds_read_b128 v[208:211], v20 offset:2048
    v_mfma_f32_16x16x32_bf16 v[44:47], v[240:243], v[180:183], v[44:47]
    s_add_u32 s44, s44, 9216
    buffer_load_dwordx4 v255, s[40:43], s44 offen offset:1024 lds
    ds_read_b128 v[224:227], v20 offset:4096
    v_mfma_f32_16x16x32_bf16 v[48:51], v[244:247], v[180:183], v[48:51]
    ds_read_b128 v[228:231], v20 offset:6144
    v_mfma_f32_16x16x32_bf16 v[52:55], v[184:187], v[180:183], v[52:55]
    ds_read_b128 v[212:215], v20 offset:8192
    v_mfma_f32_16x16x32_bf16 v[56:59], v[188:191], v[180:183], v[56:59]
    s_add_u32 s44, s44, 9216
    buffer_load_dwordx4 v254, s[40:43], s44 offen offset:2048 lds
    v_mfma_f32_16x16x32_bf16 v[60:63], v[192:195], v[180:183], v[60:63]
    v_mfma_f32_16x16x32_bf16 v[64:67], v[240:243], v[140:143], v[64:67]
    s_add_u32 s44, s44, 9216
    buffer_load_dwordx4 v255, s[40:43], s44 offen offset:3072 lds
    v_mfma_f32_16x16x32_bf16 v[68:71], v[244:247], v[140:143], v[68:71]
    v_mfma_f32_16x16x32_bf16 v[72:75], v[184:187], v[140:143], v[72:75]
    s_add_u32 m0, m0, 4096
    s_add_u32 s44, s44, s69
    buffer_load_dwordx4 v254, s[40:43], s44 offen offset:0 lds
    v_mfma_f32_16x16x32_bf16 v[76:79], v[188:191], v[140:143], v[76:79]
    v_mfma_f32_16x16x32_bf16 v[80:83], v[192:195], v[140:143], v[80:83]
    v_mfma_f32_16x16x32_bf16 v[84:87], v[240:243], v[220:223], v[84:87]
    s_add_u32 s44, s44, 9216
    buffer_load_dwordx4 v255, s[40:43], s44 offen offset:1024 lds
    v_mfma_f32_16x16x32_bf16 v[88:91], v[244:247], v[220:223], v[88:91]
    v_mfma_f32_16x16x32_bf16 v[92:95], v[184:187], v[220:223], v[92:95]
    s_add_u32 s45, s85, 8192
    buffer_load_dwordx4 v[216:219], v12, s[28:31], s45 offen sc1
    v_mfma_f32_16x16x32_bf16 v[96:99], v[188:191], v[220:223], v[96:99]
    v_mfma_f32_16x16x32_bf16 v[100:103], v[192:195], v[220:223], v[100:103]
    s_waitcnt vmcnt(19)
    s_waitcnt lgkmcnt(0)
    v_mfma_f32_16x16x32_bf16 v[24:27], v[148:151], v[104:107], v[24:27]
    buffer_load_dwordx4 v[232:235], v13, s[28:31], s45 offen sc1
    v_mfma_f32_16x16x32_bf16 v[28:31], v[152:155], v[104:107], v[28:31]
    v_mfma_f32_16x16x32_bf16 v[32:35], v[132:135], v[104:107], v[32:35]
    v_mfma_f32_16x16x32_bf16 v[36:39], v[136:139], v[104:107], v[36:39]
    buffer_load_dwordx4 v[112:115], v14, s[28:31], s45 offen sc1
    ds_read_b128 v[124:127], v21 offset:0
    v_mfma_f32_16x16x32_bf16 v[40:43], v[164:167], v[104:107], v[40:43]
    ds_read_b128 v[128:131], v21 offset:2048
    v_mfma_f32_16x16x32_bf16 v[44:47], v[148:151], v[108:111], v[44:47]
    buffer_load_dwordx4 v[116:119], v15, s[28:31], s45 offen sc1
    ds_read_b128 v[240:243], v21 offset:4096
    v_mfma_f32_16x16x32_bf16 v[48:51], v[152:155], v[108:111], v[48:51]
    ds_read_b128 v[244:247], v21 offset:6144
    v_mfma_f32_16x16x32_bf16 v[52:55], v[132:135], v[108:111], v[52:55]
    ds_read_b128 v[184:187], v21 offset:8192
    v_mfma_f32_16x16x32_bf16 v[56:59], v[136:139], v[108:111], v[56:59]
    s_add_u32 m0, s73, 40960
    s_add_u32 s44, s86, 128
    buffer_load_dwordx4 v254, s[32:35], s44 offen offset:0 lds
    v_mfma_f32_16x16x32_bf16 v[60:63], v[164:167], v[108:111], v[60:63]
    v_mfma_f32_16x16x32_bf16 v[64:67], v[148:151], v[120:123], v[64:67]
    s_add_u32 s44, s44, 9216
    buffer_load_dwordx4 v255, s[32:35], s44 offen offset:1024 lds
    v_mfma_f32_16x16x32_bf16 v[68:71], v[152:155], v[120:123], v[68:71]
    v_mfma_f32_16x16x32_bf16 v[72:75], v[132:135], v[120:123], v[72:75]
    s_add_u32 s44, s44, 9216
    buffer_load_dwordx4 v254, s[32:35], s44 offen offset:2048 lds
    v_mfma_f32_16x16x32_bf16 v[76:79], v[136:139], v[120:123], v[76:79]
    v_mfma_f32_16x16x32_bf16 v[80:83], v[164:167], v[120:123], v[80:83]
    v_mfma_f32_16x16x32_bf16 v[84:87], v[148:151], v[236:239], v[84:87]
    s_add_u32 s44, s44, 9216
    buffer_load_dwordx4 v255, s[32:35], s44 offen offset:3072 lds
    v_mfma_f32_16x16x32_bf16 v[88:91], v[152:155], v[236:239], v[88:91]
    v_mfma_f32_16x16x32_bf16 v[92:95], v[132:135], v[236:239], v[92:95]
    s_add_u32 m0, m0, 4096
    s_add_u32 s44, s44, 13312
    buffer_load_dwordx4 v254, s[32:35], s44 offen offset:0 lds
    v_mfma_f32_16x16x32_bf16 v[96:99], v[136:139], v[236:239], v[96:99]
    v_mfma_f32_16x16x32_bf16 v[100:103], v[164:167], v[236:239], v[100:103]
    s_waitcnt vmcnt(23)
    s_waitcnt lgkmcnt(0)
    v_mfma_f32_16x16x32_bf16 v[24:27], v[204:207], v[196:199], v[24:27]
    s_add_u32 s44, s44, 9216
    buffer_load_dwordx4 v255, s[32:35], s44 offen offset:1024 lds
    v_mfma_f32_16x16x32_bf16 v[28:31], v[208:211], v[196:199], v[28:31]
    v_mfma_f32_16x16x32_bf16 v[32:35], v[224:227], v[196:199], v[32:35]
    v_mfma_f32_16x16x32_bf16 v[36:39], v[228:231], v[196:199], v[36:39]
    s_add_u32 s44, s44, 9216
    buffer_load_dwordx4 v254, s[32:35], s44 offen offset:2048 lds
    v_mfma_f32_16x16x32_bf16 v[40:43], v[212:215], v[196:199], v[40:43]
    v_mfma_f32_16x16x32_bf16 v[44:47], v[204:207], v[200:203], v[44:47]
    s_add_u32 s44, s44, 9216
    buffer_load_dwordx4 v255, s[32:35], s44 offen offset:3072 lds
    v_mfma_f32_16x16x32_bf16 v[48:51], v[208:211], v[200:203], v[48:51]
    v_mfma_f32_16x16x32_bf16 v[52:55], v[224:227], v[200:203], v[52:55]
    v_mfma_f32_16x16x32_bf16 v[56:59], v[228:231], v[200:203], v[56:59]
    s_add_u32 m0, m0, 4096
    s_add_u32 s44, s44, s69
    buffer_load_dwordx4 v254, s[32:35], s44 offen offset:0 lds
    v_mfma_f32_16x16x32_bf16 v[60:63], v[212:215], v[200:203], v[60:63]
    v_mfma_f32_16x16x32_bf16 v[64:67], v[204:207], v[248:251], v[64:67]
    s_add_u32 s44, s44, 9216
    buffer_load_dwordx4 v255, s[32:35], s44 offen offset:1024 lds
    v_mfma_f32_16x16x32_bf16 v[68:71], v[208:211], v[248:251], v[68:71]
    v_mfma_f32_16x16x32_bf16 v[72:75], v[224:227], v[248:251], v[72:75]
    s_add_u32 s45, s85, 12288
    buffer_load_dwordx4 v[188:191], v12, s[28:31], s45 offen sc1
    v_mfma_f32_16x16x32_bf16 v[76:79], v[228:231], v[248:251], v[76:79]
    v_mfma_f32_16x16x32_bf16 v[80:83], v[212:215], v[248:251], v[80:83]
    v_mfma_f32_16x16x32_bf16 v[84:87], v[204:207], v[144:147], v[84:87]
    buffer_load_dwordx4 v[192:195], v13, s[28:31], s45 offen sc1
    v_mfma_f32_16x16x32_bf16 v[88:91], v[208:211], v[144:147], v[88:91]
    v_mfma_f32_16x16x32_bf16 v[92:95], v[224:227], v[144:147], v[92:95]
    buffer_load_dwordx4 v[176:179], v14, s[28:31], s45 offen sc1
    v_mfma_f32_16x16x32_bf16 v[96:99], v[228:231], v[144:147], v[96:99]
    v_mfma_f32_16x16x32_bf16 v[100:103], v[212:215], v[144:147], v[100:103]
    s_waitcnt vmcnt(27)
    v_mfma_f32_16x16x32_bf16 v[24:27], v[124:127], v[168:171], v[24:27]
    buffer_load_dwordx4 v[180:183], v15, s[28:31], s45 offen sc1
    v_mfma_f32_16x16x32_bf16 v[28:31], v[128:131], v[168:171], v[28:31]
    v_mfma_f32_16x16x32_bf16 v[32:35], v[240:243], v[168:171], v[32:35]
    v_mfma_f32_16x16x32_bf16 v[36:39], v[244:247], v[168:171], v[36:39]
    s_add_u32 s45, s85, 16384
    buffer_load_dwordx4 v[140:143], v12, s[28:31], s45 offen sc1
    s_waitcnt vmcnt(19)
    ds_read_b128 v[108:111], v6 offset:0
    v_mfma_f32_16x16x32_bf16 v[40:43], v[184:187], v[168:171], v[40:43]
    ds_read_b128 v[120:123], v6 offset:2048
    v_mfma_f32_16x16x32_bf16 v[44:47], v[124:127], v[172:175], v[44:47]
    buffer_load_dwordx4 v[220:223], v13, s[28:31], s45 offen sc1
    ds_read_b128 v[236:239], v6 offset:4096
    v_mfma_f32_16x16x32_bf16 v[48:51], v[128:131], v[172:175], v[48:51]
    ds_read_b128 v[204:207], v6 offset:6144
    v_mfma_f32_16x16x32_bf16 v[52:55], v[240:243], v[172:175], v[52:55]
    ds_read_b128 v[208:211], v6 offset:8192
    v_mfma_f32_16x16x32_bf16 v[56:59], v[244:247], v[172:175], v[56:59]
    buffer_load_dwordx4 v[148:151], v14, s[28:31], s45 offen sc1
    v_mfma_f32_16x16x32_bf16 v[60:63], v[184:187], v[172:175], v[60:63]
    v_mfma_f32_16x16x32_bf16 v[64:67], v[124:127], v[156:159], v[64:67]
    buffer_load_dwordx4 v[152:155], v15, s[28:31], s45 offen sc1
    v_mfma_f32_16x16x32_bf16 v[68:71], v[128:131], v[156:159], v[68:71]
    v_mfma_f32_16x16x32_bf16 v[72:75], v[240:243], v[156:159], v[72:75]
    s_add_u32 s45, s85, 20480
    buffer_load_dwordx4 v[132:135], v12, s[28:31], s45 offen sc1
    v_mfma_f32_16x16x32_bf16 v[76:79], v[244:247], v[156:159], v[76:79]
    v_mfma_f32_16x16x32_bf16 v[80:83], v[184:187], v[156:159], v[80:83]
    v_mfma_f32_16x16x32_bf16 v[84:87], v[124:127], v[160:163], v[84:87]
    buffer_load_dwordx4 v[136:139], v13, s[28:31], s45 offen sc1
    v_mfma_f32_16x16x32_bf16 v[88:91], v[128:131], v[160:163], v[88:91]
    v_mfma_f32_16x16x32_bf16 v[92:95], v[240:243], v[160:163], v[92:95]
    buffer_load_dwordx4 v[164:167], v14, s[28:31], s45 offen sc1
    v_mfma_f32_16x16x32_bf16 v[96:99], v[244:247], v[160:163], v[96:99]
    v_mfma_f32_16x16x32_bf16 v[100:103], v[184:187], v[160:163], v[100:103]
    s_waitcnt vmcnt(21)
    s_waitcnt lgkmcnt(0)
    v_mfma_f32_16x16x32_bf16 v[24:27], v[108:111], v[216:219], v[24:27]
    buffer_load_dwordx4 v[104:107], v15, s[28:31], s45 offen sc1
    v_mfma_f32_16x16x32_bf16 v[28:31], v[120:123], v[216:219], v[28:31]
    v_mfma_f32_16x16x32_bf16 v[32:35], v[236:239], v[216:219], v[32:35]
    v_mfma_f32_16x16x32_bf16 v[36:39], v[204:207], v[216:219], v[36:39]
    s_add_u32 m0, s73, 0
    s_add_u32 s44, s66, 128
    buffer_load_dwordx4 v254, s[40:43], s44 offen offset:0 lds
    ds_read_b128 v[200:203], v8 offset:0
    v_mfma_f32_16x16x32_bf16 v[40:43], v[208:211], v[216:219], v[40:43]
    ds_read_b128 v[248:251], v8 offset:2048
    v_mfma_f32_16x16x32_bf16 v[44:47], v[108:111], v[232:235], v[44:47]
    s_add_u32 s44, s44, 9216
    buffer_load_dwordx4 v255, s[40:43], s44 offen offset:1024 lds
    ds_read_b128 v[144:147], v8 offset:4096
    v_mfma_f32_16x16x32_bf16 v[48:51], v[120:123], v[232:235], v[48:51]
    ds_read_b128 v[124:127], v8 offset:6144
    v_mfma_f32_16x16x32_bf16 v[52:55], v[236:239], v[232:235], v[52:55]
    ds_read_b128 v[128:131], v8 offset:8192
    v_mfma_f32_16x16x32_bf16 v[56:59], v[204:207], v[232:235], v[56:59]
    s_add_u32 s44, s44, 9216
    buffer_load_dwordx4 v254, s[40:43], s44 offen offset:2048 lds
    v_mfma_f32_16x16x32_bf16 v[60:63], v[208:211], v[232:235], v[60:63]
    v_mfma_f32_16x16x32_bf16 v[64:67], v[108:111], v[112:115], v[64:67]
    s_add_u32 s44, s44, 9216
    buffer_load_dwordx4 v255, s[40:43], s44 offen offset:3072 lds
    v_mfma_f32_16x16x32_bf16 v[68:71], v[120:123], v[112:115], v[68:71]
    v_mfma_f32_16x16x32_bf16 v[72:75], v[236:239], v[112:115], v[72:75]
    s_add_u32 m0, m0, 4096
    s_add_u32 s44, s44, 13312
    buffer_load_dwordx4 v254, s[40:43], s44 offen offset:0 lds
    v_mfma_f32_16x16x32_bf16 v[76:79], v[204:207], v[112:115], v[76:79]
    v_mfma_f32_16x16x32_bf16 v[80:83], v[208:211], v[112:115], v[80:83]
    v_mfma_f32_16x16x32_bf16 v[84:87], v[108:111], v[116:119], v[84:87]
    s_add_u32 s44, s44, 9216
    buffer_load_dwordx4 v255, s[40:43], s44 offen offset:1024 lds
    v_mfma_f32_16x16x32_bf16 v[88:91], v[120:123], v[116:119], v[88:91]
    v_mfma_f32_16x16x32_bf16 v[92:95], v[236:239], v[116:119], v[92:95]
    s_add_u32 s44, s44, 9216
    buffer_load_dwordx4 v254, s[40:43], s44 offen offset:2048 lds
    v_mfma_f32_16x16x32_bf16 v[96:99], v[204:207], v[116:119], v[96:99]
    v_mfma_f32_16x16x32_bf16 v[100:103], v[208:211], v[116:119], v[100:103]
    s_waitcnt vmcnt(15)
    s_waitcnt lgkmcnt(0)
    v_mfma_f32_16x16x32_bf16 v[24:27], v[200:203], v[188:191], v[24:27]
    s_add_u32 s44, s44, 9216
    buffer_load_dwordx4 v255, s[40:43], s44 offen offset:3072 lds
    v_mfma_f32_16x16x32_bf16 v[28:31], v[248:251], v[188:191], v[28:31]
    v_mfma_f32_16x16x32_bf16 v[32:35], v[144:147], v[188:191], v[32:35]
    v_mfma_f32_16x16x32_bf16 v[36:39], v[124:127], v[188:191], v[36:39]
    s_add_u32 m0, m0, 4096
    s_add_u32 s44, s44, s69
    buffer_load_dwordx4 v254, s[40:43], s44 offen offset:0 lds
    ds_read_b128 v[172:175], v20 offset:40960
    v_mfma_f32_16x16x32_bf16 v[40:43], v[128:131], v[188:191], v[40:43]
    ds_read_b128 v[156:159], v20 offset:43008
    v_mfma_f32_16x16x32_bf16 v[44:47], v[200:203], v[192:195], v[44:47]
    s_add_u32 s44, s44, 9216
    buffer_load_dwordx4 v255, s[40:43], s44 offen offset:1024 lds
    ds_read_b128 v[160:163], v20 offset:45056
    v_mfma_f32_16x16x32_bf16 v[48:51], v[248:251], v[192:195], v[48:51]
    ds_read_b128 v[108:111], v20 offset:47104
    v_mfma_f32_16x16x32_bf16 v[52:55], v[144:147], v[192:195], v[52:55]
    ds_read_b128 v[120:123], v20 offset:49152
    v_mfma_f32_16x16x32_bf16 v[56:59], v[124:127], v[192:195], v[56:59]
    s_add_u32 s45, s85, 24576
    buffer_load_dwordx4 v[224:227], v12, s[28:31], s45 offen sc1
    v_mfma_f32_16x16x32_bf16 v[60:63], v[128:131], v[192:195], v[60:63]
    v_mfma_f32_16x16x32_bf16 v[64:67], v[200:203], v[176:179], v[64:67]
    buffer_load_dwordx4 v[228:231], v13, s[28:31], s45 offen sc1
    v_mfma_f32_16x16x32_bf16 v[68:71], v[248:251], v[176:179], v[68:71]
    v_mfma_f32_16x16x32_bf16 v[72:75], v[144:147], v[176:179], v[72:75]
    buffer_load_dwordx4 v[212:215], v14, s[28:31], s45 offen sc1
    v_mfma_f32_16x16x32_bf16 v[76:79], v[124:127], v[176:179], v[76:79]
    v_mfma_f32_16x16x32_bf16 v[80:83], v[128:131], v[176:179], v[80:83]
    v_mfma_f32_16x16x32_bf16 v[84:87], v[200:203], v[180:183], v[84:87]
    buffer_load_dwordx4 v[196:199], v15, s[28:31], s45 offen sc1
    v_mfma_f32_16x16x32_bf16 v[88:91], v[248:251], v[180:183], v[88:91]
    v_mfma_f32_16x16x32_bf16 v[92:95], v[144:147], v[180:183], v[92:95]
    s_add_u32 s45, s85, 28672
    buffer_load_dwordx4 v[240:243], v12, s[28:31], s45 offen sc1
    v_mfma_f32_16x16x32_bf16 v[96:99], v[124:127], v[180:183], v[96:99]
    v_mfma_f32_16x16x32_bf16 v[100:103], v[128:131], v[180:183], v[100:103]
    s_waitcnt vmcnt(19)
    s_waitcnt lgkmcnt(0)
    v_mfma_f32_16x16x32_bf16 v[24:27], v[172:175], v[140:143], v[24:27]
    buffer_load_dwordx4 v[244:247], v13, s[28:31], s45 offen sc1
    v_mfma_f32_16x16x32_bf16 v[28:31], v[156:159], v[140:143], v[28:31]
    v_mfma_f32_16x16x32_bf16 v[32:35], v[160:163], v[140:143], v[32:35]
    v_mfma_f32_16x16x32_bf16 v[36:39], v[108:111], v[140:143], v[36:39]
    buffer_load_dwordx4 v[184:187], v14, s[28:31], s45 offen sc1
    ds_read_b128 v[232:235], v21 offset:40960
    v_mfma_f32_16x16x32_bf16 v[40:43], v[120:123], v[140:143], v[40:43]
    ds_read_b128 v[112:115], v21 offset:43008
    v_mfma_f32_16x16x32_bf16 v[44:47], v[172:175], v[220:223], v[44:47]
    buffer_load_dwordx4 v[168:171], v15, s[28:31], s45 offen sc1
    ds_read_b128 v[116:119], v21 offset:45056
    v_mfma_f32_16x16x32_bf16 v[48:51], v[156:159], v[220:223], v[48:51]
    ds_read_b128 v[200:203], v21 offset:47104
    v_mfma_f32_16x16x32_bf16 v[52:55], v[160:163], v[220:223], v[52:55]
    ds_read_b128 v[248:251], v21 offset:49152
    v_mfma_f32_16x16x32_bf16 v[56:59], v[108:111], v[220:223], v[56:59]
    s_add_u32 m0, s73, 81920
    s_add_u32 s44, s86, 256
    buffer_load_dwordx4 v254, s[32:35], s44 offen offset:0 lds
    v_mfma_f32_16x16x32_bf16 v[60:63], v[120:123], v[220:223], v[60:63]
    v_mfma_f32_16x16x32_bf16 v[64:67], v[172:175], v[148:151], v[64:67]
    s_add_u32 s44, s44, 9216
    buffer_load_dwordx4 v255, s[32:35], s44 offen offset:1024 lds
    v_mfma_f32_16x16x32_bf16 v[68:71], v[156:159], v[148:151], v[68:71]
    v_mfma_f32_16x16x32_bf16 v[72:75], v[160:163], v[148:151], v[72:75]
    s_add_u32 s44, s44, 9216
    buffer_load_dwordx4 v254, s[32:35], s44 offen offset:2048 lds
    v_mfma_f32_16x16x32_bf16 v[76:79], v[108:111], v[148:151], v[76:79]
    v_mfma_f32_16x16x32_bf16 v[80:83], v[120:123], v[148:151], v[80:83]
    v_mfma_f32_16x16x32_bf16 v[84:87], v[172:175], v[152:155], v[84:87]
    s_add_u32 s44, s44, 9216
    buffer_load_dwordx4 v255, s[32:35], s44 offen offset:3072 lds
    v_mfma_f32_16x16x32_bf16 v[88:91], v[156:159], v[152:155], v[88:91]
    v_mfma_f32_16x16x32_bf16 v[92:95], v[160:163], v[152:155], v[92:95]
    s_add_u32 m0, m0, 4096
    s_add_u32 s44, s44, 13312
    buffer_load_dwordx4 v254, s[32:35], s44 offen offset:0 lds
    v_mfma_f32_16x16x32_bf16 v[96:99], v[108:111], v[152:155], v[96:99]
    v_mfma_f32_16x16x32_bf16 v[100:103], v[120:123], v[152:155], v[100:103]
    s_waitcnt vmcnt(23)
    s_waitcnt lgkmcnt(0)
    v_mfma_f32_16x16x32_bf16 v[24:27], v[232:235], v[132:135], v[24:27]
    s_add_u32 s44, s44, 9216
    buffer_load_dwordx4 v255, s[32:35], s44 offen offset:1024 lds
    v_mfma_f32_16x16x32_bf16 v[28:31], v[112:115], v[132:135], v[28:31]
    v_mfma_f32_16x16x32_bf16 v[32:35], v[116:119], v[132:135], v[32:35]
    v_mfma_f32_16x16x32_bf16 v[36:39], v[200:203], v[132:135], v[36:39]
    s_add_u32 s44, s44, 9216
    buffer_load_dwordx4 v254, s[32:35], s44 offen offset:2048 lds
    s_waitcnt vmcnt(15)
    ds_read_b128 v[192:195], v20 offset:0
    v_mfma_f32_16x16x32_bf16 v[40:43], v[248:251], v[132:135], v[40:43]
    ds_read_b128 v[176:179], v20 offset:2048
    v_mfma_f32_16x16x32_bf16 v[44:47], v[232:235], v[136:139], v[44:47]
    s_add_u32 s44, s44, 9216
    buffer_load_dwordx4 v255, s[32:35], s44 offen offset:3072 lds
    ds_read_b128 v[180:183], v20 offset:4096
    v_mfma_f32_16x16x32_bf16 v[48:51], v[112:115], v[136:139], v[48:51]
    ds_read_b128 v[172:175], v20 offset:6144
    v_mfma_f32_16x16x32_bf16 v[52:55], v[116:119], v[136:139], v[52:55]
    ds_read_b128 v[156:159], v20 offset:8192
    v_mfma_f32_16x16x32_bf16 v[56:59], v[200:203], v[136:139], v[56:59]
    s_add_u32 m0, m0, 4096
    s_add_u32 s44, s44, s69
    buffer_load_dwordx4 v254, s[32:35], s44 offen offset:0 lds
    v_mfma_f32_16x16x32_bf16 v[60:63], v[248:251], v[136:139], v[60:63]
    v_mfma_f32_16x16x32_bf16 v[64:67], v[232:235], v[164:167], v[64:67]
    s_add_u32 s44, s44, 9216
    buffer_load_dwordx4 v255, s[32:35], s44 offen offset:1024 lds
    v_mfma_f32_16x16x32_bf16 v[68:71], v[112:115], v[164:167], v[68:71]
    v_mfma_f32_16x16x32_bf16 v[72:75], v[116:119], v[164:167], v[72:75]
    s_add_u32 s45, s85, 32768
    buffer_load_dwordx4 v[236:239], v12, s[28:31], s45 offen sc1
    v_mfma_f32_16x16x32_bf16 v[76:79], v[200:203], v[164:167], v[76:79]
    v_mfma_f32_16x16x32_bf16 v[80:83], v[248:251], v[164:167], v[80:83]
    v_mfma_f32_16x16x32_bf16 v[84:87], v[232:235], v[104:107], v[84:87]
    buffer_load_dwordx4 v[204:207], v13, s[28:31], s45 offen sc1
    v_mfma_f32_16x16x32_bf16 v[88:91], v[112:115], v[104:107], v[88:91]
    v_mfma_f32_16x16x32_bf16 v[92:95], v[116:119], v[104:107], v[92:95]
    buffer_load_dwordx4 v[208:211], v14, s[28:31], s45 offen sc1
    v_mfma_f32_16x16x32_bf16 v[96:99], v[200:203], v[104:107], v[96:99]
    v_mfma_f32_16x16x32_bf16 v[100:103], v[248:251], v[104:107], v[100:103]
    s_waitcnt vmcnt(17)
    s_waitcnt lgkmcnt(0)
    v_mfma_f32_16x16x32_bf16 v[24:27], v[192:195], v[224:227], v[24:27]
    buffer_load_dwordx4 v[216:219], v15, s[28:31], s45 offen sc1
    v_mfma_f32_16x16x32_bf16 v[28:31], v[176:179], v[224:227], v[28:31]
    v_mfma_f32_16x16x32_bf16 v[32:35], v[180:183], v[224:227], v[32:35]
    v_mfma_f32_16x16x32_bf16 v[36:39], v[172:175], v[224:227], v[36:39]
    ds_read_b128 v[160:163], v21 offset:0
    v_mfma_f32_16x16x32_bf16 v[40:43], v[156:159], v[224:227], v[40:43]
    s_add_u32 s45, s85, 36864
    buffer_load_dwordx4 v[144:147], v12, s[28:31], s45 offen sc1
    ds_read_b128 v[108:111], v21 offset:2048
    v_mfma_f32_16x16x32_bf16 v[44:47], v[192:195], v[228:231], v[44:47]
    ds_read_b128 v[120:123], v21 offset:4096
    v_mfma_f32_16x16x32_bf16 v[48:51], v[176:179], v[228:231], v[48:51]
    ds_read_b128 v[140:143], v21 offset:6144
    v_mfma_f32_16x16x32_bf16 v[52:55], v[180:183], v[228:231], v[52:55]
    ds_read_b128 v[220:223], v21 offset:8192
    v_mfma_f32_16x16x32_bf16 v[56:59], v[172:175], v[228:231], v[56:59]
    buffer_load_dwordx4 v[124:127], v13, s[28:31], s45 offen sc1
    v_mfma_f32_16x16x32_bf16 v[60:63], v[156:159], v[228:231], v[60:63]
    v_mfma_f32_16x16x32_bf16 v[64:67], v[192:195], v[212:215], v[64:67]
    v_mfma_f32_16x16x32_bf16 v[68:71], v[176:179], v[212:215], v[68:71]
    v_mfma_f32_16x16x32_bf16 v[72:75], v[180:183], v[212:215], v[72:75]
    buffer_load_dwordx4 v[128:131], v14, s[28:31], s45 offen sc1
    v_mfma_f32_16x16x32_bf16 v[76:79], v[172:175], v[212:215], v[76:79]
    v_mfma_f32_16x16x32_bf16 v[80:83], v[156:159], v[212:215], v[80:83]
    v_mfma_f32_16x16x32_bf16 v[84:87], v[192:195], v[196:199], v[84:87]
    v_mfma_f32_16x16x32_bf16 v[88:91], v[176:179], v[196:199], v[88:91]
    buffer_load_dwordx4 v[188:191], v15, s[28:31], s45 offen sc1
    v_mfma_f32_16x16x32_bf16 v[92:95], v[180:183], v[196:199], v[92:95]
    v_mfma_f32_16x16x32_bf16 v[96:99], v[172:175], v[196:199], v[96:99]
    v_mfma_f32_16x16x32_bf16 v[100:103], v[156:159], v[196:199], v[100:103]
    s_waitcnt vmcnt(18)
    s_waitcnt lgkmcnt(0)
    v_mfma_f32_16x16x32_bf16 v[24:27], v[160:163], v[240:243], v[24:27]
    v_mfma_f32_16x16x32_bf16 v[28:31], v[108:111], v[240:243], v[28:31]
    v_mfma_f32_16x16x32_bf16 v[32:35], v[120:123], v[240:243], v[32:35]
    v_mfma_f32_16x16x32_bf16 v[36:39], v[140:143], v[240:243], v[36:39]
    s_waitcnt vmcnt(8)
    ds_read_b128 v[148:151], v6 offset:0
    v_mfma_f32_16x16x32_bf16 v[40:43], v[220:223], v[240:243], v[40:43]
    ds_read_b128 v[152:155], v6 offset:2048
    v_mfma_f32_16x16x32_bf16 v[44:47], v[160:163], v[244:247], v[44:47]
    ds_read_b128 v[232:235], v6 offset:4096
    v_mfma_f32_16x16x32_bf16 v[48:51], v[108:111], v[244:247], v[48:51]
    ds_read_b128 v[112:115], v6 offset:6144
    v_mfma_f32_16x16x32_bf16 v[52:55], v[120:123], v[244:247], v[52:55]
    ds_read_b128 v[116:119], v6 offset:8192
    v_mfma_f32_16x16x32_bf16 v[56:59], v[140:143], v[244:247], v[56:59]
    v_mfma_f32_16x16x32_bf16 v[60:63], v[220:223], v[244:247], v[60:63]
    v_mfma_f32_16x16x32_bf16 v[64:67], v[160:163], v[184:187], v[64:67]
    v_mfma_f32_16x16x32_bf16 v[68:71], v[108:111], v[184:187], v[68:71]
    v_mfma_f32_16x16x32_bf16 v[72:75], v[120:123], v[184:187], v[72:75]
    v_mfma_f32_16x16x32_bf16 v[76:79], v[140:143], v[184:187], v[76:79]
    v_mfma_f32_16x16x32_bf16 v[80:83], v[220:223], v[184:187], v[80:83]
    v_mfma_f32_16x16x32_bf16 v[84:87], v[160:163], v[168:171], v[84:87]
    v_mfma_f32_16x16x32_bf16 v[88:91], v[108:111], v[168:171], v[88:91]
    v_mfma_f32_16x16x32_bf16 v[92:95], v[120:123], v[168:171], v[92:95]
    v_mfma_f32_16x16x32_bf16 v[96:99], v[140:143], v[168:171], v[96:99]
    v_mfma_f32_16x16x32_bf16 v[100:103], v[220:223], v[168:171], v[100:103]
    s_waitcnt vmcnt(4)
    s_waitcnt lgkmcnt(0)
    v_mfma_f32_16x16x32_bf16 v[24:27], v[148:151], v[236:239], v[24:27]
    v_mfma_f32_16x16x32_bf16 v[28:31], v[152:155], v[236:239], v[28:31]
    v_mfma_f32_16x16x32_bf16 v[32:35], v[232:235], v[236:239], v[32:35]
    v_mfma_f32_16x16x32_bf16 v[36:39], v[112:115], v[236:239], v[36:39]
    ds_read_b128 v[200:203], v8 offset:0
    v_mfma_f32_16x16x32_bf16 v[40:43], v[116:119], v[236:239], v[40:43]
    ds_read_b128 v[248:251], v8 offset:2048
    v_mfma_f32_16x16x32_bf16 v[44:47], v[148:151], v[204:207], v[44:47]
    ds_read_b128 v[132:135], v8 offset:4096
    v_mfma_f32_16x16x32_bf16 v[48:51], v[152:155], v[204:207], v[48:51]
    ds_read_b128 v[136:139], v8 offset:6144
    v_mfma_f32_16x16x32_bf16 v[52:55], v[232:235], v[204:207], v[52:55]
    ds_read_b128 v[164:167], v8 offset:8192
    v_mfma_f32_16x16x32_bf16 v[56:59], v[112:115], v[204:207], v[56:59]
    v_mfma_f32_16x16x32_bf16 v[60:63], v[116:119], v[204:207], v[60:63]
    v_mfma_f32_16x16x32_bf16 v[64:67], v[148:151], v[208:211], v[64:67]
    v_mfma_f32_16x16x32_bf16 v[68:71], v[152:155], v[208:211], v[68:71]
    v_mfma_f32_16x16x32_bf16 v[72:75], v[232:235], v[208:211], v[72:75]
    v_mfma_f32_16x16x32_bf16 v[76:79], v[112:115], v[208:211], v[76:79]
    v_mfma_f32_16x16x32_bf16 v[80:83], v[116:119], v[208:211], v[80:83]
    v_mfma_f32_16x16x32_bf16 v[84:87], v[148:151], v[216:219], v[84:87]
    v_mfma_f32_16x16x32_bf16 v[88:91], v[152:155], v[216:219], v[88:91]
    v_mfma_f32_16x16x32_bf16 v[92:95], v[232:235], v[216:219], v[92:95]
    v_mfma_f32_16x16x32_bf16 v[96:99], v[112:115], v[216:219], v[96:99]
    v_mfma_f32_16x16x32_bf16 v[100:103], v[116:119], v[216:219], v[100:103]
    s_waitcnt vmcnt(0)
    s_waitcnt lgkmcnt(0)
    v_mfma_f32_16x16x32_bf16 v[44:47], v[200:203], v[124:127], v[44:47]
    v_mfma_f32_16x16x32_bf16 v[48:51], v[248:251], v[124:127], v[48:51]
    v_mfma_f32_16x16x32_bf16 v[52:55], v[132:135], v[124:127], v[52:55]
    v_mfma_f32_16x16x32_bf16 v[56:59], v[136:139], v[124:127], v[56:59]
    v_mfma_f32_16x16x32_bf16 v[60:63], v[164:167], v[124:127], v[60:63]
    v_mfma_f32_16x16x32_bf16 v[64:67], v[200:203], v[128:131], v[64:67]
    v_mfma_f32_16x16x32_bf16 v[68:71], v[248:251], v[128:131], v[68:71]
    v_mfma_f32_16x16x32_bf16 v[72:75], v[132:135], v[128:131], v[72:75]
    v_mfma_f32_16x16x32_bf16 v[76:79], v[136:139], v[128:131], v[76:79]
    ds_write_b128 v11, v[44:47] offset:5120
    v_mfma_f32_16x16x32_bf16 v[80:83], v[164:167], v[128:131], v[80:83]
    ds_write_b128 v11, v[48:51] offset:6144
    v_mfma_f32_16x16x32_bf16 v[84:87], v[200:203], v[188:191], v[84:87]
    ds_write_b128 v11, v[52:55] offset:7168
    v_mfma_f32_16x16x32_bf16 v[88:91], v[248:251], v[188:191], v[88:91]
    ds_write_b128 v11, v[56:59] offset:8192
    v_mfma_f32_16x16x32_bf16 v[92:95], v[132:135], v[188:191], v[92:95]
    ds_write_b128 v11, v[60:63] offset:9216
    v_mfma_f32_16x16x32_bf16 v[96:99], v[136:139], v[188:191], v[96:99]
    ds_write_b128 v11, v[64:67] offset:40960
    v_mfma_f32_16x16x32_bf16 v[100:103], v[164:167], v[188:191], v[100:103]
    ds_write_b128 v11, v[68:71] offset:41984
    v_mfma_f32_16x16x32_bf16 v[24:27], v[200:203], v[144:147], v[24:27]
    ds_write_b128 v11, v[72:75] offset:43008
    v_mfma_f32_16x16x32_bf16 v[28:31], v[248:251], v[144:147], v[28:31]
    ds_write_b128 v11, v[76:79] offset:44032
    v_mfma_f32_16x16x32_bf16 v[32:35], v[132:135], v[144:147], v[32:35]
    ds_write_b128 v11, v[80:83] offset:45056
    v_mfma_f32_16x16x32_bf16 v[36:39], v[136:139], v[144:147], v[36:39]
    ds_write_b128 v11, v[84:87] offset:46080
    v_mfma_f32_16x16x32_bf16 v[40:43], v[164:167], v[144:147], v[40:43]
    ds_write_b128 v11, v[88:91] offset:47104
    s_branch parallel_sum__ssm_conv_s5__geglu_ffn__prompt_kernel_red
parallel_sum__ssm_conv_s5__geglu_ffn__prompt_kernel_late_33:
    s_waitcnt lgkmcnt(0)
    v_mfma_f32_16x16x32_bf16 v[24:27], v[132:135], v[156:159], v[24:27]
    buffer_load_dwordx4 v[220:223], v15, s[28:31], s45 offen sc1
    v_mfma_f32_16x16x32_bf16 v[28:31], v[136:139], v[156:159], v[28:31]
    v_mfma_f32_16x16x32_bf16 v[32:35], v[164:167], v[156:159], v[32:35]
    v_mfma_f32_16x16x32_bf16 v[36:39], v[168:171], v[156:159], v[36:39]
    ds_read_b64_tr_b16 v[240:241], v3 offset:5120
    v_mfma_f32_16x16x32_bf16 v[40:43], v[172:175], v[156:159], v[40:43]
    s_add_u32 s45, s84, 45056
    buffer_load_dwordx4 v[104:107], v12, s[28:31], s45 offen sc1
    ds_read_b64_tr_b16 v[242:243], v3 offset:7168
    v_mfma_f32_16x16x32_bf16 v[44:47], v[132:135], v[160:163], v[44:47]
    ds_read_b64_tr_b16 v[244:245], v7 offset:5120
    v_mfma_f32_16x16x32_bf16 v[48:51], v[136:139], v[160:163], v[48:51]
    ds_read_b64_tr_b16 v[246:247], v7 offset:7168
    v_mfma_f32_16x16x32_bf16 v[52:55], v[164:167], v[160:163], v[52:55]
    ds_read_b64_tr_b16 v[184:185], v16 offset:5120
    v_mfma_f32_16x16x32_bf16 v[56:59], v[168:171], v[160:163], v[56:59]
    buffer_load_dwordx4 v[108:111], v13, s[28:31], s45 offen sc1
    ds_read_b64_tr_b16 v[186:187], v16 offset:7168
    v_mfma_f32_16x16x32_bf16 v[60:63], v[172:175], v[160:163], v[60:63]
    ds_read_b64_tr_b16 v[188:189], v17 offset:5120
    v_mfma_f32_16x16x32_bf16 v[64:67], v[132:135], v[204:207], v[64:67]
    ds_read_b64_tr_b16 v[190:191], v17 offset:7168
    v_mfma_f32_16x16x32_bf16 v[68:71], v[136:139], v[204:207], v[68:71]
    ds_read_b128 v[192:195], v19 offset:9216
    v_mfma_f32_16x16x32_bf16 v[72:75], v[164:167], v[204:207], v[72:75]
    buffer_load_dwordx4 v[120:123], v14, s[28:31], s45 offen sc1
    v_mfma_f32_16x16x32_bf16 v[76:79], v[168:171], v[204:207], v[76:79]
    v_mfma_f32_16x16x32_bf16 v[80:83], v[172:175], v[204:207], v[80:83]
    v_mfma_f32_16x16x32_bf16 v[84:87], v[132:135], v[208:211], v[84:87]
    v_mfma_f32_16x16x32_bf16 v[88:91], v[136:139], v[208:211], v[88:91]
    buffer_load_dwordx4 v[236:239], v15, s[28:31], s45 offen sc1
    v_mfma_f32_16x16x32_bf16 v[92:95], v[164:167], v[208:211], v[92:95]
    v_mfma_f32_16x16x32_bf16 v[96:99], v[168:171], v[208:211], v[96:99]
    v_mfma_f32_16x16x32_bf16 v[100:103], v[172:175], v[208:211], v[100:103]
    s_waitcnt lgkmcnt(0)
    v_mfma_f32_16x16x32_bf16 v[24:27], v[224:227], v[112:115], v[24:27]
    buffer_load_dword v22, v4, s[28:31], s79 offen sc1
    v_mfma_f32_16x16x32_bf16 v[28:31], v[228:231], v[112:115], v[28:31]
    v_mfma_f32_16x16x32_bf16 v[32:35], v[212:215], v[112:115], v[32:35]
    v_mfma_f32_16x16x32_bf16 v[36:39], v[216:219], v[112:115], v[36:39]
    s_add_u32 m0, s73, 81920
    s_add_u32 s44, s66, 0
    buffer_load_dwordx4 v254, s[40:43], s44 offen offset:0 lds
    s_waitcnt vmcnt(10)
    v_add_u32 v3, 0xfffec000, v3
    v_mfma_f32_16x16x32_bf16 v[40:43], v[232:235], v[112:115], v[40:43]
    v_add_u32 v7, 0xfffec000, v7
    v_mfma_f32_16x16x32_bf16 v[44:47], v[224:227], v[116:119], v[44:47]
    s_add_u32 s44, s44, 9216
    buffer_load_dwordx4 v255, s[40:43], s44 offen offset:1024 lds
    v_add_u32 v16, 0xfffec000, v16
    v_mfma_f32_16x16x32_bf16 v[48:51], v[228:231], v[116:119], v[48:51]
    v_add_u32 v17, 0xfffec000, v17
    v_mfma_f32_16x16x32_bf16 v[52:55], v[212:215], v[116:119], v[52:55]
    v_add_u32 v19, 0xfffec000, v19
    v_mfma_f32_16x16x32_bf16 v[56:59], v[216:219], v[116:119], v[56:59]
    s_add_u32 s44, s44, 9216
    buffer_load_dwordx4 v254, s[40:43], s44 offen offset:2048 lds
    ds_read_b64_tr_b16 v[196:197], v3 offset:40960
    v_mfma_f32_16x16x32_bf16 v[60:63], v[232:235], v[116:119], v[60:63]
    ds_read_b64_tr_b16 v[198:199], v3 offset:43008
    v_mfma_f32_16x16x32_bf16 v[64:67], v[224:227], v[124:127], v[64:67]
    s_add_u32 s44, s44, 9216
    buffer_load_dwordx4 v255, s[40:43], s44 offen offset:3072 lds
    ds_read_b64_tr_b16 v[200:201], v7 offset:40960
    v_mfma_f32_16x16x32_bf16 v[68:71], v[228:231], v[124:127], v[68:71]
    ds_read_b64_tr_b16 v[202:203], v7 offset:43008
    v_mfma_f32_16x16x32_bf16 v[72:75], v[212:215], v[124:127], v[72:75]
    s_add_u32 m0, m0, 4096
    s_add_u32 s44, s44, 13312
    buffer_load_dwordx4 v254, s[40:43], s44 offen offset:0 lds
    ds_read_b64_tr_b16 v[248:249], v16 offset:40960
    v_mfma_f32_16x16x32_bf16 v[76:79], v[216:219], v[124:127], v[76:79]
    ds_read_b64_tr_b16 v[250:251], v16 offset:43008
    v_mfma_f32_16x16x32_bf16 v[80:83], v[232:235], v[124:127], v[80:83]
    ds_read_b64_tr_b16 v[144:145], v17 offset:40960
    v_mfma_f32_16x16x32_bf16 v[84:87], v[224:227], v[128:131], v[84:87]
    s_add_u32 s44, s44, 9216
    buffer_load_dwordx4 v255, s[40:43], s44 offen offset:1024 lds
    ds_read_b64_tr_b16 v[146:147], v17 offset:43008
    v_mfma_f32_16x16x32_bf16 v[88:91], v[228:231], v[128:131], v[88:91]
    ds_read_b128 v[148:151], v19 offset:45056
    v_mfma_f32_16x16x32_bf16 v[92:95], v[212:215], v[128:131], v[92:95]
    s_add_u32 s44, s44, 9216
    buffer_load_dwordx4 v254, s[40:43], s44 offen offset:2048 lds
    v_mfma_f32_16x16x32_bf16 v[96:99], v[216:219], v[128:131], v[96:99]
    v_mfma_f32_16x16x32_bf16 v[100:103], v[232:235], v[128:131], v[100:103]
    s_waitcnt vmcnt(7)
    v_cmp_ne_u32 vcc, s4, v22
    s_nop 4
    s_cbranch_vccnz parallel_sum__ssm_conv_s5__geglu_ffn__prompt_kernel_late_34
    s_waitcnt lgkmcnt(0)
    v_mfma_f32_16x16x32_bf16 v[24:27], v[240:243], v[176:179], v[24:27]
    s_add_u32 s45, s85, 0
    buffer_load_dwordx4 v[172:175], v12, s[28:31], s45 offen sc1
    v_mfma_f32_16x16x32_bf16 v[28:31], v[244:247], v[176:179], v[28:31]
    v_mfma_f32_16x16x32_bf16 v[32:35], v[184:187], v[176:179], v[32:35]
    v_mfma_f32_16x16x32_bf16 v[36:39], v[188:191], v[176:179], v[36:39]
    buffer_load_dwordx4 v[156:159], v13, s[28:31], s45 offen sc1
    ds_read_b128 v[152:155], v20 offset:0
    v_mfma_f32_16x16x32_bf16 v[40:43], v[192:195], v[176:179], v[40:43]
    ds_read_b128 v[132:135], v20 offset:2048
    v_mfma_f32_16x16x32_bf16 v[44:47], v[240:243], v[180:183], v[44:47]
    buffer_load_dwordx4 v[160:163], v14, s[28:31], s45 offen sc1
    ds_read_b128 v[136:139], v20 offset:4096
    v_mfma_f32_16x16x32_bf16 v[48:51], v[244:247], v[180:183], v[48:51]
    ds_read_b128 v[164:167], v20 offset:6144
    v_mfma_f32_16x16x32_bf16 v[52:55], v[184:187], v[180:183], v[52:55]
    ds_read_b128 v[168:171], v20 offset:8192
    v_mfma_f32_16x16x32_bf16 v[56:59], v[188:191], v[180:183], v[56:59]
    buffer_load_dwordx4 v[204:207], v15, s[28:31], s45 offen sc1
    v_mfma_f32_16x16x32_bf16 v[60:63], v[192:195], v[180:183], v[60:63]
    v_mfma_f32_16x16x32_bf16 v[64:67], v[240:243], v[140:143], v[64:67]
    s_add_u32 s44, s44, 9216
    buffer_load_dwordx4 v255, s[40:43], s44 offen offset:3072 lds
    v_mfma_f32_16x16x32_bf16 v[68:71], v[244:247], v[140:143], v[68:71]
    v_mfma_f32_16x16x32_bf16 v[72:75], v[184:187], v[140:143], v[72:75]
    s_add_u32 m0, m0, 4096
    s_add_u32 s44, s44, s69
    buffer_load_dwordx4 v254, s[40:43], s44 offen offset:0 lds
    v_mfma_f32_16x16x32_bf16 v[76:79], v[188:191], v[140:143], v[76:79]
    v_mfma_f32_16x16x32_bf16 v[80:83], v[192:195], v[140:143], v[80:83]
    v_mfma_f32_16x16x32_bf16 v[84:87], v[240:243], v[220:223], v[84:87]
    s_add_u32 s44, s44, 9216
    buffer_load_dwordx4 v255, s[40:43], s44 offen offset:1024 lds
    v_mfma_f32_16x16x32_bf16 v[88:91], v[244:247], v[220:223], v[88:91]
    v_mfma_f32_16x16x32_bf16 v[92:95], v[184:187], v[220:223], v[92:95]
    s_add_u32 s45, s85, 4096
    buffer_load_dwordx4 v[208:211], v12, s[28:31], s45 offen sc1
    v_mfma_f32_16x16x32_bf16 v[96:99], v[188:191], v[220:223], v[96:99]
    v_mfma_f32_16x16x32_bf16 v[100:103], v[192:195], v[220:223], v[100:103]
    s_waitcnt lgkmcnt(0)
    v_mfma_f32_16x16x32_bf16 v[24:27], v[196:199], v[104:107], v[24:27]
    buffer_load_dwordx4 v[224:227], v13, s[28:31], s45 offen sc1
    v_mfma_f32_16x16x32_bf16 v[28:31], v[200:203], v[104:107], v[28:31]
    v_mfma_f32_16x16x32_bf16 v[32:35], v[248:251], v[104:107], v[32:35]
    v_mfma_f32_16x16x32_bf16 v[36:39], v[144:147], v[104:107], v[36:39]
    buffer_load_dwordx4 v[228:231], v14, s[28:31], s45 offen sc1
    ds_read_b128 v[124:127], v21 offset:0
    v_mfma_f32_16x16x32_bf16 v[40:43], v[148:151], v[104:107], v[40:43]
    ds_read_b128 v[128:131], v21 offset:2048
    v_mfma_f32_16x16x32_bf16 v[44:47], v[196:199], v[108:111], v[44:47]
    buffer_load_dwordx4 v[212:215], v15, s[28:31], s45 offen sc1
    ds_read_b128 v[240:243], v21 offset:4096
    v_mfma_f32_16x16x32_bf16 v[48:51], v[200:203], v[108:111], v[48:51]
    ds_read_b128 v[244:247], v21 offset:6144
    v_mfma_f32_16x16x32_bf16 v[52:55], v[248:251], v[108:111], v[52:55]
    ds_read_b128 v[184:187], v21 offset:8192
    v_mfma_f32_16x16x32_bf16 v[56:59], v[144:147], v[108:111], v[56:59]
    s_add_u32 s45, s85, 8192
    buffer_load_dwordx4 v[216:219], v12, s[28:31], s45 offen sc1
    v_mfma_f32_16x16x32_bf16 v[60:63], v[148:151], v[108:111], v[60:63]
    v_mfma_f32_16x16x32_bf16 v[64:67], v[196:199], v[120:123], v[64:67]
    buffer_load_dwordx4 v[232:235], v13, s[28:31], s45 offen sc1
    v_mfma_f32_16x16x32_bf16 v[68:71], v[200:203], v[120:123], v[68:71]
    v_mfma_f32_16x16x32_bf16 v[72:75], v[248:251], v[120:123], v[72:75]
    buffer_load_dwordx4 v[112:115], v14, s[28:31], s45 offen sc1
    v_mfma_f32_16x16x32_bf16 v[76:79], v[144:147], v[120:123], v[76:79]
    v_mfma_f32_16x16x32_bf16 v[80:83], v[148:151], v[120:123], v[80:83]
    v_mfma_f32_16x16x32_bf16 v[84:87], v[196:199], v[236:239], v[84:87]
    buffer_load_dwordx4 v[116:119], v15, s[28:31], s45 offen sc1
    v_mfma_f32_16x16x32_bf16 v[88:91], v[200:203], v[236:239], v[88:91]
    v_mfma_f32_16x16x32_bf16 v[92:95], v[248:251], v[236:239], v[92:95]
    s_add_u32 m0, s73, 40960
    s_add_u32 s44, s86, 128
    buffer_load_dwordx4 v254, s[32:35], s44 offen offset:0 lds
    v_mfma_f32_16x16x32_bf16 v[96:99], v[144:147], v[236:239], v[96:99]
    v_mfma_f32_16x16x32_bf16 v[100:103], v[148:151], v[236:239], v[100:103]
    s_waitcnt vmcnt(12)
    s_waitcnt lgkmcnt(0)
    v_mfma_f32_16x16x32_bf16 v[24:27], v[152:155], v[172:175], v[24:27]
    s_add_u32 s44, s44, 9216
    buffer_load_dwordx4 v255, s[32:35], s44 offen offset:1024 lds
    v_mfma_f32_16x16x32_bf16 v[28:31], v[132:135], v[172:175], v[28:31]
    v_mfma_f32_16x16x32_bf16 v[32:35], v[136:139], v[172:175], v[32:35]
    v_mfma_f32_16x16x32_bf16 v[36:39], v[164:167], v[172:175], v[36:39]
    s_add_u32 s44, s44, 9216
    buffer_load_dwordx4 v254, s[32:35], s44 offen offset:2048 lds
    v_mfma_f32_16x16x32_bf16 v[40:43], v[168:171], v[172:175], v[40:43]
    v_mfma_f32_16x16x32_bf16 v[44:47], v[152:155], v[156:159], v[44:47]
    s_add_u32 s44, s44, 9216
    buffer_load_dwordx4 v255, s[32:35], s44 offen offset:3072 lds
    v_mfma_f32_16x16x32_bf16 v[48:51], v[132:135], v[156:159], v[48:51]
    v_mfma_f32_16x16x32_bf16 v[52:55], v[136:139], v[156:159], v[52:55]
    v_mfma_f32_16x16x32_bf16 v[56:59], v[164:167], v[156:159], v[56:59]
    s_add_u32 m0, m0, 4096
    s_add_u32 s44, s44, 13312
    buffer_load_dwordx4 v254, s[32:35], s44 offen offset:0 lds
    v_mfma_f32_16x16x32_bf16 v[60:63], v[168:171], v[156:159], v[60:63]
    v_mfma_f32_16x16x32_bf16 v[64:67], v[152:155], v[160:163], v[64:67]
    s_add_u32 s44, s44, 9216
    buffer_load_dwordx4 v255, s[32:35], s44 offen offset:1024 lds
    v_mfma_f32_16x16x32_bf16 v[68:71], v[132:135], v[160:163], v[68:71]
    v_mfma_f32_16x16x32_bf16 v[72:75], v[136:139], v[160:163], v[72:75]
    s_add_u32 s44, s44, 9216
    buffer_load_dwordx4 v254, s[32:35], s44 offen offset:2048 lds
    v_mfma_f32_16x16x32_bf16 v[76:79], v[164:167], v[160:163], v[76:79]
    v_mfma_f32_16x16x32_bf16 v[80:83], v[168:171], v[160:163], v[80:83]
    v_mfma_f32_16x16x32_bf16 v[84:87], v[152:155], v[204:207], v[84:87]
    s_add_u32 s44, s44, 9216
    buffer_load_dwordx4 v255, s[32:35], s44 offen offset:3072 lds
    v_mfma_f32_16x16x32_bf16 v[88:91], v[132:135], v[204:207], v[88:91]
    v_mfma_f32_16x16x32_bf16 v[92:95], v[136:139], v[204:207], v[92:95]
    s_add_u32 m0, m0, 4096
    s_add_u32 s44, s44, s69
    buffer_load_dwordx4 v254, s[32:35], s44 offen offset:0 lds
    v_mfma_f32_16x16x32_bf16 v[96:99], v[164:167], v[204:207], v[96:99]
    v_mfma_f32_16x16x32_bf16 v[100:103], v[168:171], v[204:207], v[100:103]
    s_waitcnt vmcnt(13)
    v_mfma_f32_16x16x32_bf16 v[24:27], v[124:127], v[208:211], v[24:27]
    s_add_u32 s44, s44, 9216
    buffer_load_dwordx4 v255, s[32:35], s44 offen offset:1024 lds
    v_mfma_f32_16x16x32_bf16 v[28:31], v[128:131], v[208:211], v[28:31]
    v_mfma_f32_16x16x32_bf16 v[32:35], v[240:243], v[208:211], v[32:35]
    v_mfma_f32_16x16x32_bf16 v[36:39], v[244:247], v[208:211], v[36:39]
    s_add_u32 s45, s85, 12288
    buffer_load_dwordx4 v[188:191], v12, s[28:31], s45 offen sc1
    ds_read_b128 v[108:111], v6 offset:0
    v_mfma_f32_16x16x32_bf16 v[40:43], v[184:187], v[208:211], v[40:43]
    ds_read_b128 v[120:123], v6 offset:2048
    v_mfma_f32_16x16x32_bf16 v[44:47], v[124:127], v[224:227], v[44:47]
    buffer_load_dwordx4 v[192:195], v13, s[28:31], s45 offen sc1
    ds_read_b128 v[236:239], v6 offset:4096
    v_mfma_f32_16x16x32_bf16 v[48:51], v[128:131], v[224:227], v[48:51]
    ds_read_b128 v[152:155], v6 offset:6144
    v_mfma_f32_16x16x32_bf16 v[52:55], v[240:243], v[224:227], v[52:55]
    ds_read_b128 v[132:135], v6 offset:8192
    v_mfma_f32_16x16x32_bf16 v[56:59], v[244:247], v[224:227], v[56:59]
    buffer_load_dwordx4 v[176:179], v14, s[28:31], s45 offen sc1
    v_mfma_f32_16x16x32_bf16 v[60:63], v[184:187], v[224:227], v[60:63]
    v_mfma_f32_16x16x32_bf16 v[64:67], v[124:127], v[228:231], v[64:67]
    buffer_load_dwordx4 v[180:183], v15, s[28:31], s45 offen sc1
    v_mfma_f32_16x16x32_bf16 v[68:71], v[128:131], v[228:231], v[68:71]
    v_mfma_f32_16x16x32_bf16 v[72:75], v[240:243], v[228:231], v[72:75]
    s_add_u32 s45, s85, 16384
    buffer_load_dwordx4 v[140:143], v12, s[28:31], s45 offen sc1
    v_mfma_f32_16x16x32_bf16 v[76:79], v[244:247], v[228:231], v[76:79]
    v_mfma_f32_16x16x32_bf16 v[80:83], v[184:187], v[228:231], v[80:83]
    v_mfma_f32_16x16x32_bf16 v[84:87], v[124:127], v[212:215], v[84:87]
    buffer_load_dwordx4 v[220:223], v13, s[28:31], s45 offen sc1
    v_mfma_f32_16x16x32_bf16 v[88:91], v[128:131], v[212:215], v[88:91]
    v_mfma_f32_16x16x32_bf16 v[92:95], v[240:243], v[212:215], v[92:95]
    buffer_load_dwordx4 v[196:199], v14, s[28:31], s45 offen sc1
    v_mfma_f32_16x16x32_bf16 v[96:99], v[244:247], v[212:215], v[96:99]
    v_mfma_f32_16x16x32_bf16 v[100:103], v[184:187], v[212:215], v[100:103]
    s_waitcnt vmcnt(17)
    s_waitcnt lgkmcnt(0)
    v_mfma_f32_16x16x32_bf16 v[24:27], v[108:111], v[216:219], v[24:27]
    buffer_load_dwordx4 v[200:203], v15, s[28:31], s45 offen sc1
    v_mfma_f32_16x16x32_bf16 v[28:31], v[120:123], v[216:219], v[28:31]
    v_mfma_f32_16x16x32_bf16 v[32:35], v[236:239], v[216:219], v[32:35]
    v_mfma_f32_16x16x32_bf16 v[36:39], v[152:155], v[216:219], v[36:39]
    s_add_u32 s45, s85, 20480
    buffer_load_dwordx4 v[248:251], v12, s[28:31], s45 offen sc1
    ds_read_b128 v[156:159], v8 offset:0
    v_mfma_f32_16x16x32_bf16 v[40:43], v[132:135], v[216:219], v[40:43]
    ds_read_b128 v[160:163], v8 offset:2048
    v_mfma_f32_16x16x32_bf16 v[44:47], v[108:111], v[232:235], v[44:47]
    buffer_load_dwordx4 v[144:147], v13, s[28:31], s45 offen sc1
    ds_read_b128 v[204:207], v8 offset:4096
    v_mfma_f32_16x16x32_bf16 v[48:51], v[120:123], v[232:235], v[48:51]
    ds_read_b128 v[124:127], v8 offset:6144
    v_mfma_f32_16x16x32_bf16 v[52:55], v[236:239], v[232:235], v[52:55]
    ds_read_b128 v[128:131], v8 offset:8192
    v_mfma_f32_16x16x32_bf16 v[56:59], v[152:155], v[232:235], v[56:59]
    buffer_load_dwordx4 v[148:151], v14, s[28:31], s45 offen sc1
    v_mfma_f32_16x16x32_bf16 v[60:63], v[132:135], v[232:235], v[60:63]
    v_mfma_f32_16x16x32_bf16 v[64:67], v[108:111], v[112:115], v[64:67]
    buffer_load_dwordx4 v[104:107], v15, s[28:31], s45 offen sc1
    v_mfma_f32_16x16x32_bf16 v[68:71], v[120:123], v[112:115], v[68:71]
    v_mfma_f32_16x16x32_bf16 v[72:75], v[236:239], v[112:115], v[72:75]
    s_add_u32 m0, s73, 0
    s_add_u32 s44, s66, 128
    buffer_load_dwordx4 v254, s[40:43], s44 offen offset:0 lds
    v_mfma_f32_16x16x32_bf16 v[76:79], v[152:155], v[112:115], v[76:79]
    v_mfma_f32_16x16x32_bf16 v[80:83], v[132:135], v[112:115], v[80:83]
    v_mfma_f32_16x16x32_bf16 v[84:87], v[108:111], v[116:119], v[84:87]
    s_add_u32 s44, s44, 9216
    buffer_load_dwordx4 v255, s[40:43], s44 offen offset:1024 lds
    v_mfma_f32_16x16x32_bf16 v[88:91], v[120:123], v[116:119], v[88:91]
    v_mfma_f32_16x16x32_bf16 v[92:95], v[236:239], v[116:119], v[92:95]
    s_add_u32 s44, s44, 9216
    buffer_load_dwordx4 v254, s[40:43], s44 offen offset:2048 lds
    v_mfma_f32_16x16x32_bf16 v[96:99], v[152:155], v[116:119], v[96:99]
    v_mfma_f32_16x16x32_bf16 v[100:103], v[132:135], v[116:119], v[100:103]
    s_waitcnt vmcnt(11)
    s_waitcnt lgkmcnt(0)
    v_mfma_f32_16x16x32_bf16 v[24:27], v[156:159], v[188:191], v[24:27]
    s_add_u32 s44, s44, 9216
    buffer_load_dwordx4 v255, s[40:43], s44 offen offset:3072 lds
    v_mfma_f32_16x16x32_bf16 v[28:31], v[160:163], v[188:191], v[28:31]
    v_mfma_f32_16x16x32_bf16 v[32:35], v[204:207], v[188:191], v[32:35]
    v_mfma_f32_16x16x32_bf16 v[36:39], v[124:127], v[188:191], v[36:39]
    s_add_u32 m0, m0, 4096
    s_add_u32 s44, s44, 13312
    buffer_load_dwordx4 v254, s[40:43], s44 offen offset:0 lds
    ds_read_b128 v[224:227], v20 offset:40960
    v_mfma_f32_16x16x32_bf16 v[40:43], v[128:131], v[188:191], v[40:43]
    ds_read_b128 v[228:231], v20 offset:43008
    v_mfma_f32_16x16x32_bf16 v[44:47], v[156:159], v[192:195], v[44:47]
    s_add_u32 s44, s44, 9216
    buffer_load_dwordx4 v255, s[40:43], s44 offen offset:1024 lds
    ds_read_b128 v[212:215], v20 offset:45056
    v_mfma_f32_16x16x32_bf16 v[48:51], v[160:163], v[192:195], v[48:51]
    ds_read_b128 v[108:111], v20 offset:47104
    v_mfma_f32_16x16x32_bf16 v[52:55], v[204:207], v[192:195], v[52:55]
    ds_read_b128 v[120:123], v20 offset:49152
    v_mfma_f32_16x16x32_bf16 v[56:59], v[124:127], v[192:195], v[56:59]
    s_add_u32 s44, s44, 9216
    buffer_load_dwordx4 v254, s[40:43], s44 offen offset:2048 lds
    v_mfma_f32_16x16x32_bf16 v[60:63], v[128:131], v[192:195], v[60:63]
    v_mfma_f32_16x16x32_bf16 v[64:67], v[156:159], v[176:179], v[64:67]
    s_add_u32 s44, s44, 9216
    buffer_load_dwordx4 v255, s[40:43], s44 offen offset:3072 lds
    v_mfma_f32_16x16x32_bf16 v[68:71], v[160:163], v[176:179], v[68:71]
    v_mfma_f32_16x16x32_bf16 v[72:75], v[204:207], v[176:179], v[72:75]
    s_add_u32 m0, m0, 4096
    s_add_u32 s44, s44, s69
    buffer_load_dwordx4 v254, s[40:43], s44 offen offset:0 lds
    v_mfma_f32_16x16x32_bf16 v[76:79], v[124:127], v[176:179], v[76:79]
    v_mfma_f32_16x16x32_bf16 v[80:83], v[128:131], v[176:179], v[80:83]
    v_mfma_f32_16x16x32_bf16 v[84:87], v[156:159], v[180:183], v[84:87]
    s_add_u32 s44, s44, 9216
    buffer_load_dwordx4 v255, s[40:43], s44 offen offset:1024 lds
    v_mfma_f32_16x16x32_bf16 v[88:91], v[160:163], v[180:183], v[88:91]
    v_mfma_f32_16x16x32_bf16 v[92:95], v[204:207], v[180:183], v[92:95]
    s_add_u32 s45, s85, 24576
    buffer_load_dwordx4 v[136:139], v12, s[28:31], s45 offen sc1
    v_mfma_f32_16x16x32_bf16 v[96:99], v[124:127], v[180:183], v[96:99]
    v_mfma_f32_16x16x32_bf16 v[100:103], v[128:131], v[180:183], v[100:103]
    s_waitcnt vmcnt(15)
    s_waitcnt lgkmcnt(0)
    v_mfma_f32_16x16x32_bf16 v[24:27], v[224:227], v[140:143], v[24:27]
    buffer_load_dwordx4 v[164:167], v13, s[28:31], s45 offen sc1
    v_mfma_f32_16x16x32_bf16 v[28:31], v[228:231], v[140:143], v[28:31]
    v_mfma_f32_16x16x32_bf16 v[32:35], v[212:215], v[140:143], v[32:35]
    v_mfma_f32_16x16x32_bf16 v[36:39], v[108:111], v[140:143], v[36:39]
    buffer_load_dwordx4 v[168:171], v14, s[28:31], s45 offen sc1
    ds_read_b128 v[232:235], v21 offset:40960
    v_mfma_f32_16x16x32_bf16 v[40:43], v[120:123], v[140:143], v[40:43]
    ds_read_b128 v[112:115], v21 offset:43008
    v_mfma_f32_16x16x32_bf16 v[44:47], v[224:227], v[220:223], v[44:47]
    buffer_load_dwordx4 v[172:175], v15, s[28:31], s45 offen sc1
    ds_read_b128 v[116:119], v21 offset:45056
    v_mfma_f32_16x16x32_bf16 v[48:51], v[228:231], v[220:223], v[48:51]
    ds_read_b128 v[156:159], v21 offset:47104
    v_mfma_f32_16x16x32_bf16 v[52:55], v[212:215], v[220:223], v[52:55]
    ds_read_b128 v[160:163], v21 offset:49152
    v_mfma_f32_16x16x32_bf16 v[56:59], v[108:111], v[220:223], v[56:59]
    s_add_u32 s45, s85, 28672
    buffer_load_dwordx4 v[240:243], v12, s[28:31], s45 offen sc1
    v_mfma_f32_16x16x32_bf16 v[60:63], v[120:123], v[220:223], v[60:63]
    v_mfma_f32_16x16x32_bf16 v[64:67], v[224:227], v[196:199], v[64:67]
    buffer_load_dwordx4 v[244:247], v13, s[28:31], s45 offen sc1
    v_mfma_f32_16x16x32_bf16 v[68:71], v[228:231], v[196:199], v[68:71]
    v_mfma_f32_16x16x32_bf16 v[72:75], v[212:215], v[196:199], v[72:75]
    buffer_load_dwordx4 v[184:187], v14, s[28:31], s45 offen sc1
    v_mfma_f32_16x16x32_bf16 v[76:79], v[108:111], v[196:199], v[76:79]
    v_mfma_f32_16x16x32_bf16 v[80:83], v[120:123], v[196:199], v[80:83]
    v_mfma_f32_16x16x32_bf16 v[84:87], v[224:227], v[200:203], v[84:87]
    buffer_load_dwordx4 v[208:211], v15, s[28:31], s45 offen sc1
    v_mfma_f32_16x16x32_bf16 v[88:91], v[228:231], v[200:203], v[88:91]
    v_mfma_f32_16x16x32_bf16 v[92:95], v[212:215], v[200:203], v[92:95]
    s_add_u32 m0, s73, 81920
    s_add_u32 s44, s86, 256
    buffer_load_dwordx4 v254, s[32:35], s44 offen offset:0 lds
    v_mfma_f32_16x16x32_bf16 v[96:99], v[108:111], v[200:203], v[96:99]
    v_mfma_f32_16x16x32_bf16 v[100:103], v[120:123], v[200:203], v[100:103]
    s_waitcnt vmcnt(19)
    s_waitcnt lgkmcnt(0)
    v_mfma_f32_16x16x32_bf16 v[24:27], v[232:235], v[248:251], v[24:27]
    s_add_u32 s44, s44, 9216
    buffer_load_dwordx4 v255, s[32:35], s44 offen offset:1024 lds
    v_mfma_f32_16x16x32_bf16 v[28:31], v[112:115], v[248:251], v[28:31]
    v_mfma_f32_16x16x32_bf16 v[32:35], v[116:119], v[248:251], v[32:35]
    v_mfma_f32_16x16x32_bf16 v[36:39], v[156:159], v[248:251], v[36:39]
    s_add_u32 s44, s44, 9216
    buffer_load_dwordx4 v254, s[32:35], s44 offen offset:2048 lds
    s_waitcnt vmcnt(11)
    ds_read_b128 v[192:195], v20 offset:0
    v_mfma_f32_16x16x32_bf16 v[40:43], v[160:163], v[248:251], v[40:43]
    ds_read_b128 v[176:179], v20 offset:2048
    v_mfma_f32_16x16x32_bf16 v[44:47], v[232:235], v[144:147], v[44:47]
    s_add_u32 s44, s44, 9216
    buffer_load_dwordx4 v255, s[32:35], s44 offen offset:3072 lds
    ds_read_b128 v[180:183], v20 offset:4096
    v_mfma_f32_16x16x32_bf16 v[48:51], v[112:115], v[144:147], v[48:51]
    ds_read_b128 v[224:227], v20 offset:6144
    v_mfma_f32_16x16x32_bf16 v[52:55], v[116:119], v[144:147], v[52:55]
    ds_read_b128 v[228:231], v20 offset:8192
    v_mfma_f32_16x16x32_bf16 v[56:59], v[156:159], v[144:147], v[56:59]
    s_add_u32 m0, m0, 4096
    s_add_u32 s44, s44, 13312
    buffer_load_dwordx4 v254, s[32:35], s44 offen offset:0 lds
    v_mfma_f32_16x16x32_bf16 v[60:63], v[160:163], v[144:147], v[60:63]
    v_mfma_f32_16x16x32_bf16 v[64:67], v[232:235], v[148:151], v[64:67]
    s_add_u32 s44, s44, 9216
    buffer_load_dwordx4 v255, s[32:35], s44 offen offset:1024 lds
    v_mfma_f32_16x16x32_bf16 v[68:71], v[112:115], v[148:151], v[68:71]
    v_mfma_f32_16x16x32_bf16 v[72:75], v[116:119], v[148:151], v[72:75]
    s_add_u32 s44, s44, 9216
    buffer_load_dwordx4 v254, s[32:35], s44 offen offset:2048 lds
    v_mfma_f32_16x16x32_bf16 v[76:79], v[156:159], v[148:151], v[76:79]
    v_mfma_f32_16x16x32_bf16 v[80:83], v[160:163], v[148:151], v[80:83]
    v_mfma_f32_16x16x32_bf16 v[84:87], v[232:235], v[104:107], v[84:87]
    s_add_u32 s44, s44, 9216
    buffer_load_dwordx4 v255, s[32:35], s44 offen offset:3072 lds
    v_mfma_f32_16x16x32_bf16 v[88:91], v[112:115], v[104:107], v[88:91]
    v_mfma_f32_16x16x32_bf16 v[92:95], v[116:119], v[104:107], v[92:95]
    s_add_u32 m0, m0, 4096
    s_add_u32 s44, s44, s69
    buffer_load_dwordx4 v254, s[32:35], s44 offen offset:0 lds
    v_mfma_f32_16x16x32_bf16 v[96:99], v[156:159], v[104:107], v[96:99]
    v_mfma_f32_16x16x32_bf16 v[100:103], v[160:163], v[104:107], v[100:103]
    s_waitcnt vmcnt(13)
    s_waitcnt lgkmcnt(0)
    v_mfma_f32_16x16x32_bf16 v[24:27], v[192:195], v[136:139], v[24:27]
    s_add_u32 s44, s44, 9216
    buffer_load_dwordx4 v255, s[32:35], s44 offen offset:1024 lds
    v_mfma_f32_16x16x32_bf16 v[28:31], v[176:179], v[136:139], v[28:31]
    v_mfma_f32_16x16x32_bf16 v[32:35], v[180:183], v[136:139], v[32:35]
    v_mfma_f32_16x16x32_bf16 v[36:39], v[224:227], v[136:139], v[36:39]
    s_add_u32 s45, s85, 32768
    buffer_load_dwordx4 v[236:239], v12, s[28:31], s45 offen sc1
    ds_read_b128 v[212:215], v21 offset:0
    v_mfma_f32_16x16x32_bf16 v[40:43], v[228:231], v[136:139], v[40:43]
    ds_read_b128 v[108:111], v21 offset:2048
    v_mfma_f32_16x16x32_bf16 v[44:47], v[192:195], v[164:167], v[44:47]
    buffer_load_dwordx4 v[152:155], v13, s[28:31], s45 offen sc1
    ds_read_b128 v[120:123], v21 offset:4096
    v_mfma_f32_16x16x32_bf16 v[48:51], v[176:179], v[164:167], v[48:51]
    ds_read_b128 v[140:143], v21 offset:6144
    v_mfma_f32_16x16x32_bf16 v[52:55], v[180:183], v[164:167], v[52:55]
    ds_read_b128 v[220:223], v21 offset:8192
    v_mfma_f32_16x16x32_bf16 v[56:59], v[224:227], v[164:167], v[56:59]
    buffer_load_dwordx4 v[132:135], v14, s[28:31], s45 offen sc1
    v_mfma_f32_16x16x32_bf16 v[60:63], v[228:231], v[164:167], v[60:63]
    v_mfma_f32_16x16x32_bf16 v[64:67], v[192:195], v[168:171], v[64:67]
    buffer_load_dwordx4 v[216:219], v15, s[28:31], s45 offen sc1
    v_mfma_f32_16x16x32_bf16 v[68:71], v[176:179], v[168:171], v[68:71]
    v_mfma_f32_16x16x32_bf16 v[72:75], v[180:183], v[168:171], v[72:75]
    s_add_u32 s45, s85, 36864
    buffer_load_dwordx4 v[204:207], v12, s[28:31], s45 offen sc1
    v_mfma_f32_16x16x32_bf16 v[76:79], v[224:227], v[168:171], v[76:79]
    v_mfma_f32_16x16x32_bf16 v[80:83], v[228:231], v[168:171], v[80:83]
    v_mfma_f32_16x16x32_bf16 v[84:87], v[192:195], v[172:175], v[84:87]
    buffer_load_dwordx4 v[124:127], v13, s[28:31], s45 offen sc1
    v_mfma_f32_16x16x32_bf16 v[88:91], v[176:179], v[172:175], v[88:91]
    v_mfma_f32_16x16x32_bf16 v[92:95], v[180:183], v[172:175], v[92:95]
    buffer_load_dwordx4 v[128:131], v14, s[28:31], s45 offen sc1
    v_mfma_f32_16x16x32_bf16 v[96:99], v[224:227], v[172:175], v[96:99]
    v_mfma_f32_16x16x32_bf16 v[100:103], v[228:231], v[172:175], v[100:103]
    s_waitcnt vmcnt(17)
    s_waitcnt lgkmcnt(0)
    v_mfma_f32_16x16x32_bf16 v[24:27], v[212:215], v[240:243], v[24:27]
    buffer_load_dwordx4 v[188:191], v15, s[28:31], s45 offen sc1
    v_mfma_f32_16x16x32_bf16 v[28:31], v[108:111], v[240:243], v[28:31]
    v_mfma_f32_16x16x32_bf16 v[32:35], v[120:123], v[240:243], v[32:35]
    v_mfma_f32_16x16x32_bf16 v[36:39], v[140:143], v[240:243], v[36:39]
    s_waitcnt vmcnt(8)
    ds_read_b128 v[196:199], v6 offset:0
    v_mfma_f32_16x16x32_bf16 v[40:43], v[220:223], v[240:243], v[40:43]
    ds_read_b128 v[200:203], v6 offset:2048
    v_mfma_f32_16x16x32_bf16 v[44:47], v[212:215], v[244:247], v[44:47]
    ds_read_b128 v[232:235], v6 offset:4096
    v_mfma_f32_16x16x32_bf16 v[48:51], v[108:111], v[244:247], v[48:51]
    ds_read_b128 v[112:115], v6 offset:6144
    v_mfma_f32_16x16x32_bf16 v[52:55], v[120:123], v[244:247], v[52:55]
    ds_read_b128 v[116:119], v6 offset:8192
    v_mfma_f32_16x16x32_bf16 v[56:59], v[140:143], v[244:247], v[56:59]
    v_mfma_f32_16x16x32_bf16 v[60:63], v[220:223], v[244:247], v[60:63]
    v_mfma_f32_16x16x32_bf16 v[64:67], v[212:215], v[184:187], v[64:67]
    v_mfma_f32_16x16x32_bf16 v[68:71], v[108:111], v[184:187], v[68:71]
    v_mfma_f32_16x16x32_bf16 v[72:75], v[120:123], v[184:187], v[72:75]
    v_mfma_f32_16x16x32_bf16 v[76:79], v[140:143], v[184:187], v[76:79]
    v_mfma_f32_16x16x32_bf16 v[80:83], v[220:223], v[184:187], v[80:83]
    v_mfma_f32_16x16x32_bf16 v[84:87], v[212:215], v[208:211], v[84:87]
    v_mfma_f32_16x16x32_bf16 v[88:91], v[108:111], v[208:211], v[88:91]
    v_mfma_f32_16x16x32_bf16 v[92:95], v[120:123], v[208:211], v[92:95]
    v_mfma_f32_16x16x32_bf16 v[96:99], v[140:143], v[208:211], v[96:99]
    v_mfma_f32_16x16x32_bf16 v[100:103], v[220:223], v[208:211], v[100:103]
    s_waitcnt vmcnt(4)
    s_waitcnt lgkmcnt(0)
    v_mfma_f32_16x16x32_bf16 v[24:27], v[196:199], v[236:239], v[24:27]
    v_mfma_f32_16x16x32_bf16 v[28:31], v[200:203], v[236:239], v[28:31]
    v_mfma_f32_16x16x32_bf16 v[32:35], v[232:235], v[236:239], v[32:35]
    v_mfma_f32_16x16x32_bf16 v[36:39], v[112:115], v[236:239], v[36:39]
    ds_read_b128 v[156:159], v8 offset:0
    v_mfma_f32_16x16x32_bf16 v[40:43], v[116:119], v[236:239], v[40:43]
    ds_read_b128 v[160:163], v8 offset:2048
    v_mfma_f32_16x16x32_bf16 v[44:47], v[196:199], v[152:155], v[44:47]
    ds_read_b128 v[248:251], v8 offset:4096
    v_mfma_f32_16x16x32_bf16 v[48:51], v[200:203], v[152:155], v[48:51]
    ds_read_b128 v[144:147], v8 offset:6144
    v_mfma_f32_16x16x32_bf16 v[52:55], v[232:235], v[152:155], v[52:55]
    ds_read_b128 v[148:151], v8 offset:8192
    v_mfma_f32_16x16x32_bf16 v[56:59], v[112:115], v[152:155], v[56:59]
    v_mfma_f32_16x16x32_bf16 v[60:63], v[116:119], v[152:155], v[60:63]
    v_mfma_f32_16x16x32_bf16 v[64:67], v[196:199], v[132:135], v[64:67]
    v_mfma_f32_16x16x32_bf16 v[68:71], v[200:203], v[132:135], v[68:71]
    v_mfma_f32_16x16x32_bf16 v[72:75], v[232:235], v[132:135], v[72:75]
    v_mfma_f32_16x16x32_bf16 v[76:79], v[112:115], v[132:135], v[76:79]
    v_mfma_f32_16x16x32_bf16 v[80:83], v[116:119], v[132:135], v[80:83]
    v_mfma_f32_16x16x32_bf16 v[84:87], v[196:199], v[216:219], v[84:87]
    v_mfma_f32_16x16x32_bf16 v[88:91], v[200:203], v[216:219], v[88:91]
    v_mfma_f32_16x16x32_bf16 v[92:95], v[232:235], v[216:219], v[92:95]
    v_mfma_f32_16x16x32_bf16 v[96:99], v[112:115], v[216:219], v[96:99]
    v_mfma_f32_16x16x32_bf16 v[100:103], v[116:119], v[216:219], v[100:103]
    s_waitcnt vmcnt(0)
    s_waitcnt lgkmcnt(0)
    v_mfma_f32_16x16x32_bf16 v[44:47], v[156:159], v[124:127], v[44:47]
    v_mfma_f32_16x16x32_bf16 v[48:51], v[160:163], v[124:127], v[48:51]
    v_mfma_f32_16x16x32_bf16 v[52:55], v[248:251], v[124:127], v[52:55]
    v_mfma_f32_16x16x32_bf16 v[56:59], v[144:147], v[124:127], v[56:59]
    v_mfma_f32_16x16x32_bf16 v[60:63], v[148:151], v[124:127], v[60:63]
    v_mfma_f32_16x16x32_bf16 v[64:67], v[156:159], v[128:131], v[64:67]
    v_mfma_f32_16x16x32_bf16 v[68:71], v[160:163], v[128:131], v[68:71]
    v_mfma_f32_16x16x32_bf16 v[72:75], v[248:251], v[128:131], v[72:75]
    v_mfma_f32_16x16x32_bf16 v[76:79], v[144:147], v[128:131], v[76:79]
    ds_write_b128 v11, v[44:47] offset:5120
    v_mfma_f32_16x16x32_bf16 v[80:83], v[148:151], v[128:131], v[80:83]
    ds_write_b128 v11, v[48:51] offset:6144
    v_mfma_f32_16x16x32_bf16 v[84:87], v[156:159], v[188:191], v[84:87]
    ds_write_b128 v11, v[52:55] offset:7168
    v_mfma_f32_16x16x32_bf16 v[88:91], v[160:163], v[188:191], v[88:91]
    ds_write_b128 v11, v[56:59] offset:8192
    v_mfma_f32_16x16x32_bf16 v[92:95], v[248:251], v[188:191], v[92:95]
    ds_write_b128 v11, v[60:63] offset:9216
    v_mfma_f32_16x16x32_bf16 v[96:99], v[144:147], v[188:191], v[96:99]
    ds_write_b128 v11, v[64:67] offset:40960
    v_mfma_f32_16x16x32_bf16 v[100:103], v[148:151], v[188:191], v[100:103]
    ds_write_b128 v11, v[68:71] offset:41984
    v_mfma_f32_16x16x32_bf16 v[24:27], v[156:159], v[204:207], v[24:27]
    ds_write_b128 v11, v[72:75] offset:43008
    v_mfma_f32_16x16x32_bf16 v[28:31], v[160:163], v[204:207], v[28:31]
    ds_write_b128 v11, v[76:79] offset:44032
    v_mfma_f32_16x16x32_bf16 v[32:35], v[248:251], v[204:207], v[32:35]
    ds_write_b128 v11, v[80:83] offset:45056
    v_mfma_f32_16x16x32_bf16 v[36:39], v[144:147], v[204:207], v[36:39]
    ds_write_b128 v11, v[84:87] offset:46080
    v_mfma_f32_16x16x32_bf16 v[40:43], v[148:151], v[204:207], v[40:43]
    ds_write_b128 v11, v[88:91] offset:47104
    s_branch parallel_sum__ssm_conv_s5__geglu_ffn__prompt_kernel_red
parallel_sum__ssm_conv_s5__geglu_ffn__prompt_kernel_late_34:
    s_waitcnt lgkmcnt(0)
    v_mfma_f32_16x16x32_bf16 v[24:27], v[240:243], v[176:179], v[24:27]
    s_add_u32 s44, s44, 9216
    buffer_load_dwordx4 v255, s[40:43], s44 offen offset:3072 lds
    v_mfma_f32_16x16x32_bf16 v[28:31], v[244:247], v[176:179], v[28:31]
    v_mfma_f32_16x16x32_bf16 v[32:35], v[184:187], v[176:179], v[32:35]
    v_mfma_f32_16x16x32_bf16 v[36:39], v[188:191], v[176:179], v[36:39]
    s_add_u32 m0, m0, 4096
    s_add_u32 s44, s44, s69
    buffer_load_dwordx4 v254, s[40:43], s44 offen offset:0 lds
    ds_read_b128 v[152:155], v20 offset:0
    v_mfma_f32_16x16x32_bf16 v[40:43], v[192:195], v[176:179], v[40:43]
    ds_read_b128 v[132:135], v20 offset:2048
    v_mfma_f32_16x16x32_bf16 v[44:47], v[240:243], v[180:183], v[44:47]
    s_add_u32 s44, s44, 9216
    buffer_load_dwordx4 v255, s[40:43], s44 offen offset:1024 lds
    ds_read_b128 v[136:139], v20 offset:4096
    v_mfma_f32_16x16x32_bf16 v[48:51], v[244:247], v[180:183], v[48:51]
    ds_read_b128 v[164:167], v20 offset:6144
    v_mfma_f32_16x16x32_bf16 v[52:55], v[184:187], v[180:183], v[52:55]
    ds_read_b128 v[168:171], v20 offset:8192
    v_mfma_f32_16x16x32_bf16 v[56:59], v[188:191], v[180:183], v[56:59]
    s_add_u32 m0, s73, 40960
    s_add_u32 s44, s86, 128
    buffer_load_dwordx4 v254, s[32:35], s44 offen offset:0 lds
    v_mfma_f32_16x16x32_bf16 v[60:63], v[192:195], v[180:183], v[60:63]
    v_mfma_f32_16x16x32_bf16 v[64:67], v[240:243], v[140:143], v[64:67]
    s_add_u32 s44, s44, 9216
    buffer_load_dwordx4 v255, s[32:35], s44 offen offset:1024 lds
    v_mfma_f32_16x16x32_bf16 v[68:71], v[244:247], v[140:143], v[68:71]
    v_mfma_f32_16x16x32_bf16 v[72:75], v[184:187], v[140:143], v[72:75]
    s_add_u32 s44, s44, 9216
    buffer_load_dwordx4 v254, s[32:35], s44 offen offset:2048 lds
    v_mfma_f32_16x16x32_bf16 v[76:79], v[188:191], v[140:143], v[76:79]
    v_mfma_f32_16x16x32_bf16 v[80:83], v[192:195], v[140:143], v[80:83]
    v_mfma_f32_16x16x32_bf16 v[84:87], v[240:243], v[220:223], v[84:87]
    s_add_u32 s44, s44, 9216
    buffer_load_dwordx4 v255, s[32:35], s44 offen offset:3072 lds
    v_mfma_f32_16x16x32_bf16 v[88:91], v[244:247], v[220:223], v[88:91]
    v_mfma_f32_16x16x32_bf16 v[92:95], v[184:187], v[220:223], v[92:95]
    s_add_u32 m0, m0, 4096
    s_add_u32 s44, s44, 13312
    buffer_load_dwordx4 v254, s[32:35], s44 offen offset:0 lds
    v_mfma_f32_16x16x32_bf16 v[96:99], v[188:191], v[220:223], v[96:99]
    v_mfma_f32_16x16x32_bf16 v[100:103], v[192:195], v[220:223], v[100:103]
    s_waitcnt lgkmcnt(0)
    v_mfma_f32_16x16x32_bf16 v[24:27], v[196:199], v[104:107], v[24:27]
    buffer_load_dword v22, v4, s[28:31], s79 offen sc1
    v_mfma_f32_16x16x32_bf16 v[28:31], v[200:203], v[104:107], v[28:31]
    v_mfma_f32_16x16x32_bf16 v[32:35], v[248:251], v[104:107], v[32:35]
    v_mfma_f32_16x16x32_bf16 v[36:39], v[144:147], v[104:107], v[36:39]
    ds_read_b128 v[172:175], v21 offset:0
    v_mfma_f32_16x16x32_bf16 v[40:43], v[148:151], v[104:107], v[40:43]
    s_add_u32 s44, s44, 9216
    buffer_load_dwordx4 v255, s[32:35], s44 offen offset:1024 lds
    ds_read_b128 v[156:159], v21 offset:2048
    v_mfma_f32_16x16x32_bf16 v[44:47], v[196:199], v[108:111], v[44:47]
    ds_read_b128 v[160:163], v21 offset:4096
    v_mfma_f32_16x16x32_bf16 v[48:51], v[200:203], v[108:111], v[48:51]
    ds_read_b128 v[204:207], v21 offset:6144
    v_mfma_f32_16x16x32_bf16 v[52:55], v[248:251], v[108:111], v[52:55]
    s_add_u32 s44, s44, 9216
    buffer_load_dwordx4 v254, s[32:35], s44 offen offset:2048 lds
    ds_read_b128 v[208:211], v21 offset:8192
    v_mfma_f32_16x16x32_bf16 v[56:59], v[144:147], v[108:111], v[56:59]
    v_mfma_f32_16x16x32_bf16 v[60:63], v[148:151], v[108:111], v[60:63]
    v_mfma_f32_16x16x32_bf16 v[64:67], v[196:199], v[120:123], v[64:67]
    s_add_u32 s44, s44, 9216
    buffer_load_dwordx4 v255, s[32:35], s44 offen offset:3072 lds
    v_mfma_f32_16x16x32_bf16 v[68:71], v[200:203], v[120:123], v[68:71]
    v_mfma_f32_16x16x32_bf16 v[72:75], v[248:251], v[120:123], v[72:75]
    v_mfma_f32_16x16x32_bf16 v[76:79], v[144:147], v[120:123], v[76:79]
    s_add_u32 m0, m0, 4096
    s_add_u32 s44, s44, s69
    buffer_load_dwordx4 v254, s[32:35], s44 offen offset:0 lds
    v_mfma_f32_16x16x32_bf16 v[80:83], v[148:151], v[120:123], v[80:83]
    v_mfma_f32_16x16x32_bf16 v[84:87], v[196:199], v[236:239], v[84:87]
    v_mfma_f32_16x16x32_bf16 v[88:91], v[200:203], v[236:239], v[88:91]
    s_add_u32 s44, s44, 9216
    buffer_load_dwordx4 v255, s[32:35], s44 offen offset:1024 lds
    v_mfma_f32_16x16x32_bf16 v[92:95], v[248:251], v[236:239], v[92:95]
    v_mfma_f32_16x16x32_bf16 v[96:99], v[144:147], v[236:239], v[96:99]
    v_mfma_f32_16x16x32_bf16 v[100:103], v[148:151], v[236:239], v[100:103]
    s_waitcnt lgkmcnt(0)
    s_waitcnt vmcnt(5)
    s_add_u32 m0, s73, 0
    s_add_u32 s44, s66, 128
    buffer_load_dwordx4 v254, s[40:43], s44 offen offset:0 lds
    s_add_u32 s44, s44, 9216
    buffer_load_dwordx4 v255, s[40:43], s44 offen offset:1024 lds
    s_add_u32 s44, s44, 9216
    buffer_load_dwordx4 v254, s[40:43], s44 offen offset:2048 lds
    s_add_u32 s44, s44, 9216
    buffer_load_dwordx4 v255, s[40:43], s44 offen offset:3072 lds
    s_add_u32 m0, m0, 4096
    s_add_u32 s44, s44, 13312
    buffer_load_dwordx4 v254, s[40:43], s44 offen offset:0 lds
    s_add_u32 s44, s44, 9216
    buffer_load_dwordx4 v255, s[40:43], s44 offen offset:1024 lds
    s_add_u32 s44, s44, 9216
    buffer_load_dwordx4 v254, s[40:43], s44 offen offset:2048 lds
    s_add_u32 s44, s44, 9216
    buffer_load_dwordx4 v255, s[40:43], s44 offen offset:3072 lds
    s_add_u32 m0, m0, 4096
    s_add_u32 s44, s44, s69
    buffer_load_dwordx4 v254, s[40:43], s44 offen offset:0 lds
    s_add_u32 s44, s44, 9216
    buffer_load_dwordx4 v255, s[40:43], s44 offen offset:1024 lds
    s_mov_b32 s5, 0
parallel_sum__ssm_conv_s5__geglu_ffn__prompt_kernel_g1_35:
    v_cmp_ne_u32 vcc, s4, v22
    s_add_u32 s5, s5, 1
    s_nop 3
    s_cbranch_vccz parallel_sum__ssm_conv_s5__geglu_ffn__prompt_kernel_g1o_36
    s_cmp_ge_u32 s5, 0x20000
    s_cbranch_scc1 parallel_sum__ssm_conv_s5__geglu_ffn__prompt_kernel_g1o_36
    s_sleep 3
    buffer_load_dword v22, v4, s[28:31], s79 offen sc1
    s_waitcnt vmcnt(0)
    s_branch parallel_sum__ssm_conv_s5__geglu_ffn__prompt_kernel_g1_35
parallel_sum__ssm_conv_s5__geglu_ffn__prompt_kernel_g1o_36:
    s_add_u32 s45, s85, 0
    buffer_load_dwordx4 v[224:227], v12, s[28:31], s45 offen sc1
    buffer_load_dwordx4 v[228:231], v13, s[28:31], s45 offen sc1
    buffer_load_dwordx4 v[212:215], v14, s[28:31], s45 offen sc1
    buffer_load_dwordx4 v[216:219], v15, s[28:31], s45 offen sc1
    s_add_u32 s45, s85, 4096
    buffer_load_dwordx4 v[232:235], v12, s[28:31], s45 offen sc1
    buffer_load_dwordx4 v[112:115], v13, s[28:31], s45 offen sc1
    buffer_load_dwordx4 v[116:119], v14, s[28:31], s45 offen sc1
    buffer_load_dwordx4 v[124:127], v15, s[28:31], s45 offen sc1
    s_add_u32 s45, s85, 8192
    buffer_load_dwordx4 v[128:131], v12, s[28:31], s45 offen sc1
    buffer_load_dwordx4 v[240:243], v13, s[28:31], s45 offen sc1
    buffer_load_dwordx4 v[244:247], v14, s[28:31], s45 offen sc1
    buffer_load_dwordx4 v[184:187], v15, s[28:31], s45 offen sc1
    s_add_u32 s45, s85, 12288
    buffer_load_dwordx4 v[188:191], v12, s[28:31], s45 offen sc1
    buffer_load_dwordx4 v[192:195], v13, s[28:31], s45 offen sc1
    buffer_load_dwordx4 v[176:179], v14, s[28:31], s45 offen sc1
    buffer_load_dwordx4 v[180:183], v15, s[28:31], s45 offen sc1
    s_add_u32 s45, s85, 16384
    buffer_load_dwordx4 v[140:143], v12, s[28:31], s45 offen sc1
    buffer_load_dwordx4 v[220:223], v13, s[28:31], s45 offen sc1
    buffer_load_dwordx4 v[196:199], v14, s[28:31], s45 offen sc1
    buffer_load_dwordx4 v[200:203], v15, s[28:31], s45 offen sc1
    s_add_u32 s45, s85, 20480
    buffer_load_dwordx4 v[248:251], v12, s[28:31], s45 offen sc1
    buffer_load_dwordx4 v[144:147], v13, s[28:31], s45 offen sc1
    buffer_load_dwordx4 v[148:151], v14, s[28:31], s45 offen sc1
    buffer_load_dwordx4 v[104:107], v15, s[28:31], s45 offen sc1
    s_waitcnt vmcnt(20)
    v_mfma_f32_16x16x32_bf16 v[24:27], v[152:155], v[224:227], v[24:27]
    v_mfma_f32_16x16x32_bf16 v[28:31], v[132:135], v[224:227], v[28:31]
    v_mfma_f32_16x16x32_bf16 v[32:35], v[136:139], v[224:227], v[32:35]
    v_mfma_f32_16x16x32_bf16 v[36:39], v[164:167], v[224:227], v[36:39]
    v_mfma_f32_16x16x32_bf16 v[40:43], v[168:171], v[224:227], v[40:43]
    v_mfma_f32_16x16x32_bf16 v[44:47], v[152:155], v[228:231], v[44:47]
    v_mfma_f32_16x16x32_bf16 v[48:51], v[132:135], v[228:231], v[48:51]
    v_mfma_f32_16x16x32_bf16 v[52:55], v[136:139], v[228:231], v[52:55]
    v_mfma_f32_16x16x32_bf16 v[56:59], v[164:167], v[228:231], v[56:59]
    v_mfma_f32_16x16x32_bf16 v[60:63], v[168:171], v[228:231], v[60:63]
    v_mfma_f32_16x16x32_bf16 v[64:67], v[152:155], v[212:215], v[64:67]
    v_mfma_f32_16x16x32_bf16 v[68:71], v[132:135], v[212:215], v[68:71]
    v_mfma_f32_16x16x32_bf16 v[72:75], v[136:139], v[212:215], v[72:75]
    v_mfma_f32_16x16x32_bf16 v[76:79], v[164:167], v[212:215], v[76:79]
    v_mfma_f32_16x16x32_bf16 v[80:83], v[168:171], v[212:215], v[80:83]
    v_mfma_f32_16x16x32_bf16 v[84:87], v[152:155], v[216:219], v[84:87]
    v_mfma_f32_16x16x32_bf16 v[88:91], v[132:135], v[216:219], v[88:91]
    v_mfma_f32_16x16x32_bf16 v[92:95], v[136:139], v[216:219], v[92:95]
    v_mfma_f32_16x16x32_bf16 v[96:99], v[164:167], v[216:219], v[96:99]
    v_mfma_f32_16x16x32_bf16 v[100:103], v[168:171], v[216:219], v[100:103]
    s_waitcnt vmcnt(16)
    v_mfma_f32_16x16x32_bf16 v[24:27], v[172:175], v[232:235], v[24:27]
    s_add_u32 s45, s85, 24576
    buffer_load_dwordx4 v[136:139], v12, s[28:31], s45 offen sc1
    v_mfma_f32_16x16x32_bf16 v[28:31], v[156:159], v[232:235], v[28:31]
    v_mfma_f32_16x16x32_bf16 v[32:35], v[160:163], v[232:235], v[32:35]
    v_mfma_f32_16x16x32_bf16 v[36:39], v[204:207], v[232:235], v[36:39]
    ds_read_b128 v[108:111], v6 offset:0
    v_mfma_f32_16x16x32_bf16 v[40:43], v[208:211], v[232:235], v[40:43]
    ds_read_b128 v[120:123], v6 offset:2048
    v_mfma_f32_16x16x32_bf16 v[44:47], v[172:175], v[112:115], v[44:47]
    buffer_load_dwordx4 v[164:167], v13, s[28:31], s45 offen sc1
    ds_read_b128 v[236:239], v6 offset:4096
    v_mfma_f32_16x16x32_bf16 v[48:51], v[156:159], v[112:115], v[48:51]
    ds_read_b128 v[152:155], v6 offset:6144
    v_mfma_f32_16x16x32_bf16 v[52:55], v[160:163], v[112:115], v[52:55]
    ds_read_b128 v[132:135], v6 offset:8192
    v_mfma_f32_16x16x32_bf16 v[56:59], v[204:207], v[112:115], v[56:59]
    v_mfma_f32_16x16x32_bf16 v[60:63], v[208:211], v[112:115], v[60:63]
    v_mfma_f32_16x16x32_bf16 v[64:67], v[172:175], v[116:119], v[64:67]
    buffer_load_dwordx4 v[168:171], v14, s[28:31], s45 offen sc1
    v_mfma_f32_16x16x32_bf16 v[68:71], v[156:159], v[116:119], v[68:71]
    v_mfma_f32_16x16x32_bf16 v[72:75], v[160:163], v[116:119], v[72:75]
    v_mfma_f32_16x16x32_bf16 v[76:79], v[204:207], v[116:119], v[76:79]
    v_mfma_f32_16x16x32_bf16 v[80:83], v[208:211], v[116:119], v[80:83]
    v_mfma_f32_16x16x32_bf16 v[84:87], v[172:175], v[124:127], v[84:87]
    buffer_load_dwordx4 v[224:227], v15, s[28:31], s45 offen sc1
    v_mfma_f32_16x16x32_bf16 v[88:91], v[156:159], v[124:127], v[88:91]
    v_mfma_f32_16x16x32_bf16 v[92:95], v[160:163], v[124:127], v[92:95]
    v_mfma_f32_16x16x32_bf16 v[96:99], v[204:207], v[124:127], v[96:99]
    v_mfma_f32_16x16x32_bf16 v[100:103], v[208:211], v[124:127], v[100:103]
    s_waitcnt vmcnt(16)
    s_waitcnt lgkmcnt(0)
    v_mfma_f32_16x16x32_bf16 v[24:27], v[108:111], v[128:131], v[24:27]
    s_add_u32 s45, s85, 28672
    buffer_load_dwordx4 v[160:163], v12, s[28:31], s45 offen sc1
    v_mfma_f32_16x16x32_bf16 v[28:31], v[120:123], v[128:131], v[28:31]
    v_mfma_f32_16x16x32_bf16 v[32:35], v[236:239], v[128:131], v[32:35]
    v_mfma_f32_16x16x32_bf16 v[36:39], v[152:155], v[128:131], v[36:39]
    ds_read_b128 v[228:231], v8 offset:0
    v_mfma_f32_16x16x32_bf16 v[40:43], v[132:135], v[128:131], v[40:43]
    ds_read_b128 v[212:215], v8 offset:2048
    v_mfma_f32_16x16x32_bf16 v[44:47], v[108:111], v[240:243], v[44:47]
    buffer_load_dwordx4 v[204:207], v13, s[28:31], s45 offen sc1
    ds_read_b128 v[216:219], v8 offset:4096
    v_mfma_f32_16x16x32_bf16 v[48:51], v[120:123], v[240:243], v[48:51]
    ds_read_b128 v[172:175], v8 offset:6144
    v_mfma_f32_16x16x32_bf16 v[52:55], v[236:239], v[240:243], v[52:55]
    ds_read_b128 v[156:159], v8 offset:8192
    v_mfma_f32_16x16x32_bf16 v[56:59], v[152:155], v[240:243], v[56:59]
    v_mfma_f32_16x16x32_bf16 v[60:63], v[132:135], v[240:243], v[60:63]
    v_mfma_f32_16x16x32_bf16 v[64:67], v[108:111], v[244:247], v[64:67]
    buffer_load_dwordx4 v[208:211], v14, s[28:31], s45 offen sc1
    v_mfma_f32_16x16x32_bf16 v[68:71], v[120:123], v[244:247], v[68:71]
    v_mfma_f32_16x16x32_bf16 v[72:75], v[236:239], v[244:247], v[72:75]
    v_mfma_f32_16x16x32_bf16 v[76:79], v[152:155], v[244:247], v[76:79]
    v_mfma_f32_16x16x32_bf16 v[80:83], v[132:135], v[244:247], v[80:83]
    v_mfma_f32_16x16x32_bf16 v[84:87], v[108:111], v[184:187], v[84:87]
    buffer_load_dwordx4 v[232:235], v15, s[28:31], s45 offen sc1
    v_mfma_f32_16x16x32_bf16 v[88:91], v[120:123], v[184:187], v[88:91]
    v_mfma_f32_16x16x32_bf16 v[92:95], v[236:239], v[184:187], v[92:95]
    v_mfma_f32_16x16x32_bf16 v[96:99], v[152:155], v[184:187], v[96:99]
    v_mfma_f32_16x16x32_bf16 v[100:103], v[132:135], v[184:187], v[100:103]
    s_waitcnt vmcnt(16)
    s_waitcnt lgkmcnt(0)
    v_mfma_f32_16x16x32_bf16 v[24:27], v[228:231], v[188:191], v[24:27]
    s_add_u32 m0, s73, 81920
    s_add_u32 s44, s86, 256
    buffer_load_dwordx4 v254, s[32:35], s44 offen offset:0 lds
    v_mfma_f32_16x16x32_bf16 v[28:31], v[212:215], v[188:191], v[28:31]
    v_mfma_f32_16x16x32_bf16 v[32:35], v[216:219], v[188:191], v[32:35]
    v_mfma_f32_16x16x32_bf16 v[36:39], v[172:175], v[188:191], v[36:39]
    s_add_u32 s44, s44, 9216
    buffer_load_dwordx4 v255, s[32:35], s44 offen offset:1024 lds
    ds_read_b128 v[112:115], v20 offset:40960
    v_mfma_f32_16x16x32_bf16 v[40:43], v[156:159], v[188:191], v[40:43]
    ds_read_b128 v[116:119], v20 offset:43008
    v_mfma_f32_16x16x32_bf16 v[44:47], v[228:231], v[192:195], v[44:47]
    s_add_u32 s44, s44, 9216
    buffer_load_dwordx4 v254, s[32:35], s44 offen offset:2048 lds
    ds_read_b128 v[124:127], v20 offset:45056
    v_mfma_f32_16x16x32_bf16 v[48:51], v[212:215], v[192:195], v[48:51]
    ds_read_b128 v[108:111], v20 offset:47104
    v_mfma_f32_16x16x32_bf16 v[52:55], v[216:219], v[192:195], v[52:55]
    ds_read_b128 v[120:123], v20 offset:49152
    v_mfma_f32_16x16x32_bf16 v[56:59], v[172:175], v[192:195], v[56:59]
    s_add_u32 s44, s44, 9216
    buffer_load_dwordx4 v255, s[32:35], s44 offen offset:3072 lds
    v_mfma_f32_16x16x32_bf16 v[60:63], v[156:159], v[192:195], v[60:63]
    v_mfma_f32_16x16x32_bf16 v[64:67], v[228:231], v[176:179], v[64:67]
    s_add_u32 m0, m0, 4096
    s_add_u32 s44, s44, 13312
    buffer_load_dwordx4 v254, s[32:35], s44 offen offset:0 lds
    v_mfma_f32_16x16x32_bf16 v[68:71], v[212:215], v[176:179], v[68:71]
    v_mfma_f32_16x16x32_bf16 v[72:75], v[216:219], v[176:179], v[72:75]
    s_add_u32 s44, s44, 9216
    buffer_load_dwordx4 v255, s[32:35], s44 offen offset:1024 lds
    v_mfma_f32_16x16x32_bf16 v[76:79], v[172:175], v[176:179], v[76:79]
    v_mfma_f32_16x16x32_bf16 v[80:83], v[156:159], v[176:179], v[80:83]
    v_mfma_f32_16x16x32_bf16 v[84:87], v[228:231], v[180:183], v[84:87]
    s_add_u32 s44, s44, 9216
    buffer_load_dwordx4 v254, s[32:35], s44 offen offset:2048 lds
    v_mfma_f32_16x16x32_bf16 v[88:91], v[212:215], v[180:183], v[88:91]
    v_mfma_f32_16x16x32_bf16 v[92:95], v[216:219], v[180:183], v[92:95]
    s_add_u32 s44, s44, 9216
    buffer_load_dwordx4 v255, s[32:35], s44 offen offset:3072 lds
    v_mfma_f32_16x16x32_bf16 v[96:99], v[172:175], v[180:183], v[96:99]
    v_mfma_f32_16x16x32_bf16 v[100:103], v[156:159], v[180:183], v[100:103]
    s_waitcnt vmcnt(20)
    s_waitcnt lgkmcnt(0)
    v_mfma_f32_16x16x32_bf16 v[24:27], v[112:115], v[140:143], v[24:27]
    s_add_u32 m0, m0, 4096
    s_add_u32 s44, s44, s69
    buffer_load_dwordx4 v254, s[32:35], s44 offen offset:0 lds
    v_mfma_f32_16x16x32_bf16 v[28:31], v[116:119], v[140:143], v[28:31]
    v_mfma_f32_16x16x32_bf16 v[32:35], v[124:127], v[140:143], v[32:35]
    v_mfma_f32_16x16x32_bf16 v[36:39], v[108:111], v[140:143], v[36:39]
    s_add_u32 s44, s44, 9216
    buffer_load_dwordx4 v255, s[32:35], s44 offen offset:1024 lds
    ds_read_b128 v[240:243], v21 offset:40960
    v_mfma_f32_16x16x32_bf16 v[40:43], v[120:123], v[140:143], v[40:43]
    ds_read_b128 v[244:247], v21 offset:43008
    v_mfma_f32_16x16x32_bf16 v[44:47], v[112:115], v[220:223], v[44:47]
    s_add_u32 s45, s85, 32768
    buffer_load_dwordx4 v[236:239], v12, s[28:31], s45 offen sc1
    ds_read_b128 v[184:187], v21 offset:45056
    v_mfma_f32_16x16x32_bf16 v[48:51], v[116:119], v[220:223], v[48:51]
    ds_read_b128 v[228:231], v21 offset:47104
    v_mfma_f32_16x16x32_bf16 v[52:55], v[124:127], v[220:223], v[52:55]
    ds_read_b128 v[212:215], v21 offset:49152
    v_mfma_f32_16x16x32_bf16 v[56:59], v[108:111], v[220:223], v[56:59]
    buffer_load_dwordx4 v[152:155], v13, s[28:31], s45 offen sc1
    v_mfma_f32_16x16x32_bf16 v[60:63], v[120:123], v[220:223], v[60:63]
    v_mfma_f32_16x16x32_bf16 v[64:67], v[112:115], v[196:199], v[64:67]
    buffer_load_dwordx4 v[132:135], v14, s[28:31], s45 offen sc1
    v_mfma_f32_16x16x32_bf16 v[68:71], v[116:119], v[196:199], v[68:71]
    v_mfma_f32_16x16x32_bf16 v[72:75], v[124:127], v[196:199], v[72:75]
    buffer_load_dwordx4 v[128:131], v15, s[28:31], s45 offen sc1
    v_mfma_f32_16x16x32_bf16 v[76:79], v[108:111], v[196:199], v[76:79]
    v_mfma_f32_16x16x32_bf16 v[80:83], v[120:123], v[196:199], v[80:83]
    v_mfma_f32_16x16x32_bf16 v[84:87], v[112:115], v[200:203], v[84:87]
    s_add_u32 s45, s85, 36864
    buffer_load_dwordx4 v[216:219], v12, s[28:31], s45 offen sc1
    v_mfma_f32_16x16x32_bf16 v[88:91], v[116:119], v[200:203], v[88:91]
    v_mfma_f32_16x16x32_bf16 v[92:95], v[124:127], v[200:203], v[92:95]
    buffer_load_dwordx4 v[172:175], v13, s[28:31], s45 offen sc1
    v_mfma_f32_16x16x32_bf16 v[96:99], v[108:111], v[200:203], v[96:99]
    v_mfma_f32_16x16x32_bf16 v[100:103], v[120:123], v[200:203], v[100:103]
    s_waitcnt vmcnt(24)
    s_waitcnt lgkmcnt(0)
    v_mfma_f32_16x16x32_bf16 v[24:27], v[240:243], v[248:251], v[24:27]
    buffer_load_dwordx4 v[156:159], v14, s[28:31], s45 offen sc1
    v_mfma_f32_16x16x32_bf16 v[28:31], v[244:247], v[248:251], v[28:31]
    v_mfma_f32_16x16x32_bf16 v[32:35], v[184:187], v[248:251], v[32:35]
    v_mfma_f32_16x16x32_bf16 v[36:39], v[228:231], v[248:251], v[36:39]
    ds_read_b128 v[192:195], v20 offset:0
    v_mfma_f32_16x16x32_bf16 v[40:43], v[212:215], v[248:251], v[40:43]
    ds_read_b128 v[176:179], v20 offset:2048
    v_mfma_f32_16x16x32_bf16 v[44:47], v[240:243], v[144:147], v[44:47]
    ds_read_b128 v[180:183], v20 offset:4096
    v_mfma_f32_16x16x32_bf16 v[48:51], v[244:247], v[144:147], v[48:51]
    ds_read_b128 v[112:115], v20 offset:6144
    v_mfma_f32_16x16x32_bf16 v[52:55], v[184:187], v[144:147], v[52:55]
    ds_read_b128 v[116:119], v20 offset:8192
    v_mfma_f32_16x16x32_bf16 v[56:59], v[228:231], v[144:147], v[56:59]
    v_mfma_f32_16x16x32_bf16 v[60:63], v[212:215], v[144:147], v[60:63]
    v_mfma_f32_16x16x32_bf16 v[64:67], v[240:243], v[148:151], v[64:67]
    buffer_load_dwordx4 v[188:191], v15, s[28:31], s45 offen sc1
    v_mfma_f32_16x16x32_bf16 v[68:71], v[244:247], v[148:151], v[68:71]
    v_mfma_f32_16x16x32_bf16 v[72:75], v[184:187], v[148:151], v[72:75]
    v_mfma_f32_16x16x32_bf16 v[76:79], v[228:231], v[148:151], v[76:79]
    v_mfma_f32_16x16x32_bf16 v[80:83], v[212:215], v[148:151], v[80:83]
    v_mfma_f32_16x16x32_bf16 v[84:87], v[240:243], v[104:107], v[84:87]
    v_mfma_f32_16x16x32_bf16 v[88:91], v[244:247], v[104:107], v[88:91]
    v_mfma_f32_16x16x32_bf16 v[92:95], v[184:187], v[104:107], v[92:95]
    v_mfma_f32_16x16x32_bf16 v[96:99], v[228:231], v[104:107], v[96:99]
    v_mfma_f32_16x16x32_bf16 v[100:103], v[212:215], v[104:107], v[100:103]
    s_waitcnt vmcnt(22)
    s_waitcnt lgkmcnt(0)
    v_mfma_f32_16x16x32_bf16 v[24:27], v[192:195], v[136:139], v[24:27]
    v_mfma_f32_16x16x32_bf16 v[28:31], v[176:179], v[136:139], v[28:31]
    v_mfma_f32_16x16x32_bf16 v[32:35], v[180:183], v[136:139], v[32:35]
    v_mfma_f32_16x16x32_bf16 v[36:39], v[112:115], v[136:139], v[36:39]
    ds_read_b128 v[124:127], v21 offset:0
    v_mfma_f32_16x16x32_bf16 v[40:43], v[116:119], v[136:139], v[40:43]
    ds_read_b128 v[108:111], v21 offset:2048
    v_mfma_f32_16x16x32_bf16 v[44:47], v[192:195], v[164:167], v[44:47]
    ds_read_b128 v[120:123], v21 offset:4096
    v_mfma_f32_16x16x32_bf16 v[48:51], v[176:179], v[164:167], v[48:51]
    ds_read_b128 v[140:143], v21 offset:6144
    v_mfma_f32_16x16x32_bf16 v[52:55], v[180:183], v[164:167], v[52:55]
    ds_read_b128 v[220:223], v21 offset:8192
    v_mfma_f32_16x16x32_bf16 v[56:59], v[112:115], v[164:167], v[56:59]
    v_mfma_f32_16x16x32_bf16 v[60:63], v[116:119], v[164:167], v[60:63]
    v_mfma_f32_16x16x32_bf16 v[64:67], v[192:195], v[168:171], v[64:67]
    v_mfma_f32_16x16x32_bf16 v[68:71], v[176:179], v[168:171], v[68:71]
    v_mfma_f32_16x16x32_bf16 v[72:75], v[180:183], v[168:171], v[72:75]
    v_mfma_f32_16x16x32_bf16 v[76:79], v[112:115], v[168:171], v[76:79]
    v_mfma_f32_16x16x32_bf16 v[80:83], v[116:119], v[168:171], v[80:83]
    v_mfma_f32_16x16x32_bf16 v[84:87], v[192:195], v[224:227], v[84:87]
    v_mfma_f32_16x16x32_bf16 v[88:91], v[176:179], v[224:227], v[88:91]
    v_mfma_f32_16x16x32_bf16 v[92:95], v[180:183], v[224:227], v[92:95]
    v_mfma_f32_16x16x32_bf16 v[96:99], v[112:115], v[224:227], v[96:99]
    v_mfma_f32_16x16x32_bf16 v[100:103], v[116:119], v[224:227], v[100:103]
    s_waitcnt vmcnt(18)
    s_waitcnt lgkmcnt(0)
    v_mfma_f32_16x16x32_bf16 v[24:27], v[124:127], v[160:163], v[24:27]
    v_mfma_f32_16x16x32_bf16 v[28:31], v[108:111], v[160:163], v[28:31]
    v_mfma_f32_16x16x32_bf16 v[32:35], v[120:123], v[160:163], v[32:35]
    v_mfma_f32_16x16x32_bf16 v[36:39], v[140:143], v[160:163], v[36:39]
    s_waitcnt vmcnt(8)
    ds_read_b128 v[196:199], v6 offset:0
    v_mfma_f32_16x16x32_bf16 v[40:43], v[220:223], v[160:163], v[40:43]
    ds_read_b128 v[200:203], v6 offset:2048
    v_mfma_f32_16x16x32_bf16 v[44:47], v[124:127], v[204:207], v[44:47]
    ds_read_b128 v[240:243], v6 offset:4096
    v_mfma_f32_16x16x32_bf16 v[48:51], v[108:111], v[204:207], v[48:51]
    ds_read_b128 v[244:247], v6 offset:6144
    v_mfma_f32_16x16x32_bf16 v[52:55], v[120:123], v[204:207], v[52:55]
    ds_read_b128 v[184:187], v6 offset:8192
    v_mfma_f32_16x16x32_bf16 v[56:59], v[140:143], v[204:207], v[56:59]
    v_mfma_f32_16x16x32_bf16 v[60:63], v[220:223], v[204:207], v[60:63]
    v_mfma_f32_16x16x32_bf16 v[64:67], v[124:127], v[208:211], v[64:67]
    v_mfma_f32_16x16x32_bf16 v[68:71], v[108:111], v[208:211], v[68:71]
    v_mfma_f32_16x16x32_bf16 v[72:75], v[120:123], v[208:211], v[72:75]
    v_mfma_f32_16x16x32_bf16 v[76:79], v[140:143], v[208:211], v[76:79]
    v_mfma_f32_16x16x32_bf16 v[80:83], v[220:223], v[208:211], v[80:83]
    v_mfma_f32_16x16x32_bf16 v[84:87], v[124:127], v[232:235], v[84:87]
    v_mfma_f32_16x16x32_bf16 v[88:91], v[108:111], v[232:235], v[88:91]
    v_mfma_f32_16x16x32_bf16 v[92:95], v[120:123], v[232:235], v[92:95]
    v_mfma_f32_16x16x32_bf16 v[96:99], v[140:143], v[232:235], v[96:99]
    v_mfma_f32_16x16x32_bf16 v[100:103], v[220:223], v[232:235], v[100:103]
    s_waitcnt vmcnt(4)
    s_waitcnt lgkmcnt(0)
    v_mfma_f32_16x16x32_bf16 v[24:27], v[196:199], v[236:239], v[24:27]
    v_mfma_f32_16x16x32_bf16 v[28:31], v[200:203], v[236:239], v[28:31]
    v_mfma_f32_16x16x32_bf16 v[32:35], v[240:243], v[236:239], v[32:35]
    v_mfma_f32_16x16x32_bf16 v[36:39], v[244:247], v[236:239], v[36:39]
    ds_read_b128 v[228:231], v8 offset:0
    v_mfma_f32_16x16x32_bf16 v[40:43], v[184:187], v[236:239], v[40:43]
    ds_read_b128 v[212:215], v8 offset:2048
    v_mfma_f32_16x16x32_bf16 v[44:47], v[196:199], v[152:155], v[44:47]
    ds_read_b128 v[248:251], v8 offset:4096
    v_mfma_f32_16x16x32_bf16 v[48:51], v[200:203], v[152:155], v[48:51]
    ds_read_b128 v[144:147], v8 offset:6144
    v_mfma_f32_16x16x32_bf16 v[52:55], v[240:243], v[152:155], v[52:55]
    ds_read_b128 v[148:151], v8 offset:8192
    v_mfma_f32_16x16x32_bf16 v[56:59], v[244:247], v[152:155], v[56:59]
    v_mfma_f32_16x16x32_bf16 v[60:63], v[184:187], v[152:155], v[60:63]
    v_mfma_f32_16x16x32_bf16 v[64:67], v[196:199], v[132:135], v[64:67]
    v_mfma_f32_16x16x32_bf16 v[68:71], v[200:203], v[132:135], v[68:71]
    v_mfma_f32_16x16x32_bf16 v[72:75], v[240:243], v[132:135], v[72:75]
    v_mfma_f32_16x16x32_bf16 v[76:79], v[244:247], v[132:135], v[76:79]
    v_mfma_f32_16x16x32_bf16 v[80:83], v[184:187], v[132:135], v[80:83]
    v_mfma_f32_16x16x32_bf16 v[84:87], v[196:199], v[128:131], v[84:87]
    v_mfma_f32_16x16x32_bf16 v[88:91], v[200:203], v[128:131], v[88:91]
    v_mfma_f32_16x16x32_bf16 v[92:95], v[240:243], v[128:131], v[92:95]
    v_mfma_f32_16x16x32_bf16 v[96:99], v[244:247], v[128:131], v[96:99]
    v_mfma_f32_16x16x32_bf16 v[100:103], v[184:187], v[128:131], v[100:103]
    s_waitcnt vmcnt(0)
    s_waitcnt lgkmcnt(0)
    v_mfma_f32_16x16x32_bf16 v[44:47], v[228:231], v[172:175], v[44:47]
    v_mfma_f32_16x16x32_bf16 v[48:51], v[212:215], v[172:175], v[48:51]
    v_mfma_f32_16x16x32_bf16 v[52:55], v[248:251], v[172:175], v[52:55]
    v_mfma_f32_16x16x32_bf16 v[56:59], v[144:147], v[172:175], v[56:59]
    v_mfma_f32_16x16x32_bf16 v[60:63], v[148:151], v[172:175], v[60:63]
    v_mfma_f32_16x16x32_bf16 v[64:67], v[228:231], v[156:159], v[64:67]
    v_mfma_f32_16x16x32_bf16 v[68:71], v[212:215], v[156:159], v[68:71]
    v_mfma_f32_16x16x32_bf16 v[72:75], v[248:251], v[156:159], v[72:75]
    v_mfma_f32_16x16x32_bf16 v[76:79], v[144:147], v[156:159], v[76:79]
    ds_write_b128 v11, v[44:47] offset:5120
    v_mfma_f32_16x16x32_bf16 v[80:83], v[148:151], v[156:159], v[80:83]
    ds_write_b128 v11, v[48:51] offset:6144
    v_mfma_f32_16x16x32_bf16 v[84:87], v[228:231], v[188:191], v[84:87]
    ds_write_b128 v11, v[52:55] offset:7168
    v_mfma_f32_16x16x32_bf16 v[88:91], v[212:215], v[188:191], v[88:91]
    ds_write_b128 v11, v[56:59] offset:8192
    v_mfma_f32_16x16x32_bf16 v[92:95], v[248:251], v[188:191], v[92:95]
    ds_write_b128 v11, v[60:63] offset:9216
    v_mfma_f32_16x16x32_bf16 v[96:99], v[144:147], v[188:191], v[96:99]
    ds_write_b128 v11, v[64:67] offset:40960
    v_mfma_f32_16x16x32_bf16 v[100:103], v[148:151], v[188:191], v[100:103]
    ds_write_b128 v11, v[68:71] offset:41984
    v_mfma_f32_16x16x32_bf16 v[24:27], v[228:231], v[216:219], v[24:27]
    ds_write_b128 v11, v[72:75] offset:43008
    v_mfma_f32_16x16x32_bf16 v[28:31], v[212:215], v[216:219], v[28:31]
    ds_write_b128 v11, v[76:79] offset:44032
    v_mfma_f32_16x16x32_bf16 v[32:35], v[248:251], v[216:219], v[32:35]
    ds_write_b128 v11, v[80:83] offset:45056
    v_mfma_f32_16x16x32_bf16 v[36:39], v[144:147], v[216:219], v[36:39]
    ds_write_b128 v11, v[84:87] offset:46080
    v_mfma_f32_16x16x32_bf16 v[40:43], v[148:151], v[216:219], v[40:43]
    ds_write_b128 v11, v[88:91] offset:47104
parallel_sum__ssm_conv_s5__geglu_ffn__prompt_kernel_red:
    ds_write_b128 v11, v[92:95] offset:48128
    ds_write_b128 v11, v[96:99] offset:49152
    ds_write_b128 v11, v[100:103] offset:50176
    s_sub_u32 s44, s22, 1
    s_and_b32 s44, s44, 3
    s_mul_i32 s44, s44, 10240
    s_add_u32 s44, s44, 5120
    v_add_u32 v13, s44, v9
    s_sub_u32 s44, s22, 2
    s_and_b32 s44, s44, 3
    s_mul_i32 s44, s44, 10240
    s_add_u32 s44, s44, 40960
    v_add_u32_e64 v14, s44, v9
    s_sub_u32 s44, s22, 3
    s_and_b32 s44, s44, 3
    s_mul_i32 s44, s44, 10240
    s_add_u32 s44, s44, 46080
    v_add_u32_e64 v15, s44, v9
    s_waitcnt lgkmcnt(0)
    s_barrier
    ds_read_b128 v[104:107], v13 offset:0
    ds_read_b128 v[108:111], v14 offset:0
    ds_read_b128 v[112:115], v15 offset:0
    ds_read_b128 v[116:119], v13 offset:1024
    ds_read_b128 v[120:123], v14 offset:1024
    ds_read_b128 v[124:127], v15 offset:1024
    ds_read_b128 v[128:131], v13 offset:2048
    ds_read_b128 v[132:135], v14 offset:2048
    ds_read_b128 v[136:139], v15 offset:2048
    ds_read_b128 v[140:143], v13 offset:3072
    ds_read_b128 v[144:147], v14 offset:3072
    ds_read_b128 v[148:151], v15 offset:3072
    ds_read_b128 v[152:155], v13 offset:4096
    ds_read_b128 v[156:159], v14 offset:4096
    ds_read_b128 v[160:163], v15 offset:4096
    s_waitcnt lgkmcnt(12)
    s_nop 0
    v_pk_add_f32 v[104:105], v[104:105], v[108:109] op_sel:[0,0] op_sel_hi:[1,1]
    v_pk_add_f32 v[24:25], v[24:25], v[112:113] op_sel:[0,0] op_sel_hi:[1,1]
    v_pk_add_f32 v[106:107], v[106:107], v[110:111] op_sel:[0,0] op_sel_hi:[1,1]
    v_pk_add_f32 v[26:27], v[26:27], v[114:115] op_sel:[0,0] op_sel_hi:[1,1]
    v_pk_add_f32 v[24:25], v[24:25], v[104:105] op_sel:[0,0] op_sel_hi:[1,1]
    v_pk_add_f32 v[26:27], v[26:27], v[106:107] op_sel:[0,0] op_sel_hi:[1,1]
    buffer_store_dwordx4 v[24:27], v10, s[24:27], 0 offen offset:0
    s_waitcnt lgkmcnt(9)
    s_nop 0
    v_pk_add_f32 v[116:117], v[116:117], v[120:121] op_sel:[0,0] op_sel_hi:[1,1]
    v_pk_add_f32 v[28:29], v[28:29], v[124:125] op_sel:[0,0] op_sel_hi:[1,1]
    v_pk_add_f32 v[118:119], v[118:119], v[122:123] op_sel:[0,0] op_sel_hi:[1,1]
    v_pk_add_f32 v[30:31], v[30:31], v[126:127] op_sel:[0,0] op_sel_hi:[1,1]
    v_pk_add_f32 v[28:29], v[28:29], v[116:117] op_sel:[0,0] op_sel_hi:[1,1]
    v_pk_add_f32 v[30:31], v[30:31], v[118:119] op_sel:[0,0] op_sel_hi:[1,1]
    buffer_store_dwordx4 v[28:31], v10, s[24:27], 0 offen offset:64
    s_waitcnt lgkmcnt(6)
    s_nop 0
    v_pk_add_f32 v[128:129], v[128:129], v[132:133] op_sel:[0,0] op_sel_hi:[1,1]
    v_pk_add_f32 v[32:33], v[32:33], v[136:137] op_sel:[0,0] op_sel_hi:[1,1]
    v_pk_add_f32 v[130:131], v[130:131], v[134:135] op_sel:[0,0] op_sel_hi:[1,1]
    v_pk_add_f32 v[34:35], v[34:35], v[138:139] op_sel:[0,0] op_sel_hi:[1,1]
    v_pk_add_f32 v[32:33], v[32:33], v[128:129] op_sel:[0,0] op_sel_hi:[1,1]
    v_pk_add_f32 v[34:35], v[34:35], v[130:131] op_sel:[0,0] op_sel_hi:[1,1]
    buffer_store_dwordx4 v[32:35], v10, s[24:27], 0 offen offset:128
    s_waitcnt lgkmcnt(3)
    s_nop 0
    v_pk_add_f32 v[140:141], v[140:141], v[144:145] op_sel:[0,0] op_sel_hi:[1,1]
    v_pk_add_f32 v[36:37], v[36:37], v[148:149] op_sel:[0,0] op_sel_hi:[1,1]
    v_pk_add_f32 v[142:143], v[142:143], v[146:147] op_sel:[0,0] op_sel_hi:[1,1]
    v_pk_add_f32 v[38:39], v[38:39], v[150:151] op_sel:[0,0] op_sel_hi:[1,1]
    v_pk_add_f32 v[36:37], v[36:37], v[140:141] op_sel:[0,0] op_sel_hi:[1,1]
    v_pk_add_f32 v[38:39], v[38:39], v[142:143] op_sel:[0,0] op_sel_hi:[1,1]
    buffer_store_dwordx4 v[36:39], v10, s[24:27], 0 offen offset:192
    s_waitcnt lgkmcnt(0)
    s_nop 0
    v_pk_add_f32 v[152:153], v[152:153], v[156:157] op_sel:[0,0] op_sel_hi:[1,1]
    v_pk_add_f32 v[40:41], v[40:41], v[160:161] op_sel:[0,0] op_sel_hi:[1,1]
    v_pk_add_f32 v[154:155], v[154:155], v[158:159] op_sel:[0,0] op_sel_hi:[1,1]
    v_pk_add_f32 v[42:43], v[42:43], v[162:163] op_sel:[0,0] op_sel_hi:[1,1]
    v_pk_add_f32 v[40:41], v[40:41], v[152:153] op_sel:[0,0] op_sel_hi:[1,1]
    v_pk_add_f32 v[42:43], v[42:43], v[154:155] op_sel:[0,0] op_sel_hi:[1,1]
    buffer_store_dwordx4 v[40:43], v10, s[24:27], s87 offen
    s_endpgm
parallel_sum__ssm_conv_s5__geglu_ffn__prompt_kernel_sread:
    s_cmp_eq_u32 s20, 1
    s_cbranch_scc1 parallel_sum__ssm_conv_s5__geglu_ffn__prompt_kernel_hq_37
    s_nop 0
    ds_read_b64_tr_b16 v[204:205], v22 offset:0
    ds_read_b64_tr_b16 v[206:207], v22 offset:512
    ds_read_b64_tr_b16 v[212:213], v23 offset:0
    ds_read_b64_tr_b16 v[214:215], v23 offset:512
    ds_read_b64_tr_b16 v[220:221], v22 offset:8192
    ds_read_b64_tr_b16 v[222:223], v22 offset:8704
    ds_read_b64_tr_b16 v[228:229], v23 offset:8192
    ds_read_b64_tr_b16 v[230:231], v23 offset:8704
    ds_read_b64_tr_b16 v[208:209], v22 offset:4096
    ds_read_b64_tr_b16 v[210:211], v22 offset:4608
    ds_read_b64_tr_b16 v[216:217], v23 offset:4096
    ds_read_b64_tr_b16 v[218:219], v23 offset:4608
    ds_read_b64_tr_b16 v[224:225], v22 offset:12288
    ds_read_b64_tr_b16 v[226:227], v22 offset:12800
    ds_read_b64_tr_b16 v[232:233], v23 offset:12288
    ds_read_b64_tr_b16 v[234:235], v23 offset:12800
    s_setpc_b64 s[14:15]
parallel_sum__ssm_conv_s5__geglu_ffn__prompt_kernel_hq_37:
    s_nop 0
    ds_read_b128 v[204:207], v22 offset:0
    ds_read_b128 v[212:215], v22 offset:2048
    ds_read_b128 v[220:223], v22 offset:8192
    ds_read_b128 v[228:231], v22 offset:10240
    ds_read_b128 v[208:211], v23 offset:0
    ds_read_b128 v[216:219], v23 offset:2048
    ds_read_b128 v[224:227], v23 offset:8192
    ds_read_b128 v[232:235], v23 offset:10240
    s_setpc_b64 s[14:15]
parallel_sum__ssm_conv_s5__geglu_ffn__prompt_kernel_spub:
    s_setprio 3
    v_mfma_f32_16x16x32_bf16 v[236:239], v[28:31], v[204:207], 0
    v_mfma_f32_16x16x32_bf16 v[236:239], v[28:31], v[208:211], v[236:239]
    v_mfma_f32_16x16x32_bf16 v[236:239], v[32:35], v[212:215], v[236:239]
    v_mfma_f32_16x16x32_bf16 v[236:239], v[32:35], v[216:219], v[236:239]
    v_mfma_f32_16x16x32_bf16 v[236:239], v[36:39], v[220:223], v[236:239]
    v_mfma_f32_16x16x32_bf16 v[236:239], v[36:39], v[224:227], v[236:239]
    v_mfma_f32_16x16x32_bf16 v[236:239], v[40:43], v[228:231], v[236:239]
    v_mfma_f32_16x16x32_bf16 v[236:239], v[40:43], v[232:235], v[236:239]
    s_setprio 0
    s_nop 7
    s_setpc_b64 s[14:15]
parallel_sum__ssm_conv_s5__geglu_ffn__prompt_kernel_spare:
    s_waitcnt lgkmcnt(0)
    s_mov_b32 s40, s92
    s_mov_b32 s41, s93
    s_mov_b32 s42, 0x100
    s_mov_b32 s43, 0x00020000
    v_mov_b32 v6, 0
    s_setprio 0
    s_mov_b32 s28, s94
    s_mov_b32 s29, s95
    s_mov_b32 s30, 0x1800000
    s_mov_b32 s31, 0x00020000
    s_mov_b32 s24, s64
    s_mov_b32 s25, s65
    s_mov_b32 s26, 0x280000
    s_mov_b32 s27, 0x00020000
    v_lshlrev_b32 v9, 4, v2
    s_and_b32 s44, s2, 1
    s_lshl_b32 s8, s44, 4
    s_lshr_b32 s45, s2, 3
    s_and_b32 s44, s2, 6
    s_lshl_b32 s44, s44, 1
    s_add_u32 s8, s8, s44
    s_lshr_b32 s46, s45, 3
    s_add_u32 s8, s8, s46
    s_and_b32 s9, s45, 7
    s_mul_i32 s46, s8, 88
    s_mul_i32 s44, s22, 12
    s_add_u32 s44, s44, 40
    s_add_u32 s45, s46, s44
    s_lshl_b32 s84, s45, 12
    s_mul_i32 s44, s22, 10
    s_add_u32 s44, s44, 0
    s_add_u32 s45, s46, s44
    s_lshl_b32 s85, s45, 12
    s_mul_i32 s70, s22, 491520
    s_lshl_b32 s44, s9, 7
    s_add_u32 s70, s70, s44
    s_lshl_b32 s67, s9, 2
    s_add_u32 s67, s67, s22
    s_mul_i32 s68, s67, 3
    s_nop 0
    s_mul_i32 s67, s67, 12288
    s_add_u32 s67, s67, 0xb00000
    s_mul_i32 s69, s9, -61440
    s_add_u32 s69, s69, 586752
    s_mul_i32 s87, s9, -48
    s_add_u32 s87, s87, 512
    s_mul_i32 s44, s9, 81920
    s_mul_i32 s45, s22, 5
    s_lshr_b32 s82, s45, 1
    s_lshl_b32 s86, s82, 7
    s_add_u32 s86, s86, s44
    s_add_u32 s45, s45, 1
    s_lshr_b32 s45, s45, 1
    s_lshl_b32 s66, s45, 7
    s_add_u32 s66, s66, s44
    s_lshl_b32 s44, s8, 2
    s_mul_i32 s45, s44, 57
    s_lshr_b32 s46, s45, 9
    s_add_u32 s44, s44, 3
    s_mul_i32 s45, s44, 57
    s_lshr_b32 s83, s45, 9
    s_sub_u32 s83, s83, s46
    s_lshl_b32 s83, s83, 14
    s_lshl_b32 s46, s46, 14
    s_add_u32 s46, s46, 0x1030000
    s_mul_i32 s44, s22, 1536
    s_add_u32 s78, s46, s44
    s_lshl_b32 s44, s82, 8
    s_add_u32 s79, s46, s44
    s_add_u32 s79, s79, 6144
    s_mul_i32 s73, s22, 10240
    v_min_u32 v12, 35, v2
    s_mul_i32 s44, s22, 36
    v_add_u32 v1, s44, v12
    v_and_b32 v13, 1, v12
    v_mul_u32_u24 v13, 18, v13
    v_lshrrev_b32 v14, 1, v12
    v_add3_u32 v13, v13, v14, s44
    s_cmp_eq_u32 s20, 1
    s_cselect_b64 vcc, -1, 0
    s_mul_i32 s44, s18, 144
    s_lshl_b32 s45, s8, 6
    v_cndmask_b32 v13, v1, v13, vcc
    v_add_u32 v13, s44, v13
    v_min_u32 v13, 0x7ff, v13
    s_lshl_b32 s46, s22, 4
    s_add_u32 s45, s45, s46
    s_sub_u32 s46, s45, 48
    v_add_u32 v14, s46, v2
    v_cmp_eq_u32 vcc, 3, v5
    v_and_b32 v15, 31, v2
    v_lshrrev_b32 v12, 5, v2
    v_cndmask_b32 v13, v13, v14, vcc
    v_subrev_u32 v14, 36, v2
    v_cmp_gt_u32 vcc, 3, v14
    v_add_lshl_u32 v14, s68, v14, 3
    s_nop 0
    v_cndmask_b32 v13, v13, v14, vcc
    v_lshlrev_b32 v4, 4, v13
    v_mul_u32_u24 v13, 10240, v12
    v_lshl_add_u32 v25, v15, 4, v13
    v_lshl_add_u32 v13, v15, 1, v12
    s_lshl_b32 s44, s22, 8
    s_add_u32 s44, s44, 161920
    v_lshl_add_u32 v26, v13, 2, s44
    v_lshrrev_b32 v13, 3, v2
    v_mul_u32_u24 v13, 1280, v13
    v_and_b32 v14, 7, v2
    v_lshlrev_b32 v15, 1, v5
    v_xor_b32 v15, v14, v15
    v_lshl_add_u32 v0, v15, 4, v13
    v_xor_b32 v14, v14, v5
    v_lshl_add_u32 v254, v14, 4, v13
    v_xor_b32 v255, 64, v254
    v_lshrrev_b32 v13, 2, v2
    v_lshlrev_b32 v13, 7, v13
    v_and_b32 v14, 3, v2
    v_lshl_add_u32 v13, v14, 3, v13
    v_bfe_u32 v14, v2, 3, 2
    v_lshl_add_u32 v13, v14, 5, v13
    v_add_u32 v3, s73, v13
    v_xor_b32 v7, 32, v3
    v_xor_b32 v16, 64, v3
    v_xor_b32 v17, 96, v3
    v_add_u32 v19, s73, v9
    s_mul_i32 s71, s45, 1280
    s_lshl_b32 s44, s9, 7
    s_add_u32 s71, s71, s44
    s_lshl_b32 s72, s22, 11
    s_add_u32 s72, s72, 153600
    v_and_b32 v12, 15, v2
    v_lshlrev_b32_e64 v13, 7, v12
    v_lshl_add_u32 v13, v5, 3, v13
    v_bfe_u32 v14, v2, 1, 2
    v_lshl_add_u32 v13, v14, 5, v13
    v_add_u32 v100, s72, v13
    v_xor_b32 v101, 32, v100
    v_xor_b32_e64 v102, 64, v100
    v_xor_b32 v103, 96, v100
    v_mul_u32_u24 v12, 1280, v12
    v_lshl_add_u32 v96, v5, 3, v12
    v_lshl_add_u32 v97, v5, 3, s44
    v_mov_b32 v8, 0
    s_mov_b32 s5, 0
parallel_sum__ssm_conv_s5__geglu_ffn__prompt_kernel_tg_38:
    v_cmp_eq_u32 vcc, 0, v8
    s_add_u32 s5, s5, 1
    s_nop 3
    s_cbranch_vccz parallel_sum__ssm_conv_s5__geglu_ffn__prompt_kernel_tgo_39
    s_cmp_ge_u32 s5, 0x20000
    s_cbranch_scc1 parallel_sum__ssm_conv_s5__geglu_ffn__prompt_kernel_tgo_39
    s_sleep 2
    buffer_load_dword v8, v6, s[40:43], 0 offen sc1
    s_waitcnt vmcnt(0)
    s_branch parallel_sum__ssm_conv_s5__geglu_ffn__prompt_kernel_tg_38
parallel_sum__ssm_conv_s5__geglu_ffn__prompt_kernel_tgo_39:
    v_readfirstlane_b32 s4, v8
    s_barrier
    v_lshlrev_b32_e64 v12, 3, v2
    v_add_u32 v12, 161792, v12
    ds_read_b32 v240, v12
    ds_read_b32 v242, v12 offset:4
    s_lshl_b32 s44, s3, 7
    s_add_u32 s44, s44, 0xe70000
    s_cmp_eq_u32 s22, 0
    s_cselect_b32 s44, s44, 0x7f000000
    v_mov_b32 v241, s4
    v_mov_b32 v243, s4
    s_mov_b64 exec, 0xff
    s_waitcnt lgkmcnt(0)
    buffer_store_dwordx4 v[240:243], v9, s[28:31], s44 offen sc1
    s_mov_b64 exec, -1
    s_barrier
    s_mov_b32 s36, s80
    s_mov_b32 s37, s81
    s_mov_b32 s38, 0x500
    s_mov_b32 s39, 0x00020000
    s_lshl_b32 s44, s87, 1
    buffer_load_dwordx2 v[86:87], v97, s[36:39], 0 offen offset:0
    buffer_load_dwordx2 v[88:89], v97, s[36:39], 0 offen offset:32
    buffer_load_dwordx2 v[90:91], v97, s[36:39], 0 offen offset:64
    buffer_load_dwordx2 v[92:93], v97, s[36:39], 0 offen offset:96
    buffer_load_dwordx2 v[94:95], v97, s[36:39], s44 offen
    s_add_u32 s44, s44, s71
    buffer_load_dwordx2 v[84:85], v96, s[24:27], s44 offen
    s_mov_b32 s36, s88
    s_mov_b32 s37, s89
    s_mov_b32 s38, 0x1e0000
    s_mov_b32 s39, 0x00020000
    s_mov_b32 m0, s72
    s_add_u32 s44, s71, 9216
    buffer_load_dwordx4 v0, s[24:27], s71 offen lds
    buffer_load_dwordx4 v0, s[24:27], s44 offen offset:1024 lds
    s_mov_b32 s44, 0xe70000
    buffer_load_dwordx4 v[44:47], v4, s[28:31], s44 offen sc1
    s_waitcnt vmcnt(0)
    ds_read_b64 v[76:77], v100
    ds_read_b64 v[78:79], v101
    ds_read_b64 v[80:81], v102
    ds_read_b64 v[82:83], v103
    s_mov_b32 s5, 0
parallel_sum__ssm_conv_s5__geglu_ffn__prompt_kernel_sr_40:
    v_xor_b32 v68, s4, v45
    v_bitop3_b32 v68, v68, s4, v47 bitop3:0xf6
    v_cmp_ne_u32 vcc, 0, v68
    s_add_u32 s5, s5, 1
    s_nop 3
    s_cbranch_vccz parallel_sum__ssm_conv_s5__geglu_ffn__prompt_kernel_sro_41
    s_cmp_ge_u32 s5, 0x20000
    s_cbranch_scc1 parallel_sum__ssm_conv_s5__geglu_ffn__prompt_kernel_sro_41
    s_sleep 2
    s_mov_b32 s44, 0xe70000
    buffer_load_dwordx4 v[44:47], v4, s[28:31], s44 offen sc1
    s_waitcnt vmcnt(0)
    s_branch parallel_sum__ssm_conv_s5__geglu_ffn__prompt_kernel_sr_40
parallel_sum__ssm_conv_s5__geglu_ffn__prompt_kernel_sro_41:
    v_rcp_f32 v45, v46
    v_or_b32 v12, 48, v2
    v_lshlrev_b32 v12, 2, v12
    ds_bpermute_b32 v20, v12, v44
    ds_bpermute_b32 v21, v12, v45
    s_add_u32 m0, s73, 0
    s_add_u32 s46, s70, 0
    buffer_load_dwordx4 v0, s[36:39], s46 offen offset:0 lds
    s_add_u32 s46, s70, 9216
    buffer_load_dwordx4 v0, s[36:39], s46 offen offset:1024 lds
    s_add_u32 s46, s70, 18432
    buffer_load_dwordx4 v0, s[36:39], s46 offen offset:2048 lds
    s_add_u32 s46, s70, 27648
    buffer_load_dwordx4 v0, s[36:39], s46 offen offset:3072 lds
    s_add_u32 m0, s73, 4096
    s_add_u32 s46, s67, 0
    buffer_load_dwordx4 v9, s[28:31], s46 offen sc1 lds
    s_add_u32 m0, s73, 5120
    s_add_u32 s46, s70, 40960
    buffer_load_dwordx4 v0, s[36:39], s46 offen offset:0 lds
    s_add_u32 s46, s70, 50176
    buffer_load_dwordx4 v0, s[36:39], s46 offen offset:1024 lds
    s_add_u32 s46, s70, 59392
    buffer_load_dwordx4 v0, s[36:39], s46 offen offset:2048 lds
    s_add_u32 s46, s70, 68608
    buffer_load_dwordx4 v0, s[36:39], s46 offen offset:3072 lds
    s_add_u32 m0, s73, 9216
    s_add_u32 s46, s67, 1024
    buffer_load_dwordx4 v9, s[28:31], s46 offen sc1 lds
    s_add_u32 m0, s73, 40960
    s_add_u32 s46, s70, 122880
    buffer_load_dwordx4 v0, s[36:39], s46 offen offset:0 lds
    s_add_u32 s46, s70, 132096
    buffer_load_dwordx4 v0, s[36:39], s46 offen offset:1024 lds
    s_add_u32 s46, s70, 141312
    buffer_load_dwordx4 v0, s[36:39], s46 offen offset:2048 lds
    s_add_u32 s46, s70, 150528
    buffer_load_dwordx4 v0, s[36:39], s46 offen offset:3072 lds
    s_add_u32 m0, s73, 45056
    s_add_u32 s46, s67, 3072
    buffer_load_dwordx4 v9, s[28:31], s46 offen sc1 lds
    s_add_u32 m0, s73, 46080
    s_add_u32 s46, s70, 204800
    buffer_load_dwordx4 v0, s[36:39], s46 offen offset:0 lds
    s_add_u32 s46, s70, 214016
    buffer_load_dwordx4 v0, s[36:39], s46 offen offset:1024 lds
    s_add_u32 s46, s70, 223232
    buffer_load_dwordx4 v0, s[36:39], s46 offen offset:2048 lds
    s_add_u32 s46, s70, 232448
    buffer_load_dwordx4 v0, s[36:39], s46 offen offset:3072 lds
    s_add_u32 m0, s73, 50176
    s_add_u32 s46, s67, 5120
    buffer_load_dwordx4 v9, s[28:31], s46 offen sc1 lds
    s_mov_b32 s20, 0
    s_waitcnt vmcnt(0) lgkmcnt(0)
    v_lshlrev_b32 v104, 16, v76
    v_and_b32 v105, 0xffff0000, v76
    v_lshlrev_b32 v106, 16, v77
    v_and_b32 v107, 0xffff0000, v77
    v_lshlrev_b32 v108, 16, v78
    v_and_b32 v109, 0xffff0000, v78
    v_lshlrev_b32 v110, 16, v79
    v_and_b32 v111, 0xffff0000, v79
    v_lshlrev_b32 v112, 16, v80
    v_and_b32 v113, 0xffff0000, v80
    v_lshlrev_b32 v114, 16, v81
    v_and_b32 v115, 0xffff0000, v81
    v_lshlrev_b32 v116, 16, v82
    v_and_b32 v117, 0xffff0000, v82
    v_lshlrev_b32 v118, 16, v83
    v_and_b32 v119, 0xffff0000, v83
    v_lshlrev_b32 v120, 16, v84
    v_and_b32 v121, 0xffff0000, v84
    v_lshlrev_b32 v122, 16, v85
    v_and_b32 v123, 0xffff0000, v85
    v_lshlrev_b32 v124, 16, v86
    v_and_b32 v125, 0xffff0000, v86
    v_lshlrev_b32 v126, 16, v87
    v_and_b32 v127, 0xffff0000, v87
    v_lshlrev_b32 v128, 16, v88
    v_and_b32 v129, 0xffff0000, v88
    v_lshlrev_b32 v130, 16, v89
    v_and_b32 v131, 0xffff0000, v89
    v_lshlrev_b32 v132, 16, v90
    v_and_b32 v133, 0xffff0000, v90
    v_lshlrev_b32 v134, 16, v91
    v_and_b32 v135, 0xffff0000, v91
    v_lshlrev_b32 v136, 16, v92
    v_and_b32 v137, 0xffff0000, v92
    v_lshlrev_b32 v138, 16, v93
    v_and_b32 v139, 0xffff0000, v93
    v_lshlrev_b32 v140, 16, v94
    v_and_b32 v141, 0xffff0000, v94
    v_lshlrev_b32 v142, 16, v95
    v_and_b32 v143, 0xffff0000, v95
    s_branch parallel_sum__ssm_conv_s5__geglu_ffn__prompt_kernel_pre
parallel_sum__ssm_conv_s5__geglu_ffn__prompt_kernel_comp:
    v_and_b32 v12, 15, v2
    v_bfe_u32 v13, v2, 1, 3
    v_xor_b32 v13, v5, v13
    v_lshlrev_b32 v13, 4, v13
    v_lshl_add_u32 v20, v12, 7, v13
    v_xor_b32 v21, 64, v20
    v_lshrrev_b32 v13, 2, v12
    v_lshl_add_u32 v13, v5, 3, v13
    v_lshlrev_b32 v13, 7, v13
    v_and_b32_e64 v14, 3, v2
    v_lshl_add_u32 v13, v14, 3, v13
    v_bfe_u32 v14, v2, 3, 2
    s_lshl_b32 s44, s16, 1
    v_xor_b32 v15, s44, v14
    v_lshl_add_u32 v22, v15, 5, v13
    s_lshl_b32 s44, s16, 12
    v_add_u32 v23, s44, v20
    s_lshl_b32 s45, s17, 14
    s_add_u32 s45, s45, 18432
    s_cmp_eq_u32 s20, 1
    s_cselect_b64 vcc, -1, 0
    s_cselect_b32 s44, 64, 32
    s_nop 0
    v_cndmask_b32 v22, v22, v23, vcc
    v_add_u32 v22, s45, v22
    v_xor_b32 v23, s44, v22
    v_add_u32 v26, 102400, v20
    v_add_u32 v27, 102400, v21
    v_add_u32 v28, 102400, v22
    v_add_u32 v29, 102400, v23
    v_lshlrev_b32 v94, 3, v94
    v_add_u32 v94, 161792, v94
    v_lshlrev_b32 v1, 2, v2
    v_mov_b32_e64 v30, 0
    s_mov_b32 s40, s92
    s_mov_b32 s41, s93
    s_mov_b32 s42, 0x100
    s_mov_b32 s43, 0x00020000
    s_mov_b32 s28, s94
    s_mov_b32 s29, s95
    s_mov_b32 s30, 0x1800000
    s_mov_b32 s31, 0x00020000
    s_mov_b32 s36, s94
    s_mov_b32 s37, s95
    s_mov_b32 s38, 0xb00000
    s_mov_b32 s39, 0x00020000
    v_mov_b32 v100, 0
    v_mov_b32 v101, 0
    v_mov_b32 v102, 0
    v_mov_b32 v103, 0
    v_mov_b32 v104, 0
    v_mov_b32 v105, 0
    v_mov_b32 v106, 0
    v_mov_b32 v107, 0
    v_mov_b32 v108, 0
    v_mov_b32 v109, 0
    v_mov_b32 v110, 0
    v_mov_b32 v111, 0
    v_mov_b32 v112, 0
    v_mov_b32 v113, 0
    v_mov_b32 v114, 0
    v_mov_b32 v115, 0
    v_mov_b32 v116, 0
    v_mov_b32 v117, 0
    v_mov_b32 v118, 0
    v_mov_b32 v119, 0
    v_mov_b32 v120, 0
    v_mov_b32 v121, 0
    v_mov_b32 v122, 0
    v_mov_b32 v123, 0
    v_mov_b32 v124, 0
    v_mov_b32 v125, 0
    v_mov_b32 v126, 0
    v_mov_b32 v127, 0
    v_mov_b32 v128, 0
    v_mov_b32 v129, 0
    v_mov_b32 v130, 0
    v_mov_b32 v131, 0
    v_mov_b32 v132, 0
    v_mov_b32 v133, 0
    v_mov_b32 v134, 0
    v_mov_b32 v135, 0
    v_mov_b32 v136, 0
    v_mov_b32 v137, 0
    v_mov_b32 v138, 0
    v_mov_b32 v139, 0
    v_mov_b32 v140, 0
    v_mov_b32 v141, 0
    v_mov_b32 v142, 0
    v_mov_b32 v143, 0
    v_mov_b32 v144, 0
    v_mov_b32 v145, 0
    v_mov_b32 v146, 0
    v_mov_b32 v147, 0
    v_mov_b32 v148, 0
    v_mov_b32 v149, 0
    v_mov_b32 v150, 0
    v_mov_b32 v151, 0
    v_mov_b32 v152, 0
    v_mov_b32 v153, 0
    v_mov_b32 v154, 0
    v_mov_b32 v155, 0
    v_mov_b32 v156, 0
    v_mov_b32 v157, 0
    v_mov_b32 v158, 0
    v_mov_b32 v159, 0
    v_mov_b32 v160, 0
    v_mov_b32 v161, 0
    v_mov_b32 v162, 0
    v_mov_b32 v163, 0
    v_mov_b32 v164, 0
    v_mov_b32 v165, 0
    v_mov_b32 v166, 0
    v_mov_b32 v167, 0
    v_mov_b32 v168, 0
    v_mov_b32 v169, 0
    v_mov_b32 v170, 0
    v_mov_b32 v171, 0
    v_mov_b32 v172, 0
    v_mov_b32 v173, 0
    v_mov_b32 v174, 0
    v_mov_b32 v175, 0
    v_mov_b32 v176, 0
    v_mov_b32 v177, 0
    v_mov_b32 v178, 0
    v_mov_b32 v179, 0
    v_mov_b32 v180, 0
    v_mov_b32 v181, 0
    v_mov_b32 v182, 0
    v_mov_b32 v183, 0
    v_mov_b32 v184, 0
    v_mov_b32 v185, 0
    v_mov_b32 v186, 0
    v_mov_b32 v187, 0
    v_mov_b32 v188, 0
    v_mov_b32 v189, 0
    v_mov_b32 v190, 0
    v_mov_b32 v191, 0
    v_mov_b32 v192, 0
    v_mov_b32 v193, 0
    v_mov_b32 v194, 0
    v_mov_b32 v195, 0
    v_mov_b32 v196, 0
    v_mov_b32 v197, 0
    v_mov_b32 v198, 0
    v_mov_b32 v199, 0
    v_mov_b32 v200, 0
    v_mov_b32 v201, 0
    v_mov_b32 v202, 0
    v_mov_b32 v203, 0
    v_mov_b32 v204, 0
    v_mov_b32 v205, 0
    v_mov_b32 v206, 0
    v_mov_b32 v207, 0
    v_mov_b32 v208, 0
    v_mov_b32 v209, 0
    v_mov_b32 v210, 0
    v_mov_b32 v211, 0
    v_mov_b32 v212, 0
    v_mov_b32 v213, 0
    v_mov_b32 v214, 0
    v_mov_b32 v215, 0
    v_mov_b32 v216, 0
    v_mov_b32 v217, 0
    v_mov_b32 v218, 0
    v_mov_b32 v219, 0
    v_mov_b32 v220, 0
    v_mov_b32 v221, 0
    v_mov_b32 v222, 0
    v_mov_b32 v223, 0
    v_mov_b32 v224, 0
    v_mov_b32 v225, 0
    v_mov_b32 v226, 0
    v_mov_b32 v227, 0
    v_mov_b32 v228, 0
    v_mov_b32 v229, 0
    v_mov_b32 v230, 0
    v_mov_b32 v231, 0
    v_mov_b32 v232, 0
    v_mov_b32 v233, 0
    v_mov_b32 v234, 0
    v_mov_b32 v235, 0
    v_mov_b32 v236, 0
    v_mov_b32 v237, 0
    v_mov_b32 v238, 0
    v_mov_b32 v239, 0
    v_mov_b32 v240, 0
    v_mov_b32 v241, 0
    v_mov_b32 v242, 0
    v_mov_b32 v243, 0
    s_waitcnt vmcnt(6)
    v_lshlrev_b32 v44, 16, v32
    v_and_b32 v45, 0xffff0000, v32
    v_lshlrev_b32 v46, 16, v33
    v_and_b32 v47, 0xffff0000, v33
    v_lshlrev_b32 v48, 16, v34
    v_and_b32 v49, 0xffff0000, v34
    v_lshlrev_b32 v50, 16, v35
    v_and_b32 v51, 0xffff0000, v35
    v_lshlrev_b32 v52, 16, v36
    v_and_b32 v53, 0xffff0000, v36
    v_lshlrev_b32 v54, 16, v37
    v_and_b32 v55, 0xffff0000, v37
    v_lshlrev_b32 v56, 16, v38
    v_and_b32 v57, 0xffff0000, v38
    v_lshlrev_b32 v58, 16, v39
    v_and_b32 v59, 0xffff0000, v39
    v_lshlrev_b32 v60, 16, v40
    v_and_b32 v61, 0xffff0000, v40
    v_lshlrev_b32_e64 v62, 16, v41
    v_and_b32 v63, 0xffff0000, v41
    v_pk_add_f32 v[84:85], v[44:45], v[46:47] op_sel:[0,0] op_sel_hi:[1,1]
    v_pk_add_f32 v[86:87], v[48:49], v[50:51] op_sel:[0,0] op_sel_hi:[1,1]
    v_pk_add_f32 v[84:85], v[84:85], v[52:53] op_sel:[0,0] op_sel_hi:[1,1]
    v_pk_add_f32 v[86:87], v[86:87], v[54:55] op_sel:[0,0] op_sel_hi:[1,1]
    v_pk_add_f32 v[84:85], v[84:85], v[56:57] op_sel:[0,0] op_sel_hi:[1,1]
    v_pk_add_f32 v[86:87], v[86:87], v[58:59] op_sel:[0,0] op_sel_hi:[1,1]
    v_pk_add_f32 v[84:85], v[84:85], v[60:61] op_sel:[0,0] op_sel_hi:[1,1]
    v_pk_add_f32 v[86:87], v[86:87], v[62:63] op_sel:[0,0] op_sel_hi:[1,1]
    v_pk_add_f32 v[84:85], v[84:85], v[86:87] op_sel:[0,0] op_sel_hi:[1,1]
    v_add_f32 v84, v84, v85
    s_nop 1
    v_add_f32_dpp v84, v84, v84 row_ror:8 row_mask:0xf bank_mask:0xf
    s_nop 1
    v_add_f32_dpp v84, v84, v84 row_ror:4 row_mask:0xf bank_mask:0xf
    s_nop 1
    v_add_f32_dpp v84, v84, v84 row_ror:2 row_mask:0xf bank_mask:0xf
    s_nop 1
    v_add_f32_dpp v84, v84, v84 row_ror:1 row_mask:0xf bank_mask:0xf
    v_mov_b32 v85, v84
    s_nop 1
    v_permlane16_swap_b32 v84, v85
    s_nop 1
    v_add_f32 v84, v84, v85
    v_mul_f32 v84, 0x3acccccd, v84
    v_pk_add_f32 v[44:45], v[44:45], v[84:85] op_sel:[0,0] op_sel_hi:[1,0] neg_lo:[0,1] neg_hi:[0,1]
    v_pk_add_f32 v[46:47], v[46:47], v[84:85] op_sel:[0,0] op_sel_hi:[1,0] neg_lo:[0,1] neg_hi:[0,1]
    v_pk_add_f32 v[48:49], v[48:49], v[84:85] op_sel:[0,0] op_sel_hi:[1,0] neg_lo:[0,1] neg_hi:[0,1]
    v_pk_add_f32 v[50:51], v[50:51], v[84:85] op_sel:[0,0] op_sel_hi:[1,0] neg_lo:[0,1] neg_hi:[0,1]
    v_pk_add_f32 v[52:53], v[52:53], v[84:85] op_sel:[0,0] op_sel_hi:[1,0] neg_lo:[0,1] neg_hi:[0,1]
    v_pk_add_f32 v[54:55], v[54:55], v[84:85] op_sel:[0,0] op_sel_hi:[1,0] neg_lo:[0,1] neg_hi:[0,1]
    v_pk_add_f32 v[56:57], v[56:57], v[84:85] op_sel:[0,0] op_sel_hi:[1,0] neg_lo:[0,1] neg_hi:[0,1]
    v_pk_add_f32 v[58:59], v[58:59], v[84:85] op_sel:[0,0] op_sel_hi:[1,0] neg_lo:[0,1] neg_hi:[0,1]
    v_pk_add_f32 v[60:61], v[60:61], v[84:85] op_sel:[0,0] op_sel_hi:[1,0] neg_lo:[0,1] neg_hi:[0,1]
    v_pk_add_f32 v[62:63], v[62:63], v[84:85] op_sel:[0,0] op_sel_hi:[1,0] neg_lo:[0,1] neg_hi:[0,1]
    v_pk_mul_f32 v[86:87], v[44:45], v[44:45] op_sel:[0,0] op_sel_hi:[1,1]
    v_pk_mul_f32 v[88:89], v[46:47], v[46:47] op_sel:[0,0] op_sel_hi:[1,1]
    v_pk_fma_f32 v[86:87], v[48:49], v[48:49], v[86:87] op_sel:[0,0,0] op_sel_hi:[1,1,1]
    v_pk_fma_f32 v[88:89], v[50:51], v[50:51], v[88:89] op_sel:[0,0,0] op_sel_hi:[1,1,1]
    v_pk_fma_f32 v[86:87], v[52:53], v[52:53], v[86:87] op_sel:[0,0,0] op_sel_hi:[1,1,1]
    v_pk_fma_f32 v[88:89], v[54:55], v[54:55], v[88:89] op_sel:[0,0,0] op_sel_hi:[1,1,1]
    v_pk_fma_f32 v[86:87], v[56:57], v[56:57], v[86:87] op_sel:[0,0,0] op_sel_hi:[1,1,1]
    v_pk_fma_f32 v[88:89], v[58:59], v[58:59], v[88:89] op_sel:[0,0,0] op_sel_hi:[1,1,1]
    v_pk_fma_f32 v[86:87], v[60:61], v[60:61], v[86:87] op_sel:[0,0,0] op_sel_hi:[1,1,1]
    v_pk_fma_f32 v[88:89], v[62:63], v[62:63], v[88:89] op_sel:[0,0,0] op_sel_hi:[1,1,1]
    v_pk_add_f32 v[86:87], v[86:87], v[88:89] op_sel:[0,0] op_sel_hi:[1,1]
    v_add_f32 v86, v86, v87
    s_nop 1
    v_add_f32_dpp v86, v86, v86 row_ror:8 row_mask:0xf bank_mask:0xf
    s_nop 1
    v_add_f32_dpp v86, v86, v86 row_ror:4 row_mask:0xf bank_mask:0xf
    s_nop 1
    v_add_f32_dpp v86, v86, v86 row_ror:2 row_mask:0xf bank_mask:0xf
    s_nop 1
    v_add_f32_dpp v86, v86, v86 row_ror:1 row_mask:0xf bank_mask:0xf
    v_mov_b32 v87, v86
    s_nop 1
    v_permlane16_swap_b32 v86, v87
    s_nop 1
    v_add_f32 v86, v86, v87
    v_mul_f32 v86, 0x3acccccd, v86
    v_cvt_pk_bf16_f32 v88, v84, v86
    v_lshlrev_b32_e64 v90, 16, v88
    v_and_b32 v86, 0xffff0000, v88
    v_add_f32 v86, 0x3727c5ac, v86
    v_cvt_pk_bf16_f32 v88, v86, v86
    v_lshlrev_b32 v86, 16, v88
    v_sqrt_f32 v86, v86
    s_nop 0
    v_cvt_pk_bf16_f32 v88, v86, v86
    v_lshlrev_b32 v91, 16, v88
    ds_write_b64 v94, v[90:91]
    v_lshl_add_u32 v96, v2, 3, s51
    s_lshl_b32 s46, s50, 10
    s_add_u32 s46, s46, 0xb00000
    s_cmp_lt_u32 s50, 384
    s_cselect_b32 s46, s46, 0x7f000000
    v_lshlrev_b32_e64 v97, 4, v2
    s_waitcnt vmcnt(2)
    ds_read_b64_tr_b16 v[32:33], v96
    ds_read_b64_tr_b16 v[34:35], v96 offset:512
    s_waitcnt lgkmcnt(0)
    buffer_store_dwordx4 v[32:35], v97, s[28:31], s46 offen sc1
    s_mov_b32 s53, 102400
    s_mov_b32 s54, 0
    s_lshl_b32 s44, s18, 7
    s_lshl_b32 s45, s19, 2
    s_add_u32 s44, s44, s45
    s_add_u32 s44, s44, s22
    s_cmp_eq_u32 s20, 1
    s_cselect_b32 s45, 48, -20
    s_add_u32 s44, s44, s45
    s_lshl_b32 s44, s44, 7
    s_add_u32 s14, s44, 0x1030000
    s_mul_i32 s44, s19, 20480
    s_lshl_b32 s45, s22, 9
    s_add_u32 s44, s44, s45
    s_min_u32 s45, s18, 9
    s_lshl_b32 s45, s45, 11
    s_add_u32 s44, s44, s45
    s_add_u32 s44, s44, 0xed0000
    v_and_b32_e64 v12, 3, v2
    v_lshl_add_u32 v13, v12, 7, s44
    s_mul_i32 s44, s18, 10240
    s_min_u32 s45, s19, 4
    s_lshl_b32 s45, s45, 11
    s_add_u32 s44, s44, s45
    s_lshl_b32 s45, s22, 9
    s_add_u32 s44, s44, s45
    s_add_u32 s44, s44, 0xf30000
    v_lshl_add_u32 v14, v12, 7, s44
    v_cmp_gt_u32 vcc, 4, v2
    s_lshl_b32 s44, s3, 7
    s_add_u32 s44, s44, 0xe70000
    v_cndmask_b32 v13, v14, v13, vcc
    v_writelane_b32 v13, s44, 8
    v_writelane_b32 v13, s14, 9
    s_mov_b64 exec, 0x3ff
    buffer_load_dword v251, v13, s[28:31], 0 offen sc1
    s_mov_b64 exec, -1
    s_lshl_b32 s7, s19, 2
    s_add_u32 s7, s7, s22
    s_add_u32 s7, s7, 20
    s_lshl_b32 s44, s19, 1
    s_add_u32 s44, s44, s17
    s_lshl_b32 s44, s44, 2
    s_add_u32 s44, s44, s16
    s_cmp_eq_u32 s20, 1
    s_cselect_b32 s7, s44, s7
    s_cselect_b64 vcc, -1, 0
    s_lshl_b32 s7, s7, 2
    s_mul_i32 s6, s18, 9
    s_add_u32 s44, s6, 0
    s_lshr_b32 s45, s44, 2
    s_mul_i32 s45, s45, 348
    s_add_u32 s45, s45, s44
    s_add_u32 s45, s45, s7
    s_lshl_b32 s55, s45, 10
    s_add_u32 s44, s6, 1
    s_lshr_b32 s45, s44, 2
    s_mul_i32 s45, s45, 348
    s_add_u32 s45, s45, s44
    s_add_u32 s45, s45, s7
    s_lshl_b32 s56, s45, 10
    s_add_u32 s44, s6, 2
    s_lshr_b32 s45, s44, 2
    s_mul_i32 s45, s45, 348
    s_add_u32 s45, s45, s44
    s_add_u32 s45, s45, s7
    s_lshl_b32 s57, s45, 10
    s_add_u32 s44, s6, 3
    s_lshr_b32 s45, s44, 2
    s_mul_i32 s45, s45, 348
    s_add_u32 s45, s45, s44
    s_add_u32 s45, s45, s7
    s_lshl_b32 s58, s45, 10
    s_add_u32 s44, s6, 4
    s_lshr_b32 s45, s44, 2
    s_mul_i32 s45, s45, 348
    s_add_u32 s45, s45, s44
    s_add_u32 s45, s45, s7
    s_lshl_b32 s59, s45, 10
    s_add_u32 s44, s6, 5
    s_lshr_b32 s45, s44, 2
    s_mul_i32 s45, s45, 348
    s_add_u32 s45, s45, s44
    s_add_u32 s45, s45, s7
    s_lshl_b32 s60, s45, 10
    s_add_u32 s44, s6, 6
    s_lshr_b32 s45, s44, 2
    s_mul_i32 s45, s45, 348
    s_add_u32 s45, s45, s44
    s_add_u32 s45, s45, s7
    s_lshl_b32 s61, s45, 10
    s_add_u32 s44, s6, 7
    s_lshr_b32 s45, s44, 2
    s_mul_i32 s45, s45, 348
    s_add_u32 s45, s45, s44
    s_add_u32 s45, s45, s7
    s_lshl_b32 s62, s45, 10
    s_add_u32 s44, s6, 8
    s_lshr_b32 s45, s44, 2
    s_mul_i32 s45, s45, 348
    s_add_u32 s45, s45, s44
    s_add_u32 s45, s45, s7
    s_lshl_b32 s63, s45, 10
    v_and_b32 v4, 15, v2
    s_lshl_b32 s44, s22, 8
    s_add_u32 s44, s44, 161920
    v_lshl_add_u32 v24, v5, 4, s44
    v_lshl_add_u32 v12, v4, 2, s44
    v_cndmask_b32 v24, v24, v12, vcc
    v_lshlrev_b32 v25, 4, v4
    v_add_u32 v25, 153600, v25
    v_mul_u32_u24 v12, 144, v5
    v_add_u32 v12, 160768, v12
    v_cndmask_b32 v31, v25, v12, vcc
    buffer_load_dword v252, v30, s[40:43], 0 offen sc1
    s_waitcnt lgkmcnt(0)
    s_setprio 2
    s_cmp_eq_u32 s2, 0
    s_cbranch_scc1 parallel_sum__ssm_conv_s5__geglu_ffn__prompt_kernel_cspare
    s_cmp_eq_u32 s20, 1
    s_cbranch_scc1 parallel_sum__ssm_conv_s5__geglu_ffn__prompt_kernel_s
    s_barrier
    ds_read_b64_tr_b16 v[68:69], v28 offset:0
    ds_read_b64_tr_b16 v[70:71], v28 offset:512
    ds_read_b64_tr_b16 v[72:73], v29 offset:0
    ds_read_b64_tr_b16 v[74:75], v29 offset:512
    ds_read_b64_tr_b16 v[76:77], v28 offset:8192
    ds_read_b64_tr_b16 v[78:79], v28 offset:8704
    ds_read_b64_tr_b16 v[80:81], v29 offset:8192
    ds_read_b64_tr_b16 v[82:83], v29 offset:8704
    ds_read_b128 v[32:35], v26 offset:0
    ds_read_b128 v[36:39], v26 offset:2048
    ds_read_b128 v[40:43], v26 offset:4096
    ds_read_b128 v[44:47], v26 offset:6144
    ds_read_b128 v[48:51], v26 offset:8192
    ds_read_b128 v[52:55], v26 offset:10240
    ds_read_b128 v[56:59], v26 offset:12288
    ds_read_b128 v[60:63], v26 offset:14336
    ds_read_b128 v[64:67], v26 offset:16384
    s_waitcnt lgkmcnt(0)
.p2align 5
    s_nop 0
    s_nop 0
    s_nop 0
    s_nop 0
parallel_sum__ssm_conv_s5__geglu_ffn__prompt_kernel_loop_p:
    s_waitcnt lgkmcnt(7)
    v_mfma_f32_16x16x32_bf16 v[100:103], v[68:71], v[32:35], v[100:103]
    ds_read_b64_tr_b16 v[84:85], v28 offset:4096
    v_mfma_f32_16x16x32_bf16 v[104:107], v[72:75], v[32:35], v[104:107]
    ds_read_b64_tr_b16 v[86:87], v28 offset:4608
    v_mfma_f32_16x16x32_bf16 v[108:111], v[76:79], v[32:35], v[108:111]
    ds_read_b64_tr_b16 v[88:89], v29 offset:4096
    v_mfma_f32_16x16x32_bf16 v[112:115], v[80:83], v[32:35], v[112:115]
    ds_read_b64_tr_b16 v[90:91], v29 offset:4608
    v_mfma_f32_16x16x32_bf16 v[116:119], v[68:71], v[36:39], v[116:119]
    ds_read_b64_tr_b16 v[92:93], v28 offset:12288
    v_mfma_f32_16x16x32_bf16 v[120:123], v[72:75], v[36:39], v[120:123]
    ds_read_b64_tr_b16 v[94:95], v28 offset:12800
    v_mfma_f32_16x16x32_bf16 v[124:127], v[76:79], v[36:39], v[124:127]
    ds_read_b64_tr_b16 v[96:97], v29 offset:12288
    v_mfma_f32_16x16x32_bf16 v[128:131], v[80:83], v[36:39], v[128:131]
    ds_read_b64_tr_b16 v[98:99], v29 offset:12800
    s_waitcnt lgkmcnt(14)
    v_mfma_f32_16x16x32_bf16 v[132:135], v[68:71], v[40:43], v[132:135]
    ds_read_b128 v[32:35], v27 offset:0
    v_mfma_f32_16x16x32_bf16 v[136:139], v[72:75], v[40:43], v[136:139]
    ds_read_b128 v[36:39], v27 offset:2048
    v_mfma_f32_16x16x32_bf16 v[140:143], v[76:79], v[40:43], v[140:143]
    v_mfma_f32_16x16x32_bf16 v[144:147], v[80:83], v[40:43], v[144:147]
    ds_read_b128 v[40:43], v27 offset:4096
    v_mfma_f32_16x16x32_bf16 v[148:151], v[68:71], v[44:47], v[148:151]
    v_mfma_f32_16x16x32_bf16 v[152:155], v[72:75], v[44:47], v[152:155]
    v_mfma_f32_16x16x32_bf16 v[156:159], v[76:79], v[44:47], v[156:159]
    v_mfma_f32_16x16x32_bf16 v[160:163], v[80:83], v[44:47], v[160:163]
    ds_read_b128 v[44:47], v27 offset:6144
    v_mfma_f32_16x16x32_bf16 v[164:167], v[68:71], v[48:51], v[164:167]
    v_mfma_f32_16x16x32_bf16 v[168:171], v[72:75], v[48:51], v[168:171]
    v_mfma_f32_16x16x32_bf16 v[172:175], v[76:79], v[48:51], v[172:175]
    v_mfma_f32_16x16x32_bf16 v[176:179], v[80:83], v[48:51], v[176:179]
    ds_read_b128 v[48:51], v27 offset:8192
    v_mfma_f32_16x16x32_bf16 v[180:183], v[68:71], v[52:55], v[180:183]
    v_mfma_f32_16x16x32_bf16 v[184:187], v[72:75], v[52:55], v[184:187]
    v_mfma_f32_16x16x32_bf16 v[188:191], v[76:79], v[52:55], v[188:191]
    v_mfma_f32_16x16x32_bf16 v[192:195], v[80:83], v[52:55], v[192:195]
    ds_read_b128 v[52:55], v27 offset:10240
    v_mfma_f32_16x16x32_bf16 v[196:199], v[68:71], v[56:59], v[196:199]
    v_mfma_f32_16x16x32_bf16 v[200:203], v[72:75], v[56:59], v[200:203]
    v_mfma_f32_16x16x32_bf16 v[204:207], v[76:79], v[56:59], v[204:207]
    v_mfma_f32_16x16x32_bf16 v[208:211], v[80:83], v[56:59], v[208:211]
    ds_read_b128 v[56:59], v27 offset:12288
    v_mfma_f32_16x16x32_bf16 v[212:215], v[68:71], v[60:63], v[212:215]
    v_mfma_f32_16x16x32_bf16 v[216:219], v[72:75], v[60:63], v[216:219]
    v_mfma_f32_16x16x32_bf16 v[220:223], v[76:79], v[60:63], v[220:223]
    v_mfma_f32_16x16x32_bf16 v[224:227], v[80:83], v[60:63], v[224:227]
    ds_read_b128 v[60:63], v27 offset:14336
    v_mfma_f32_16x16x32_bf16 v[228:231], v[68:71], v[64:67], v[228:231]
    v_mfma_f32_16x16x32_bf16 v[232:235], v[72:75], v[64:67], v[232:235]
    v_mfma_f32_16x16x32_bf16 v[236:239], v[76:79], v[64:67], v[236:239]
    v_mfma_f32_16x16x32_bf16 v[240:243], v[80:83], v[64:67], v[240:243]
    ds_read_b128 v[64:67], v27 offset:16384
    s_add_u32 s54, s54, 1
    s_cmp_eq_u32 s54, 10
    s_cbranch_scc1 parallel_sum__ssm_conv_s5__geglu_ffn__prompt_kernel_tail_p
    s_waitcnt lgkmcnt(8)
    v_mfma_f32_16x16x32_bf16 v[100:103], v[84:87], v[32:35], v[100:103]
    s_add_u32 s53, s53, 51200
    s_cmp_eq_u32 s53, 153600
    v_mfma_f32_16x16x32_bf16 v[104:107], v[88:91], v[32:35], v[104:107]
    s_cselect_b32 s53, 0, s53
    v_add_u32 v26, s53, v20
    v_mfma_f32_16x16x32_bf16 v[108:111], v[92:95], v[32:35], v[108:111]
    v_add_u32 v27, s53, v21
    v_add_u32 v28, s53, v22
    v_mfma_f32_16x16x32_bf16 v[112:115], v[96:99], v[32:35], v[112:115]
    v_add_u32 v29, s53, v23
    s_waitcnt lgkmcnt(7)
    v_mfma_f32_16x16x32_bf16 v[116:119], v[84:87], v[36:39], v[116:119]
    v_mfma_f32_16x16x32_bf16 v[120:123], v[88:91], v[36:39], v[120:123]
    v_mfma_f32_16x16x32_bf16 v[124:127], v[92:95], v[36:39], v[124:127]
    v_mfma_f32_16x16x32_bf16 v[128:131], v[96:99], v[36:39], v[128:131]
    s_waitcnt vmcnt(0) lgkmcnt(0)
    s_barrier
    v_mfma_f32_16x16x32_bf16 v[132:135], v[84:87], v[40:43], v[132:135]
    ds_read_b128 v[32:35], v26 offset:0
    v_mfma_f32_16x16x32_bf16 v[136:139], v[88:91], v[40:43], v[136:139]
    ds_read_b128 v[36:39], v26 offset:2048
    v_mfma_f32_16x16x32_bf16 v[140:143], v[92:95], v[40:43], v[140:143]
    ds_read_b64_tr_b16 v[68:69], v28 offset:0
    v_mfma_f32_16x16x32_bf16 v[144:147], v[96:99], v[40:43], v[144:147]
    ds_read_b64_tr_b16 v[70:71], v28 offset:512
    v_mfma_f32_16x16x32_bf16 v[148:151], v[84:87], v[44:47], v[148:151]
    ds_read_b64_tr_b16 v[72:73], v29 offset:0
    v_mfma_f32_16x16x32_bf16 v[152:155], v[88:91], v[44:47], v[152:155]
    ds_read_b64_tr_b16 v[74:75], v29 offset:512
    v_mfma_f32_16x16x32_bf16 v[156:159], v[92:95], v[44:47], v[156:159]
    ds_read_b64_tr_b16 v[76:77], v28 offset:8192
    v_mfma_f32_16x16x32_bf16 v[160:163], v[96:99], v[44:47], v[160:163]
    ds_read_b64_tr_b16 v[78:79], v28 offset:8704
    v_mfma_f32_16x16x32_bf16 v[164:167], v[84:87], v[48:51], v[164:167]
    ds_read_b64_tr_b16 v[80:81], v29 offset:8192
    v_mfma_f32_16x16x32_bf16 v[168:171], v[88:91], v[48:51], v[168:171]
    ds_read_b64_tr_b16 v[82:83], v29 offset:8704
    v_mfma_f32_16x16x32_bf16 v[172:175], v[92:95], v[48:51], v[172:175]
    ds_read_b128 v[40:43], v26 offset:4096
    v_mfma_f32_16x16x32_bf16 v[176:179], v[96:99], v[48:51], v[176:179]
    ds_read_b128 v[44:47], v26 offset:6144
    v_mfma_f32_16x16x32_bf16 v[180:183], v[84:87], v[52:55], v[180:183]
    ds_read_b128 v[48:51], v26 offset:8192
    v_mfma_f32_16x16x32_bf16 v[184:187], v[88:91], v[52:55], v[184:187]
    v_mfma_f32_16x16x32_bf16 v[188:191], v[92:95], v[52:55], v[188:191]
    v_mfma_f32_16x16x32_bf16 v[192:195], v[96:99], v[52:55], v[192:195]
    ds_read_b128 v[52:55], v26 offset:10240
    v_mfma_f32_16x16x32_bf16 v[196:199], v[84:87], v[56:59], v[196:199]
    v_mfma_f32_16x16x32_bf16 v[200:203], v[88:91], v[56:59], v[200:203]
    v_mfma_f32_16x16x32_bf16 v[204:207], v[92:95], v[56:59], v[204:207]
    v_mfma_f32_16x16x32_bf16 v[208:211], v[96:99], v[56:59], v[208:211]
    ds_read_b128 v[56:59], v26 offset:12288
    v_mfma_f32_16x16x32_bf16 v[212:215], v[84:87], v[60:63], v[212:215]
    v_mfma_f32_16x16x32_bf16 v[216:219], v[88:91], v[60:63], v[216:219]
    v_mfma_f32_16x16x32_bf16 v[220:223], v[92:95], v[60:63], v[220:223]
    v_mfma_f32_16x16x32_bf16 v[224:227], v[96:99], v[60:63], v[224:227]
    ds_read_b128 v[60:63], v26 offset:14336
    v_mfma_f32_16x16x32_bf16 v[228:231], v[84:87], v[64:67], v[228:231]
    v_mfma_f32_16x16x32_bf16 v[232:235], v[88:91], v[64:67], v[232:235]
    v_mfma_f32_16x16x32_bf16 v[236:239], v[92:95], v[64:67], v[236:239]
    v_mfma_f32_16x16x32_bf16 v[240:243], v[96:99], v[64:67], v[240:243]
    ds_read_b128 v[64:67], v26 offset:16384
    s_branch parallel_sum__ssm_conv_s5__geglu_ffn__prompt_kernel_loop_p
parallel_sum__ssm_conv_s5__geglu_ffn__prompt_kernel_tail_p:
    s_waitcnt vmcnt(0)
    s_mov_b32 s5, 0
parallel_sum__ssm_conv_s5__geglu_ffn__prompt_kernel_tc_42:
    v_cmp_eq_u32 vcc, 0, v252
    s_add_u32 s5, s5, 1
    s_nop 3
    s_cbranch_vccz parallel_sum__ssm_conv_s5__geglu_ffn__prompt_kernel_tco_43
    s_cmp_ge_u32 s5, 0x20000
    s_cbranch_scc1 parallel_sum__ssm_conv_s5__geglu_ffn__prompt_kernel_tco_43
    s_sleep 2
    buffer_load_dword v252, v30, s[40:43], 0 offen sc1
    s_waitcnt vmcnt(0)
    s_branch parallel_sum__ssm_conv_s5__geglu_ffn__prompt_kernel_tc_42
parallel_sum__ssm_conv_s5__geglu_ffn__prompt_kernel_tco_43:
    s_waitcnt lgkmcnt(8)
    v_mfma_f32_16x16x32_bf16 v[100:103], v[84:87], v[32:35], v[100:103]
    v_mfma_f32_16x16x32_bf16 v[104:107], v[88:91], v[32:35], v[104:107]
    v_mfma_f32_16x16x32_bf16 v[108:111], v[92:95], v[32:35], v[108:111]
    v_mfma_f32_16x16x32_bf16 v[112:115], v[96:99], v[32:35], v[112:115]
    s_waitcnt lgkmcnt(7)
    v_mfma_f32_16x16x32_bf16 v[116:119], v[84:87], v[36:39], v[116:119]
    v_mfma_f32_16x16x32_bf16 v[120:123], v[88:91], v[36:39], v[120:123]
    v_mfma_f32_16x16x32_bf16 v[124:127], v[92:95], v[36:39], v[124:127]
    v_mfma_f32_16x16x32_bf16 v[128:131], v[96:99], v[36:39], v[128:131]
    s_waitcnt lgkmcnt(6)
    v_mfma_f32_16x16x32_bf16 v[132:135], v[84:87], v[40:43], v[132:135]
    v_mfma_f32_16x16x32_bf16 v[136:139], v[88:91], v[40:43], v[136:139]
    v_mfma_f32_16x16x32_bf16 v[140:143], v[92:95], v[40:43], v[140:143]
    v_mfma_f32_16x16x32_bf16 v[144:147], v[96:99], v[40:43], v[144:147]
    s_waitcnt lgkmcnt(5)
    v_mfma_f32_16x16x32_bf16 v[148:151], v[84:87], v[44:47], v[148:151]
    v_mfma_f32_16x16x32_bf16 v[152:155], v[88:91], v[44:47], v[152:155]
    v_mfma_f32_16x16x32_bf16 v[156:159], v[92:95], v[44:47], v[156:159]
    v_mfma_f32_16x16x32_bf16 v[160:163], v[96:99], v[44:47], v[160:163]
    s_waitcnt lgkmcnt(4)
    v_mfma_f32_16x16x32_bf16 v[164:167], v[84:87], v[48:51], v[164:167]
    v_mfma_f32_16x16x32_bf16 v[168:171], v[88:91], v[48:51], v[168:171]
    v_mfma_f32_16x16x32_bf16 v[172:175], v[92:95], v[48:51], v[172:175]
    v_mfma_f32_16x16x32_bf16 v[176:179], v[96:99], v[48:51], v[176:179]
    s_waitcnt lgkmcnt(3)
    v_mfma_f32_16x16x32_bf16 v[180:183], v[84:87], v[52:55], v[180:183]
    v_mfma_f32_16x16x32_bf16 v[184:187], v[88:91], v[52:55], v[184:187]
    v_mfma_f32_16x16x32_bf16 v[188:191], v[92:95], v[52:55], v[188:191]
    v_mfma_f32_16x16x32_bf16 v[192:195], v[96:99], v[52:55], v[192:195]
    s_waitcnt vmcnt(0) lgkmcnt(0)
    s_barrier
    v_mfma_f32_16x16x32_bf16 v[196:199], v[84:87], v[56:59], v[196:199]
    ds_read_b128 v[68:71], v24 offset:0
    v_mfma_f32_16x16x32_bf16 v[200:203], v[88:91], v[56:59], v[200:203]
    ds_read_b128 v[72:75], v24 offset:64
    v_mfma_f32_16x16x32_bf16 v[204:207], v[92:95], v[56:59], v[204:207]
    ds_read_b128 v[76:79], v24 offset:128
    v_mfma_f32_16x16x32_bf16 v[208:211], v[96:99], v[56:59], v[208:211]
    ds_read_b128 v[80:83], v24 offset:192
    v_mfma_f32_16x16x32_bf16 v[212:215], v[84:87], v[60:63], v[212:215]
    ds_read_b128 v[32:35], v31 offset:0
    v_mfma_f32_16x16x32_bf16 v[216:219], v[88:91], v[60:63], v[216:219]
    ds_read_b128 v[36:39], v31 offset:256
    v_mfma_f32_16x16x32_bf16 v[220:223], v[92:95], v[60:63], v[220:223]
    ds_read_b128 v[40:43], v31 offset:512
    v_mfma_f32_16x16x32_bf16 v[224:227], v[96:99], v[60:63], v[224:227]
    ds_read_b128 v[44:47], v31 offset:768
    v_mfma_f32_16x16x32_bf16 v[228:231], v[84:87], v[64:67], v[228:231]
    ds_read_b128 v[48:51], v31 offset:1024
    v_mfma_f32_16x16x32_bf16 v[232:235], v[88:91], v[64:67], v[232:235]
    ds_read_b128 v[52:55], v31 offset:1280
    v_mfma_f32_16x16x32_bf16 v[236:239], v[92:95], v[64:67], v[236:239]
    v_mfma_f32_16x16x32_bf16 v[240:243], v[96:99], v[64:67], v[240:243]
    ds_read_b128 v[56:59], v31 offset:1536
    ds_read_b128 v[60:63], v31 offset:1792
    ds_read_b128 v[64:67], v31 offset:2048
    v_lshlrev_b32 v14, 4, v2
    s_waitcnt lgkmcnt(3)
.p2align 3
    v_pk_fma_f32 v[100:101], v[32:33], v[68:69], v[100:101] op_sel:[0,0,0] op_sel_hi:[0,1,1] neg_lo:[1,0,0] neg_hi:[1,0,0]
    v_pk_fma_f32 v[102:103], v[32:33], v[70:71], v[102:103] op_sel:[0,0,0] op_sel_hi:[0,1,1] neg_lo:[1,0,0] neg_hi:[1,0,0]
    v_pk_fma_f32 v[104:105], v[32:33], v[72:73], v[104:105] op_sel:[0,0,0] op_sel_hi:[0,1,1] neg_lo:[1,0,0] neg_hi:[1,0,0]
    v_pk_fma_f32 v[106:107], v[32:33], v[74:75], v[106:107] op_sel:[0,0,0] op_sel_hi:[0,1,1] neg_lo:[1,0,0] neg_hi:[1,0,0]
    v_pk_mul_f32 v[84:85], v[100:101], v[100:101] op_sel:[0,0] op_sel_hi:[1,1]
    v_pk_mul_f32 v[86:87], v[102:103], v[102:103] op_sel:[0,0] op_sel_hi:[1,1]
    v_pk_mul_f32 v[88:89], v[104:105], v[104:105] op_sel:[0,0] op_sel_hi:[1,1]
    v_pk_mul_f32 v[90:91], v[106:107], v[106:107] op_sel:[0,0] op_sel_hi:[1,1]
    v_pk_fma_f32 v[84:85], v[84:85], v[34:35], v[32:33] op_sel:[0,0,1] op_sel_hi:[1,0,1]
    v_pk_fma_f32 v[86:87], v[86:87], v[34:35], v[32:33] op_sel:[0,0,1] op_sel_hi:[1,0,1]
    v_pk_fma_f32 v[88:89], v[88:89], v[34:35], v[32:33] op_sel:[0,0,1] op_sel_hi:[1,0,1]
    v_pk_fma_f32 v[90:91], v[90:91], v[34:35], v[32:33] op_sel:[0,0,1] op_sel_hi:[1,0,1]
    v_pk_mul_f32 v[84:85], v[84:85], v[100:101] op_sel:[0,0] op_sel_hi:[1,1]
    v_pk_mul_f32 v[86:87], v[86:87], v[102:103] op_sel:[0,0] op_sel_hi:[1,1]
    v_pk_mul_f32 v[88:89], v[88:89], v[104:105] op_sel:[0,0] op_sel_hi:[1,1]
    v_pk_mul_f32 v[90:91], v[90:91], v[106:107] op_sel:[0,0] op_sel_hi:[1,1]
    v_exp_f32 v84, v84
    v_exp_f32 v85, v85
    v_exp_f32 v86, v86
    v_exp_f32 v87, v87
    v_exp_f32 v88, v88
    v_exp_f32 v89, v89
    v_exp_f32 v90, v90
    v_exp_f32 v91, v91
    v_pk_fma_f32 v[108:109], v[32:33], v[76:77], v[108:109] op_sel:[0,0,0] op_sel_hi:[0,1,1] neg_lo:[1,0,0] neg_hi:[1,0,0]
    v_pk_fma_f32 v[110:111], v[32:33], v[78:79], v[110:111] op_sel:[0,0,0] op_sel_hi:[0,1,1] neg_lo:[1,0,0] neg_hi:[1,0,0]
    v_pk_fma_f32 v[112:113], v[32:33], v[80:81], v[112:113] op_sel:[0,0,0] op_sel_hi:[0,1,1] neg_lo:[1,0,0] neg_hi:[1,0,0]
    v_pk_fma_f32 v[114:115], v[32:33], v[82:83], v[114:115] op_sel:[0,0,0] op_sel_hi:[0,1,1] neg_lo:[1,0,0] neg_hi:[1,0,0]
    v_pk_fma_f32 v[84:85], v[34:35], v[84:85], v[34:35] op_sel:[1,0,1] op_sel_hi:[1,1,1]
    v_pk_fma_f32 v[86:87], v[34:35], v[86:87], v[34:35] op_sel:[1,0,1] op_sel_hi:[1,1,1]
    v_pk_fma_f32 v[88:89], v[34:35], v[88:89], v[34:35] op_sel:[1,0,1] op_sel_hi:[1,1,1]
    v_pk_fma_f32 v[90:91], v[34:35], v[90:91], v[34:35] op_sel:[1,0,1] op_sel_hi:[1,1,1]
    v_rcp_f32 v84, v84
    v_rcp_f32 v85, v85
    v_rcp_f32 v86, v86
    v_rcp_f32 v87, v87
    v_rcp_f32 v88, v88
    v_rcp_f32 v89, v89
    v_rcp_f32 v90, v90
    v_rcp_f32 v91, v91
    v_pk_mul_f32 v[100:101], v[100:101], v[108:109] op_sel:[0,0] op_sel_hi:[1,1]
    v_pk_mul_f32 v[102:103], v[102:103], v[110:111] op_sel:[0,0] op_sel_hi:[1,1]
    v_pk_mul_f32 v[104:105], v[104:105], v[112:113] op_sel:[0,0] op_sel_hi:[1,1]
    v_pk_mul_f32 v[106:107], v[106:107], v[114:115] op_sel:[0,0] op_sel_hi:[1,1]
    v_pk_mul_f32 v[100:101], v[100:101], v[84:85] op_sel:[0,0] op_sel_hi:[1,1]
    v_pk_mul_f32 v[102:103], v[102:103], v[86:87] op_sel:[0,0] op_sel_hi:[1,1]
    v_pk_mul_f32 v[104:105], v[104:105], v[88:89] op_sel:[0,0] op_sel_hi:[1,1]
    v_pk_mul_f32 v[106:107], v[106:107], v[90:91] op_sel:[0,0] op_sel_hi:[1,1]
    v_cvt_pk_bf16_f32 v92, v100, v101
    v_cvt_pk_bf16_f32 v93, v102, v103
    v_cvt_pk_bf16_f32 v94, v104, v105
    v_cvt_pk_bf16_f32 v95, v106, v107
    buffer_store_dwordx4 v[92:95], v14, s[36:39], s55 offen sc1
    v_pk_fma_f32 v[116:117], v[36:37], v[68:69], v[116:117] op_sel:[0,0,0] op_sel_hi:[0,1,1] neg_lo:[1,0,0] neg_hi:[1,0,0]
    v_pk_fma_f32 v[118:119], v[36:37], v[70:71], v[118:119] op_sel:[0,0,0] op_sel_hi:[0,1,1] neg_lo:[1,0,0] neg_hi:[1,0,0]
    v_pk_fma_f32 v[120:121], v[36:37], v[72:73], v[120:121] op_sel:[0,0,0] op_sel_hi:[0,1,1] neg_lo:[1,0,0] neg_hi:[1,0,0]
    v_pk_fma_f32 v[122:123], v[36:37], v[74:75], v[122:123] op_sel:[0,0,0] op_sel_hi:[0,1,1] neg_lo:[1,0,0] neg_hi:[1,0,0]
    v_pk_mul_f32 v[84:85], v[116:117], v[116:117] op_sel:[0,0] op_sel_hi:[1,1]
    v_pk_mul_f32 v[86:87], v[118:119], v[118:119] op_sel:[0,0] op_sel_hi:[1,1]
    v_pk_mul_f32 v[88:89], v[120:121], v[120:121] op_sel:[0,0] op_sel_hi:[1,1]
    v_pk_mul_f32 v[90:91], v[122:123], v[122:123] op_sel:[0,0] op_sel_hi:[1,1]
    v_pk_fma_f32 v[84:85], v[84:85], v[38:39], v[36:37] op_sel:[0,0,1] op_sel_hi:[1,0,1]
    v_pk_fma_f32 v[86:87], v[86:87], v[38:39], v[36:37] op_sel:[0,0,1] op_sel_hi:[1,0,1]
    v_pk_fma_f32 v[88:89], v[88:89], v[38:39], v[36:37] op_sel:[0,0,1] op_sel_hi:[1,0,1]
    v_pk_fma_f32 v[90:91], v[90:91], v[38:39], v[36:37] op_sel:[0,0,1] op_sel_hi:[1,0,1]
    v_pk_mul_f32 v[84:85], v[84:85], v[116:117] op_sel:[0,0] op_sel_hi:[1,1]
    v_pk_mul_f32 v[86:87], v[86:87], v[118:119] op_sel:[0,0] op_sel_hi:[1,1]
    v_pk_mul_f32 v[88:89], v[88:89], v[120:121] op_sel:[0,0] op_sel_hi:[1,1]
    v_pk_mul_f32 v[90:91], v[90:91], v[122:123] op_sel:[0,0] op_sel_hi:[1,1]
    v_exp_f32 v84, v84
    v_exp_f32 v85, v85
    v_exp_f32 v86, v86
    v_exp_f32 v87, v87
    v_exp_f32 v88, v88
    v_exp_f32 v89, v89
    v_exp_f32 v90, v90
    v_exp_f32 v91, v91
    v_pk_fma_f32 v[124:125], v[36:37], v[76:77], v[124:125] op_sel:[0,0,0] op_sel_hi:[0,1,1] neg_lo:[1,0,0] neg_hi:[1,0,0]
    v_pk_fma_f32 v[126:127], v[36:37], v[78:79], v[126:127] op_sel:[0,0,0] op_sel_hi:[0,1,1] neg_lo:[1,0,0] neg_hi:[1,0,0]
    v_pk_fma_f32 v[128:129], v[36:37], v[80:81], v[128:129] op_sel:[0,0,0] op_sel_hi:[0,1,1] neg_lo:[1,0,0] neg_hi:[1,0,0]
    v_pk_fma_f32 v[130:131], v[36:37], v[82:83], v[130:131] op_sel:[0,0,0] op_sel_hi:[0,1,1] neg_lo:[1,0,0] neg_hi:[1,0,0]
    v_pk_fma_f32 v[84:85], v[38:39], v[84:85], v[38:39] op_sel:[1,0,1] op_sel_hi:[1,1,1]
    v_pk_fma_f32 v[86:87], v[38:39], v[86:87], v[38:39] op_sel:[1,0,1] op_sel_hi:[1,1,1]
    v_pk_fma_f32 v[88:89], v[38:39], v[88:89], v[38:39] op_sel:[1,0,1] op_sel_hi:[1,1,1]
    v_pk_fma_f32 v[90:91], v[38:39], v[90:91], v[38:39] op_sel:[1,0,1] op_sel_hi:[1,1,1]
    v_rcp_f32 v84, v84
    v_rcp_f32 v85, v85
    v_rcp_f32 v86, v86
    v_rcp_f32 v87, v87
    v_rcp_f32 v88, v88
    v_rcp_f32 v89, v89
    v_rcp_f32 v90, v90
    v_rcp_f32 v91, v91
    v_pk_mul_f32 v[116:117], v[116:117], v[124:125] op_sel:[0,0] op_sel_hi:[1,1]
    v_pk_mul_f32 v[118:119], v[118:119], v[126:127] op_sel:[0,0] op_sel_hi:[1,1]
    v_pk_mul_f32 v[120:121], v[120:121], v[128:129] op_sel:[0,0] op_sel_hi:[1,1]
    v_pk_mul_f32 v[122:123], v[122:123], v[130:131] op_sel:[0,0] op_sel_hi:[1,1]
    v_pk_mul_f32 v[116:117], v[116:117], v[84:85] op_sel:[0,0] op_sel_hi:[1,1]
    v_pk_mul_f32 v[118:119], v[118:119], v[86:87] op_sel:[0,0] op_sel_hi:[1,1]
    v_pk_mul_f32 v[120:121], v[120:121], v[88:89] op_sel:[0,0] op_sel_hi:[1,1]
    v_pk_mul_f32 v[122:123], v[122:123], v[90:91] op_sel:[0,0] op_sel_hi:[1,1]
    v_cvt_pk_bf16_f32 v96, v116, v117
    v_cvt_pk_bf16_f32 v97, v118, v119
    v_cvt_pk_bf16_f32 v98, v120, v121
    v_cvt_pk_bf16_f32 v99, v122, v123
    buffer_store_dwordx4 v[96:99], v14, s[36:39], s56 offen sc1
    v_pk_fma_f32 v[132:133], v[40:41], v[68:69], v[132:133] op_sel:[0,0,0] op_sel_hi:[0,1,1] neg_lo:[1,0,0] neg_hi:[1,0,0]
    v_pk_fma_f32 v[134:135], v[40:41], v[70:71], v[134:135] op_sel:[0,0,0] op_sel_hi:[0,1,1] neg_lo:[1,0,0] neg_hi:[1,0,0]
    v_pk_fma_f32 v[136:137], v[40:41], v[72:73], v[136:137] op_sel:[0,0,0] op_sel_hi:[0,1,1] neg_lo:[1,0,0] neg_hi:[1,0,0]
    v_pk_fma_f32 v[138:139], v[40:41], v[74:75], v[138:139] op_sel:[0,0,0] op_sel_hi:[0,1,1] neg_lo:[1,0,0] neg_hi:[1,0,0]
    v_pk_mul_f32 v[84:85], v[132:133], v[132:133] op_sel:[0,0] op_sel_hi:[1,1]
    v_pk_mul_f32 v[86:87], v[134:135], v[134:135] op_sel:[0,0] op_sel_hi:[1,1]
    v_pk_mul_f32 v[88:89], v[136:137], v[136:137] op_sel:[0,0] op_sel_hi:[1,1]
    v_pk_mul_f32 v[90:91], v[138:139], v[138:139] op_sel:[0,0] op_sel_hi:[1,1]
    v_pk_fma_f32 v[84:85], v[84:85], v[42:43], v[40:41] op_sel:[0,0,1] op_sel_hi:[1,0,1]
    v_pk_fma_f32 v[86:87], v[86:87], v[42:43], v[40:41] op_sel:[0,0,1] op_sel_hi:[1,0,1]
    v_pk_fma_f32 v[88:89], v[88:89], v[42:43], v[40:41] op_sel:[0,0,1] op_sel_hi:[1,0,1]
    v_pk_fma_f32 v[90:91], v[90:91], v[42:43], v[40:41] op_sel:[0,0,1] op_sel_hi:[1,0,1]
    v_pk_mul_f32 v[84:85], v[84:85], v[132:133] op_sel:[0,0] op_sel_hi:[1,1]
    v_pk_mul_f32 v[86:87], v[86:87], v[134:135] op_sel:[0,0] op_sel_hi:[1,1]
    v_pk_mul_f32 v[88:89], v[88:89], v[136:137] op_sel:[0,0] op_sel_hi:[1,1]
    v_pk_mul_f32 v[90:91], v[90:91], v[138:139] op_sel:[0,0] op_sel_hi:[1,1]
    v_exp_f32 v84, v84
    v_exp_f32 v85, v85
    v_exp_f32 v86, v86
    v_exp_f32 v87, v87
    v_exp_f32 v88, v88
    v_exp_f32 v89, v89
    v_exp_f32 v90, v90
    v_exp_f32 v91, v91
    v_pk_fma_f32 v[140:141], v[40:41], v[76:77], v[140:141] op_sel:[0,0,0] op_sel_hi:[0,1,1] neg_lo:[1,0,0] neg_hi:[1,0,0]
    v_pk_fma_f32 v[142:143], v[40:41], v[78:79], v[142:143] op_sel:[0,0,0] op_sel_hi:[0,1,1] neg_lo:[1,0,0] neg_hi:[1,0,0]
    v_pk_fma_f32 v[144:145], v[40:41], v[80:81], v[144:145] op_sel:[0,0,0] op_sel_hi:[0,1,1] neg_lo:[1,0,0] neg_hi:[1,0,0]
    v_pk_fma_f32 v[146:147], v[40:41], v[82:83], v[146:147] op_sel:[0,0,0] op_sel_hi:[0,1,1] neg_lo:[1,0,0] neg_hi:[1,0,0]
    v_pk_fma_f32 v[84:85], v[42:43], v[84:85], v[42:43] op_sel:[1,0,1] op_sel_hi:[1,1,1]
    v_pk_fma_f32 v[86:87], v[42:43], v[86:87], v[42:43] op_sel:[1,0,1] op_sel_hi:[1,1,1]
    v_pk_fma_f32 v[88:89], v[42:43], v[88:89], v[42:43] op_sel:[1,0,1] op_sel_hi:[1,1,1]
    v_pk_fma_f32 v[90:91], v[42:43], v[90:91], v[42:43] op_sel:[1,0,1] op_sel_hi:[1,1,1]
    v_rcp_f32 v84, v84
    v_rcp_f32 v85, v85
    v_rcp_f32 v86, v86
    v_rcp_f32 v87, v87
    v_rcp_f32 v88, v88
    v_rcp_f32 v89, v89
    v_rcp_f32 v90, v90
    v_rcp_f32 v91, v91
    v_pk_mul_f32 v[132:133], v[132:133], v[140:141] op_sel:[0,0] op_sel_hi:[1,1]
    v_pk_mul_f32 v[134:135], v[134:135], v[142:143] op_sel:[0,0] op_sel_hi:[1,1]
    v_pk_mul_f32 v[136:137], v[136:137], v[144:145] op_sel:[0,0] op_sel_hi:[1,1]
    v_pk_mul_f32 v[138:139], v[138:139], v[146:147] op_sel:[0,0] op_sel_hi:[1,1]
    v_pk_mul_f32 v[132:133], v[132:133], v[84:85] op_sel:[0,0] op_sel_hi:[1,1]
    v_pk_mul_f32 v[134:135], v[134:135], v[86:87] op_sel:[0,0] op_sel_hi:[1,1]
    v_pk_mul_f32 v[136:137], v[136:137], v[88:89] op_sel:[0,0] op_sel_hi:[1,1]
    v_pk_mul_f32 v[138:139], v[138:139], v[90:91] op_sel:[0,0] op_sel_hi:[1,1]
    v_cvt_pk_bf16_f32 v92, v132, v133
    v_cvt_pk_bf16_f32 v93, v134, v135
    v_cvt_pk_bf16_f32 v94, v136, v137
    v_cvt_pk_bf16_f32 v95, v138, v139
    buffer_store_dwordx4 v[92:95], v14, s[36:39], s57 offen sc1
    v_pk_fma_f32 v[148:149], v[44:45], v[68:69], v[148:149] op_sel:[0,0,0] op_sel_hi:[0,1,1] neg_lo:[1,0,0] neg_hi:[1,0,0]
    v_pk_fma_f32 v[150:151], v[44:45], v[70:71], v[150:151] op_sel:[0,0,0] op_sel_hi:[0,1,1] neg_lo:[1,0,0] neg_hi:[1,0,0]
    v_pk_fma_f32 v[152:153], v[44:45], v[72:73], v[152:153] op_sel:[0,0,0] op_sel_hi:[0,1,1] neg_lo:[1,0,0] neg_hi:[1,0,0]
    v_pk_fma_f32 v[154:155], v[44:45], v[74:75], v[154:155] op_sel:[0,0,0] op_sel_hi:[0,1,1] neg_lo:[1,0,0] neg_hi:[1,0,0]
    v_pk_mul_f32 v[84:85], v[148:149], v[148:149] op_sel:[0,0] op_sel_hi:[1,1]
    v_pk_mul_f32 v[86:87], v[150:151], v[150:151] op_sel:[0,0] op_sel_hi:[1,1]
    v_pk_mul_f32 v[88:89], v[152:153], v[152:153] op_sel:[0,0] op_sel_hi:[1,1]
    v_pk_mul_f32 v[90:91], v[154:155], v[154:155] op_sel:[0,0] op_sel_hi:[1,1]
    v_pk_fma_f32 v[84:85], v[84:85], v[46:47], v[44:45] op_sel:[0,0,1] op_sel_hi:[1,0,1]
    v_pk_fma_f32 v[86:87], v[86:87], v[46:47], v[44:45] op_sel:[0,0,1] op_sel_hi:[1,0,1]
    v_pk_fma_f32 v[88:89], v[88:89], v[46:47], v[44:45] op_sel:[0,0,1] op_sel_hi:[1,0,1]
    v_pk_fma_f32 v[90:91], v[90:91], v[46:47], v[44:45] op_sel:[0,0,1] op_sel_hi:[1,0,1]
    v_pk_mul_f32 v[84:85], v[84:85], v[148:149] op_sel:[0,0] op_sel_hi:[1,1]
    v_pk_mul_f32 v[86:87], v[86:87], v[150:151] op_sel:[0,0] op_sel_hi:[1,1]
    v_pk_mul_f32 v[88:89], v[88:89], v[152:153] op_sel:[0,0] op_sel_hi:[1,1]
    v_pk_mul_f32 v[90:91], v[90:91], v[154:155] op_sel:[0,0] op_sel_hi:[1,1]
    v_exp_f32 v84, v84
    v_exp_f32 v85, v85
    v_exp_f32 v86, v86
    v_exp_f32 v87, v87
    v_exp_f32 v88, v88
    v_exp_f32 v89, v89
    v_exp_f32 v90, v90
    v_exp_f32 v91, v91
    v_pk_fma_f32 v[156:157], v[44:45], v[76:77], v[156:157] op_sel:[0,0,0] op_sel_hi:[0,1,1] neg_lo:[1,0,0] neg_hi:[1,0,0]
    v_pk_fma_f32 v[158:159], v[44:45], v[78:79], v[158:159] op_sel:[0,0,0] op_sel_hi:[0,1,1] neg_lo:[1,0,0] neg_hi:[1,0,0]
    v_pk_fma_f32 v[160:161], v[44:45], v[80:81], v[160:161] op_sel:[0,0,0] op_sel_hi:[0,1,1] neg_lo:[1,0,0] neg_hi:[1,0,0]
    v_pk_fma_f32 v[162:163], v[44:45], v[82:83], v[162:163] op_sel:[0,0,0] op_sel_hi:[0,1,1] neg_lo:[1,0,0] neg_hi:[1,0,0]
    v_pk_fma_f32 v[84:85], v[46:47], v[84:85], v[46:47] op_sel:[1,0,1] op_sel_hi:[1,1,1]
    v_pk_fma_f32 v[86:87], v[46:47], v[86:87], v[46:47] op_sel:[1,0,1] op_sel_hi:[1,1,1]
    v_pk_fma_f32 v[88:89], v[46:47], v[88:89], v[46:47] op_sel:[1,0,1] op_sel_hi:[1,1,1]
    v_pk_fma_f32 v[90:91], v[46:47], v[90:91], v[46:47] op_sel:[1,0,1] op_sel_hi:[1,1,1]
    v_rcp_f32 v84, v84
    v_rcp_f32 v85, v85
    v_rcp_f32 v86, v86
    v_rcp_f32 v87, v87
    v_rcp_f32 v88, v88
    v_rcp_f32 v89, v89
    v_rcp_f32 v90, v90
    v_rcp_f32 v91, v91
    v_pk_mul_f32 v[148:149], v[148:149], v[156:157] op_sel:[0,0] op_sel_hi:[1,1]
    v_pk_mul_f32 v[150:151], v[150:151], v[158:159] op_sel:[0,0] op_sel_hi:[1,1]
    v_pk_mul_f32 v[152:153], v[152:153], v[160:161] op_sel:[0,0] op_sel_hi:[1,1]
    v_pk_mul_f32 v[154:155], v[154:155], v[162:163] op_sel:[0,0] op_sel_hi:[1,1]
    v_pk_mul_f32 v[148:149], v[148:149], v[84:85] op_sel:[0,0] op_sel_hi:[1,1]
    v_pk_mul_f32 v[150:151], v[150:151], v[86:87] op_sel:[0,0] op_sel_hi:[1,1]
    v_pk_mul_f32 v[152:153], v[152:153], v[88:89] op_sel:[0,0] op_sel_hi:[1,1]
    v_pk_mul_f32 v[154:155], v[154:155], v[90:91] op_sel:[0,0] op_sel_hi:[1,1]
    v_cvt_pk_bf16_f32 v96, v148, v149
    v_cvt_pk_bf16_f32 v97, v150, v151
    v_cvt_pk_bf16_f32 v98, v152, v153
    v_cvt_pk_bf16_f32 v99, v154, v155
    buffer_store_dwordx4 v[96:99], v14, s[36:39], s58 offen sc1
    v_pk_fma_f32 v[164:165], v[48:49], v[68:69], v[164:165] op_sel:[0,0,0] op_sel_hi:[0,1,1] neg_lo:[1,0,0] neg_hi:[1,0,0]
    v_pk_fma_f32 v[166:167], v[48:49], v[70:71], v[166:167] op_sel:[0,0,0] op_sel_hi:[0,1,1] neg_lo:[1,0,0] neg_hi:[1,0,0]
    v_pk_fma_f32 v[168:169], v[48:49], v[72:73], v[168:169] op_sel:[0,0,0] op_sel_hi:[0,1,1] neg_lo:[1,0,0] neg_hi:[1,0,0]
    v_pk_fma_f32 v[170:171], v[48:49], v[74:75], v[170:171] op_sel:[0,0,0] op_sel_hi:[0,1,1] neg_lo:[1,0,0] neg_hi:[1,0,0]
    v_pk_mul_f32 v[84:85], v[164:165], v[164:165] op_sel:[0,0] op_sel_hi:[1,1]
    v_pk_mul_f32 v[86:87], v[166:167], v[166:167] op_sel:[0,0] op_sel_hi:[1,1]
    v_pk_mul_f32 v[88:89], v[168:169], v[168:169] op_sel:[0,0] op_sel_hi:[1,1]
    v_pk_mul_f32 v[90:91], v[170:171], v[170:171] op_sel:[0,0] op_sel_hi:[1,1]
    v_pk_fma_f32 v[84:85], v[84:85], v[50:51], v[48:49] op_sel:[0,0,1] op_sel_hi:[1,0,1]
    v_pk_fma_f32 v[86:87], v[86:87], v[50:51], v[48:49] op_sel:[0,0,1] op_sel_hi:[1,0,1]
    v_pk_fma_f32 v[88:89], v[88:89], v[50:51], v[48:49] op_sel:[0,0,1] op_sel_hi:[1,0,1]
    v_pk_fma_f32 v[90:91], v[90:91], v[50:51], v[48:49] op_sel:[0,0,1] op_sel_hi:[1,0,1]
    v_pk_mul_f32 v[84:85], v[84:85], v[164:165] op_sel:[0,0] op_sel_hi:[1,1]
    v_pk_mul_f32 v[86:87], v[86:87], v[166:167] op_sel:[0,0] op_sel_hi:[1,1]
    v_pk_mul_f32 v[88:89], v[88:89], v[168:169] op_sel:[0,0] op_sel_hi:[1,1]
    v_pk_mul_f32 v[90:91], v[90:91], v[170:171] op_sel:[0,0] op_sel_hi:[1,1]
    v_exp_f32 v84, v84
    v_exp_f32 v85, v85
    v_exp_f32 v86, v86
    v_exp_f32 v87, v87
    v_exp_f32 v88, v88
    v_exp_f32 v89, v89
    v_exp_f32 v90, v90
    v_exp_f32 v91, v91
    v_pk_fma_f32 v[172:173], v[48:49], v[76:77], v[172:173] op_sel:[0,0,0] op_sel_hi:[0,1,1] neg_lo:[1,0,0] neg_hi:[1,0,0]
    v_pk_fma_f32 v[174:175], v[48:49], v[78:79], v[174:175] op_sel:[0,0,0] op_sel_hi:[0,1,1] neg_lo:[1,0,0] neg_hi:[1,0,0]
    v_pk_fma_f32 v[176:177], v[48:49], v[80:81], v[176:177] op_sel:[0,0,0] op_sel_hi:[0,1,1] neg_lo:[1,0,0] neg_hi:[1,0,0]
    v_pk_fma_f32 v[178:179], v[48:49], v[82:83], v[178:179] op_sel:[0,0,0] op_sel_hi:[0,1,1] neg_lo:[1,0,0] neg_hi:[1,0,0]
    v_pk_fma_f32 v[84:85], v[50:51], v[84:85], v[50:51] op_sel:[1,0,1] op_sel_hi:[1,1,1]
    v_pk_fma_f32 v[86:87], v[50:51], v[86:87], v[50:51] op_sel:[1,0,1] op_sel_hi:[1,1,1]
    v_pk_fma_f32 v[88:89], v[50:51], v[88:89], v[50:51] op_sel:[1,0,1] op_sel_hi:[1,1,1]
    v_pk_fma_f32 v[90:91], v[50:51], v[90:91], v[50:51] op_sel:[1,0,1] op_sel_hi:[1,1,1]
    v_rcp_f32 v84, v84
    v_rcp_f32 v85, v85
    v_rcp_f32 v86, v86
    v_rcp_f32 v87, v87
    v_rcp_f32 v88, v88
    v_rcp_f32 v89, v89
    v_rcp_f32 v90, v90
    v_rcp_f32 v91, v91
    v_pk_mul_f32 v[164:165], v[164:165], v[172:173] op_sel:[0,0] op_sel_hi:[1,1]
    v_pk_mul_f32 v[166:167], v[166:167], v[174:175] op_sel:[0,0] op_sel_hi:[1,1]
    v_pk_mul_f32 v[168:169], v[168:169], v[176:177] op_sel:[0,0] op_sel_hi:[1,1]
    v_pk_mul_f32 v[170:171], v[170:171], v[178:179] op_sel:[0,0] op_sel_hi:[1,1]
    v_pk_mul_f32 v[164:165], v[164:165], v[84:85] op_sel:[0,0] op_sel_hi:[1,1]
    v_pk_mul_f32 v[166:167], v[166:167], v[86:87] op_sel:[0,0] op_sel_hi:[1,1]
    v_pk_mul_f32 v[168:169], v[168:169], v[88:89] op_sel:[0,0] op_sel_hi:[1,1]
    v_pk_mul_f32 v[170:171], v[170:171], v[90:91] op_sel:[0,0] op_sel_hi:[1,1]
    v_cvt_pk_bf16_f32 v92, v164, v165
    v_cvt_pk_bf16_f32 v93, v166, v167
    v_cvt_pk_bf16_f32 v94, v168, v169
    v_cvt_pk_bf16_f32 v95, v170, v171
    buffer_store_dwordx4 v[92:95], v14, s[36:39], s59 offen sc1
    v_pk_fma_f32 v[180:181], v[52:53], v[68:69], v[180:181] op_sel:[0,0,0] op_sel_hi:[0,1,1] neg_lo:[1,0,0] neg_hi:[1,0,0]
    v_pk_fma_f32 v[182:183], v[52:53], v[70:71], v[182:183] op_sel:[0,0,0] op_sel_hi:[0,1,1] neg_lo:[1,0,0] neg_hi:[1,0,0]
    v_pk_fma_f32 v[184:185], v[52:53], v[72:73], v[184:185] op_sel:[0,0,0] op_sel_hi:[0,1,1] neg_lo:[1,0,0] neg_hi:[1,0,0]
    v_pk_fma_f32 v[186:187], v[52:53], v[74:75], v[186:187] op_sel:[0,0,0] op_sel_hi:[0,1,1] neg_lo:[1,0,0] neg_hi:[1,0,0]
    v_pk_mul_f32 v[84:85], v[180:181], v[180:181] op_sel:[0,0] op_sel_hi:[1,1]
    v_pk_mul_f32 v[86:87], v[182:183], v[182:183] op_sel:[0,0] op_sel_hi:[1,1]
    v_pk_mul_f32 v[88:89], v[184:185], v[184:185] op_sel:[0,0] op_sel_hi:[1,1]
    v_pk_mul_f32 v[90:91], v[186:187], v[186:187] op_sel:[0,0] op_sel_hi:[1,1]
    v_pk_fma_f32 v[84:85], v[84:85], v[54:55], v[52:53] op_sel:[0,0,1] op_sel_hi:[1,0,1]
    v_pk_fma_f32 v[86:87], v[86:87], v[54:55], v[52:53] op_sel:[0,0,1] op_sel_hi:[1,0,1]
    v_pk_fma_f32 v[88:89], v[88:89], v[54:55], v[52:53] op_sel:[0,0,1] op_sel_hi:[1,0,1]
    v_pk_fma_f32 v[90:91], v[90:91], v[54:55], v[52:53] op_sel:[0,0,1] op_sel_hi:[1,0,1]
    v_pk_mul_f32 v[84:85], v[84:85], v[180:181] op_sel:[0,0] op_sel_hi:[1,1]
    v_pk_mul_f32 v[86:87], v[86:87], v[182:183] op_sel:[0,0] op_sel_hi:[1,1]
    v_pk_mul_f32 v[88:89], v[88:89], v[184:185] op_sel:[0,0] op_sel_hi:[1,1]
    v_pk_mul_f32 v[90:91], v[90:91], v[186:187] op_sel:[0,0] op_sel_hi:[1,1]
    v_exp_f32 v84, v84
    v_exp_f32 v85, v85
    v_exp_f32 v86, v86
    v_exp_f32 v87, v87
    v_exp_f32 v88, v88
    v_exp_f32 v89, v89
    v_exp_f32 v90, v90
    v_exp_f32 v91, v91
    v_pk_fma_f32 v[188:189], v[52:53], v[76:77], v[188:189] op_sel:[0,0,0] op_sel_hi:[0,1,1] neg_lo:[1,0,0] neg_hi:[1,0,0]
    v_pk_fma_f32 v[190:191], v[52:53], v[78:79], v[190:191] op_sel:[0,0,0] op_sel_hi:[0,1,1] neg_lo:[1,0,0] neg_hi:[1,0,0]
    v_pk_fma_f32 v[192:193], v[52:53], v[80:81], v[192:193] op_sel:[0,0,0] op_sel_hi:[0,1,1] neg_lo:[1,0,0] neg_hi:[1,0,0]
    v_pk_fma_f32 v[194:195], v[52:53], v[82:83], v[194:195] op_sel:[0,0,0] op_sel_hi:[0,1,1] neg_lo:[1,0,0] neg_hi:[1,0,0]
    v_pk_fma_f32 v[84:85], v[54:55], v[84:85], v[54:55] op_sel:[1,0,1] op_sel_hi:[1,1,1]
    v_pk_fma_f32 v[86:87], v[54:55], v[86:87], v[54:55] op_sel:[1,0,1] op_sel_hi:[1,1,1]
    v_pk_fma_f32 v[88:89], v[54:55], v[88:89], v[54:55] op_sel:[1,0,1] op_sel_hi:[1,1,1]
    v_pk_fma_f32 v[90:91], v[54:55], v[90:91], v[54:55] op_sel:[1,0,1] op_sel_hi:[1,1,1]
    v_rcp_f32 v84, v84
    v_rcp_f32 v85, v85
    v_rcp_f32 v86, v86
    v_rcp_f32 v87, v87
    v_rcp_f32 v88, v88
    v_rcp_f32 v89, v89
    v_rcp_f32 v90, v90
    v_rcp_f32 v91, v91
    v_pk_mul_f32 v[180:181], v[180:181], v[188:189] op_sel:[0,0] op_sel_hi:[1,1]
    v_pk_mul_f32 v[182:183], v[182:183], v[190:191] op_sel:[0,0] op_sel_hi:[1,1]
    v_pk_mul_f32 v[184:185], v[184:185], v[192:193] op_sel:[0,0] op_sel_hi:[1,1]
    v_pk_mul_f32 v[186:187], v[186:187], v[194:195] op_sel:[0,0] op_sel_hi:[1,1]
    v_pk_mul_f32 v[180:181], v[180:181], v[84:85] op_sel:[0,0] op_sel_hi:[1,1]
    v_pk_mul_f32 v[182:183], v[182:183], v[86:87] op_sel:[0,0] op_sel_hi:[1,1]
    v_pk_mul_f32 v[184:185], v[184:185], v[88:89] op_sel:[0,0] op_sel_hi:[1,1]
    v_pk_mul_f32 v[186:187], v[186:187], v[90:91] op_sel:[0,0] op_sel_hi:[1,1]
    v_cvt_pk_bf16_f32 v96, v180, v181
    v_cvt_pk_bf16_f32 v97, v182, v183
    v_cvt_pk_bf16_f32 v98, v184, v185
    v_cvt_pk_bf16_f32 v99, v186, v187
    buffer_store_dwordx4 v[96:99], v14, s[36:39], s60 offen sc1
    s_waitcnt lgkmcnt(0)
    s_nop 0
    v_pk_fma_f32 v[196:197], v[56:57], v[68:69], v[196:197] op_sel:[0,0,0] op_sel_hi:[0,1,1] neg_lo:[1,0,0] neg_hi:[1,0,0]
    v_pk_fma_f32 v[198:199], v[56:57], v[70:71], v[198:199] op_sel:[0,0,0] op_sel_hi:[0,1,1] neg_lo:[1,0,0] neg_hi:[1,0,0]
    v_pk_fma_f32 v[200:201], v[56:57], v[72:73], v[200:201] op_sel:[0,0,0] op_sel_hi:[0,1,1] neg_lo:[1,0,0] neg_hi:[1,0,0]
    v_pk_fma_f32 v[202:203], v[56:57], v[74:75], v[202:203] op_sel:[0,0,0] op_sel_hi:[0,1,1] neg_lo:[1,0,0] neg_hi:[1,0,0]
    v_pk_mul_f32 v[84:85], v[196:197], v[196:197] op_sel:[0,0] op_sel_hi:[1,1]
    v_pk_mul_f32 v[86:87], v[198:199], v[198:199] op_sel:[0,0] op_sel_hi:[1,1]
    v_pk_mul_f32 v[88:89], v[200:201], v[200:201] op_sel:[0,0] op_sel_hi:[1,1]
    v_pk_mul_f32 v[90:91], v[202:203], v[202:203] op_sel:[0,0] op_sel_hi:[1,1]
    v_pk_fma_f32 v[84:85], v[84:85], v[58:59], v[56:57] op_sel:[0,0,1] op_sel_hi:[1,0,1]
    v_pk_fma_f32 v[86:87], v[86:87], v[58:59], v[56:57] op_sel:[0,0,1] op_sel_hi:[1,0,1]
    v_pk_fma_f32 v[88:89], v[88:89], v[58:59], v[56:57] op_sel:[0,0,1] op_sel_hi:[1,0,1]
    v_pk_fma_f32 v[90:91], v[90:91], v[58:59], v[56:57] op_sel:[0,0,1] op_sel_hi:[1,0,1]
    v_pk_mul_f32 v[84:85], v[84:85], v[196:197] op_sel:[0,0] op_sel_hi:[1,1]
    v_pk_mul_f32 v[86:87], v[86:87], v[198:199] op_sel:[0,0] op_sel_hi:[1,1]
    v_pk_mul_f32 v[88:89], v[88:89], v[200:201] op_sel:[0,0] op_sel_hi:[1,1]
    v_pk_mul_f32 v[90:91], v[90:91], v[202:203] op_sel:[0,0] op_sel_hi:[1,1]
    v_exp_f32 v84, v84
    v_exp_f32 v85, v85
    v_exp_f32 v86, v86
    v_exp_f32 v87, v87
    v_exp_f32 v88, v88
    v_exp_f32 v89, v89
    v_exp_f32 v90, v90
    v_exp_f32 v91, v91
    v_pk_fma_f32 v[204:205], v[56:57], v[76:77], v[204:205] op_sel:[0,0,0] op_sel_hi:[0,1,1] neg_lo:[1,0,0] neg_hi:[1,0,0]
    v_pk_fma_f32 v[206:207], v[56:57], v[78:79], v[206:207] op_sel:[0,0,0] op_sel_hi:[0,1,1] neg_lo:[1,0,0] neg_hi:[1,0,0]
    v_pk_fma_f32 v[208:209], v[56:57], v[80:81], v[208:209] op_sel:[0,0,0] op_sel_hi:[0,1,1] neg_lo:[1,0,0] neg_hi:[1,0,0]
    v_pk_fma_f32 v[210:211], v[56:57], v[82:83], v[210:211] op_sel:[0,0,0] op_sel_hi:[0,1,1] neg_lo:[1,0,0] neg_hi:[1,0,0]
    v_pk_fma_f32 v[84:85], v[58:59], v[84:85], v[58:59] op_sel:[1,0,1] op_sel_hi:[1,1,1]
    v_pk_fma_f32 v[86:87], v[58:59], v[86:87], v[58:59] op_sel:[1,0,1] op_sel_hi:[1,1,1]
    v_pk_fma_f32 v[88:89], v[58:59], v[88:89], v[58:59] op_sel:[1,0,1] op_sel_hi:[1,1,1]
    v_pk_fma_f32 v[90:91], v[58:59], v[90:91], v[58:59] op_sel:[1,0,1] op_sel_hi:[1,1,1]
    v_rcp_f32 v84, v84
    v_rcp_f32 v85, v85
    v_rcp_f32 v86, v86
    v_rcp_f32 v87, v87
    v_rcp_f32 v88, v88
    v_rcp_f32 v89, v89
    v_rcp_f32 v90, v90
    v_rcp_f32 v91, v91
    v_pk_mul_f32 v[196:197], v[196:197], v[204:205] op_sel:[0,0] op_sel_hi:[1,1]
    v_pk_mul_f32 v[198:199], v[198:199], v[206:207] op_sel:[0,0] op_sel_hi:[1,1]
    v_pk_mul_f32 v[200:201], v[200:201], v[208:209] op_sel:[0,0] op_sel_hi:[1,1]
    v_pk_mul_f32 v[202:203], v[202:203], v[210:211] op_sel:[0,0] op_sel_hi:[1,1]
    v_pk_mul_f32 v[196:197], v[196:197], v[84:85] op_sel:[0,0] op_sel_hi:[1,1]
    v_pk_mul_f32 v[198:199], v[198:199], v[86:87] op_sel:[0,0] op_sel_hi:[1,1]
    v_pk_mul_f32 v[200:201], v[200:201], v[88:89] op_sel:[0,0] op_sel_hi:[1,1]
    v_pk_mul_f32 v[202:203], v[202:203], v[90:91] op_sel:[0,0] op_sel_hi:[1,1]
    v_cvt_pk_bf16_f32 v92, v196, v197
    v_cvt_pk_bf16_f32 v93, v198, v199
    v_cvt_pk_bf16_f32 v94, v200, v201
    v_cvt_pk_bf16_f32 v95, v202, v203
    buffer_store_dwordx4 v[92:95], v14, s[36:39], s61 offen sc1
    v_pk_fma_f32 v[212:213], v[60:61], v[68:69], v[212:213] op_sel:[0,0,0] op_sel_hi:[0,1,1] neg_lo:[1,0,0] neg_hi:[1,0,0]
    v_pk_fma_f32 v[214:215], v[60:61], v[70:71], v[214:215] op_sel:[0,0,0] op_sel_hi:[0,1,1] neg_lo:[1,0,0] neg_hi:[1,0,0]
    v_pk_fma_f32 v[216:217], v[60:61], v[72:73], v[216:217] op_sel:[0,0,0] op_sel_hi:[0,1,1] neg_lo:[1,0,0] neg_hi:[1,0,0]
    v_pk_fma_f32 v[218:219], v[60:61], v[74:75], v[218:219] op_sel:[0,0,0] op_sel_hi:[0,1,1] neg_lo:[1,0,0] neg_hi:[1,0,0]
    v_pk_mul_f32 v[84:85], v[212:213], v[212:213] op_sel:[0,0] op_sel_hi:[1,1]
    v_pk_mul_f32 v[86:87], v[214:215], v[214:215] op_sel:[0,0] op_sel_hi:[1,1]
    v_pk_mul_f32 v[88:89], v[216:217], v[216:217] op_sel:[0,0] op_sel_hi:[1,1]
    v_pk_mul_f32 v[90:91], v[218:219], v[218:219] op_sel:[0,0] op_sel_hi:[1,1]
    v_pk_fma_f32 v[84:85], v[84:85], v[62:63], v[60:61] op_sel:[0,0,1] op_sel_hi:[1,0,1]
    v_pk_fma_f32 v[86:87], v[86:87], v[62:63], v[60:61] op_sel:[0,0,1] op_sel_hi:[1,0,1]
    v_pk_fma_f32 v[88:89], v[88:89], v[62:63], v[60:61] op_sel:[0,0,1] op_sel_hi:[1,0,1]
    v_pk_fma_f32 v[90:91], v[90:91], v[62:63], v[60:61] op_sel:[0,0,1] op_sel_hi:[1,0,1]
    v_pk_mul_f32 v[84:85], v[84:85], v[212:213] op_sel:[0,0] op_sel_hi:[1,1]
    v_pk_mul_f32 v[86:87], v[86:87], v[214:215] op_sel:[0,0] op_sel_hi:[1,1]
    v_pk_mul_f32 v[88:89], v[88:89], v[216:217] op_sel:[0,0] op_sel_hi:[1,1]
    v_pk_mul_f32 v[90:91], v[90:91], v[218:219] op_sel:[0,0] op_sel_hi:[1,1]
    v_exp_f32 v84, v84
    v_exp_f32 v85, v85
    v_exp_f32 v86, v86
    v_exp_f32 v87, v87
    v_exp_f32 v88, v88
    v_exp_f32 v89, v89
    v_exp_f32 v90, v90
    v_exp_f32 v91, v91
    v_pk_fma_f32 v[220:221], v[60:61], v[76:77], v[220:221] op_sel:[0,0,0] op_sel_hi:[0,1,1] neg_lo:[1,0,0] neg_hi:[1,0,0]
    v_pk_fma_f32 v[222:223], v[60:61], v[78:79], v[222:223] op_sel:[0,0,0] op_sel_hi:[0,1,1] neg_lo:[1,0,0] neg_hi:[1,0,0]
    v_pk_fma_f32 v[224:225], v[60:61], v[80:81], v[224:225] op_sel:[0,0,0] op_sel_hi:[0,1,1] neg_lo:[1,0,0] neg_hi:[1,0,0]
    v_pk_fma_f32 v[226:227], v[60:61], v[82:83], v[226:227] op_sel:[0,0,0] op_sel_hi:[0,1,1] neg_lo:[1,0,0] neg_hi:[1,0,0]
    v_pk_fma_f32 v[84:85], v[62:63], v[84:85], v[62:63] op_sel:[1,0,1] op_sel_hi:[1,1,1]
    v_pk_fma_f32 v[86:87], v[62:63], v[86:87], v[62:63] op_sel:[1,0,1] op_sel_hi:[1,1,1]
    v_pk_fma_f32 v[88:89], v[62:63], v[88:89], v[62:63] op_sel:[1,0,1] op_sel_hi:[1,1,1]
    v_pk_fma_f32 v[90:91], v[62:63], v[90:91], v[62:63] op_sel:[1,0,1] op_sel_hi:[1,1,1]
    v_rcp_f32 v84, v84
    v_rcp_f32 v85, v85
    v_rcp_f32 v86, v86
    v_rcp_f32 v87, v87
    v_rcp_f32 v88, v88
    v_rcp_f32 v89, v89
    v_rcp_f32 v90, v90
    v_rcp_f32 v91, v91
    v_pk_mul_f32 v[212:213], v[212:213], v[220:221] op_sel:[0,0] op_sel_hi:[1,1]
    v_pk_mul_f32 v[214:215], v[214:215], v[222:223] op_sel:[0,0] op_sel_hi:[1,1]
    v_pk_mul_f32 v[216:217], v[216:217], v[224:225] op_sel:[0,0] op_sel_hi:[1,1]
    v_pk_mul_f32 v[218:219], v[218:219], v[226:227] op_sel:[0,0] op_sel_hi:[1,1]
    v_pk_mul_f32 v[212:213], v[212:213], v[84:85] op_sel:[0,0] op_sel_hi:[1,1]
    v_pk_mul_f32 v[214:215], v[214:215], v[86:87] op_sel:[0,0] op_sel_hi:[1,1]
    v_pk_mul_f32 v[216:217], v[216:217], v[88:89] op_sel:[0,0] op_sel_hi:[1,1]
    v_pk_mul_f32 v[218:219], v[218:219], v[90:91] op_sel:[0,0] op_sel_hi:[1,1]
    v_cvt_pk_bf16_f32 v96, v212, v213
    v_cvt_pk_bf16_f32 v97, v214, v215
    v_cvt_pk_bf16_f32 v98, v216, v217
    v_cvt_pk_bf16_f32 v99, v218, v219
    buffer_store_dwordx4 v[96:99], v14, s[36:39], s62 offen sc1
    v_pk_fma_f32 v[228:229], v[64:65], v[68:69], v[228:229] op_sel:[0,0,0] op_sel_hi:[0,1,1] neg_lo:[1,0,0] neg_hi:[1,0,0]
    v_pk_fma_f32 v[230:231], v[64:65], v[70:71], v[230:231] op_sel:[0,0,0] op_sel_hi:[0,1,1] neg_lo:[1,0,0] neg_hi:[1,0,0]
    v_pk_fma_f32 v[232:233], v[64:65], v[72:73], v[232:233] op_sel:[0,0,0] op_sel_hi:[0,1,1] neg_lo:[1,0,0] neg_hi:[1,0,0]
    v_pk_fma_f32 v[234:235], v[64:65], v[74:75], v[234:235] op_sel:[0,0,0] op_sel_hi:[0,1,1] neg_lo:[1,0,0] neg_hi:[1,0,0]
    v_pk_mul_f32 v[84:85], v[228:229], v[228:229] op_sel:[0,0] op_sel_hi:[1,1]
    v_pk_mul_f32 v[86:87], v[230:231], v[230:231] op_sel:[0,0] op_sel_hi:[1,1]
    v_pk_mul_f32 v[88:89], v[232:233], v[232:233] op_sel:[0,0] op_sel_hi:[1,1]
    v_pk_mul_f32 v[90:91], v[234:235], v[234:235] op_sel:[0,0] op_sel_hi:[1,1]
    v_pk_fma_f32 v[84:85], v[84:85], v[66:67], v[64:65] op_sel:[0,0,1] op_sel_hi:[1,0,1]
    v_pk_fma_f32 v[86:87], v[86:87], v[66:67], v[64:65] op_sel:[0,0,1] op_sel_hi:[1,0,1]
    v_pk_fma_f32 v[88:89], v[88:89], v[66:67], v[64:65] op_sel:[0,0,1] op_sel_hi:[1,0,1]
    v_pk_fma_f32 v[90:91], v[90:91], v[66:67], v[64:65] op_sel:[0,0,1] op_sel_hi:[1,0,1]
    v_pk_mul_f32 v[84:85], v[84:85], v[228:229] op_sel:[0,0] op_sel_hi:[1,1]
    v_pk_mul_f32 v[86:87], v[86:87], v[230:231] op_sel:[0,0] op_sel_hi:[1,1]
    v_pk_mul_f32 v[88:89], v[88:89], v[232:233] op_sel:[0,0] op_sel_hi:[1,1]
    v_pk_mul_f32 v[90:91], v[90:91], v[234:235] op_sel:[0,0] op_sel_hi:[1,1]
    v_exp_f32 v84, v84
    v_exp_f32 v85, v85
    v_exp_f32 v86, v86
    v_exp_f32 v87, v87
    v_exp_f32 v88, v88
    v_exp_f32 v89, v89
    v_exp_f32 v90, v90
    v_exp_f32 v91, v91
    v_pk_fma_f32 v[236:237], v[64:65], v[76:77], v[236:237] op_sel:[0,0,0] op_sel_hi:[0,1,1] neg_lo:[1,0,0] neg_hi:[1,0,0]
    v_pk_fma_f32 v[238:239], v[64:65], v[78:79], v[238:239] op_sel:[0,0,0] op_sel_hi:[0,1,1] neg_lo:[1,0,0] neg_hi:[1,0,0]
    v_pk_fma_f32 v[240:241], v[64:65], v[80:81], v[240:241] op_sel:[0,0,0] op_sel_hi:[0,1,1] neg_lo:[1,0,0] neg_hi:[1,0,0]
    v_pk_fma_f32 v[242:243], v[64:65], v[82:83], v[242:243] op_sel:[0,0,0] op_sel_hi:[0,1,1] neg_lo:[1,0,0] neg_hi:[1,0,0]
    v_pk_fma_f32 v[84:85], v[66:67], v[84:85], v[66:67] op_sel:[1,0,1] op_sel_hi:[1,1,1]
    v_pk_fma_f32 v[86:87], v[66:67], v[86:87], v[66:67] op_sel:[1,0,1] op_sel_hi:[1,1,1]
    v_pk_fma_f32 v[88:89], v[66:67], v[88:89], v[66:67] op_sel:[1,0,1] op_sel_hi:[1,1,1]
    v_pk_fma_f32 v[90:91], v[66:67], v[90:91], v[66:67] op_sel:[1,0,1] op_sel_hi:[1,1,1]
    v_rcp_f32 v84, v84
    v_rcp_f32 v85, v85
    v_rcp_f32 v86, v86
    v_rcp_f32 v87, v87
    v_rcp_f32 v88, v88
    v_rcp_f32 v89, v89
    v_rcp_f32 v90, v90
    v_rcp_f32 v91, v91
    v_pk_mul_f32 v[228:229], v[228:229], v[236:237] op_sel:[0,0] op_sel_hi:[1,1]
    v_pk_mul_f32 v[230:231], v[230:231], v[238:239] op_sel:[0,0] op_sel_hi:[1,1]
    v_pk_mul_f32 v[232:233], v[232:233], v[240:241] op_sel:[0,0] op_sel_hi:[1,1]
    v_pk_mul_f32 v[234:235], v[234:235], v[242:243] op_sel:[0,0] op_sel_hi:[1,1]
    v_pk_mul_f32 v[228:229], v[228:229], v[84:85] op_sel:[0,0] op_sel_hi:[1,1]
    v_pk_mul_f32 v[230:231], v[230:231], v[86:87] op_sel:[0,0] op_sel_hi:[1,1]
    v_pk_mul_f32 v[232:233], v[232:233], v[88:89] op_sel:[0,0] op_sel_hi:[1,1]
    v_pk_mul_f32 v[234:235], v[234:235], v[90:91] op_sel:[0,0] op_sel_hi:[1,1]
    v_cvt_pk_bf16_f32 v92, v228, v229
    v_cvt_pk_bf16_f32 v93, v230, v231
    v_cvt_pk_bf16_f32 v94, v232, v233
    v_cvt_pk_bf16_f32 v95, v234, v235
    buffer_store_dwordx4 v[92:95], v14, s[36:39], s63 offen sc1
    s_branch parallel_sum__ssm_conv_s5__geglu_ffn__prompt_kernel_cp2
parallel_sum__ssm_conv_s5__geglu_ffn__prompt_kernel_s:
    s_barrier
    ds_read_b128 v[68:71], v28 offset:0
    ds_read_b128 v[72:75], v28 offset:2048
    ds_read_b128 v[76:79], v28 offset:8192
    ds_read_b128 v[80:83], v28 offset:10240
    ds_read_b128 v[32:35], v26 offset:0
    ds_read_b128 v[36:39], v26 offset:2048
    ds_read_b128 v[40:43], v26 offset:4096
    ds_read_b128 v[44:47], v26 offset:6144
    ds_read_b128 v[48:51], v26 offset:8192
    ds_read_b128 v[52:55], v26 offset:10240
    ds_read_b128 v[56:59], v26 offset:12288
    ds_read_b128 v[60:63], v26 offset:14336
    ds_read_b128 v[64:67], v26 offset:16384
    s_waitcnt lgkmcnt(0)
.p2align 5
    s_nop 0
    s_nop 0
    s_nop 0
    s_nop 0
parallel_sum__ssm_conv_s5__geglu_ffn__prompt_kernel_loop_s:
    s_waitcnt lgkmcnt(7)
    v_mfma_f32_16x16x32_bf16 v[100:103], v[32:35], v[68:71], v[100:103]
    ds_read_b128 v[84:87], v29 offset:0
    v_mfma_f32_16x16x32_bf16 v[104:107], v[32:35], v[72:75], v[104:107]
    ds_read_b128 v[88:91], v29 offset:2048
    v_mfma_f32_16x16x32_bf16 v[108:111], v[32:35], v[76:79], v[108:111]
    ds_read_b128 v[92:95], v29 offset:8192
    v_mfma_f32_16x16x32_bf16 v[112:115], v[32:35], v[80:83], v[112:115]
    ds_read_b128 v[96:99], v29 offset:10240
    v_mfma_f32_16x16x32_bf16 v[116:119], v[36:39], v[68:71], v[116:119]
    ds_read_b128 v[32:35], v27 offset:0
    v_mfma_f32_16x16x32_bf16 v[120:123], v[36:39], v[72:75], v[120:123]
    v_mfma_f32_16x16x32_bf16 v[124:127], v[36:39], v[76:79], v[124:127]
    v_mfma_f32_16x16x32_bf16 v[128:131], v[36:39], v[80:83], v[128:131]
    ds_read_b128 v[36:39], v27 offset:2048
    s_waitcnt lgkmcnt(12)
    v_mfma_f32_16x16x32_bf16 v[132:135], v[40:43], v[68:71], v[132:135]
    v_mfma_f32_16x16x32_bf16 v[136:139], v[40:43], v[72:75], v[136:139]
    v_mfma_f32_16x16x32_bf16 v[140:143], v[40:43], v[76:79], v[140:143]
    v_mfma_f32_16x16x32_bf16 v[144:147], v[40:43], v[80:83], v[144:147]
    ds_read_b128 v[40:43], v27 offset:4096
    s_waitcnt lgkmcnt(12)
    v_mfma_f32_16x16x32_bf16 v[148:151], v[44:47], v[68:71], v[148:151]
    v_mfma_f32_16x16x32_bf16 v[152:155], v[44:47], v[72:75], v[152:155]
    v_mfma_f32_16x16x32_bf16 v[156:159], v[44:47], v[76:79], v[156:159]
    v_mfma_f32_16x16x32_bf16 v[160:163], v[44:47], v[80:83], v[160:163]
    ds_read_b128 v[44:47], v27 offset:6144
    s_waitcnt lgkmcnt(12)
    v_mfma_f32_16x16x32_bf16 v[164:167], v[48:51], v[68:71], v[164:167]
    v_mfma_f32_16x16x32_bf16 v[168:171], v[48:51], v[72:75], v[168:171]
    v_mfma_f32_16x16x32_bf16 v[172:175], v[48:51], v[76:79], v[172:175]
    v_mfma_f32_16x16x32_bf16 v[176:179], v[48:51], v[80:83], v[176:179]
    ds_read_b128 v[48:51], v27 offset:8192
    s_waitcnt lgkmcnt(12)
    v_mfma_f32_16x16x32_bf16 v[180:183], v[52:55], v[68:71], v[180:183]
    v_mfma_f32_16x16x32_bf16 v[184:187], v[52:55], v[72:75], v[184:187]
    v_mfma_f32_16x16x32_bf16 v[188:191], v[52:55], v[76:79], v[188:191]
    v_mfma_f32_16x16x32_bf16 v[192:195], v[52:55], v[80:83], v[192:195]
    ds_read_b128 v[52:55], v27 offset:10240
    s_waitcnt lgkmcnt(12)
    v_mfma_f32_16x16x32_bf16 v[196:199], v[56:59], v[68:71], v[196:199]
    v_mfma_f32_16x16x32_bf16 v[200:203], v[56:59], v[72:75], v[200:203]
    v_mfma_f32_16x16x32_bf16 v[204:207], v[56:59], v[76:79], v[204:207]
    v_mfma_f32_16x16x32_bf16 v[208:211], v[56:59], v[80:83], v[208:211]
    ds_read_b128 v[56:59], v27 offset:12288
    s_waitcnt lgkmcnt(12)
    v_mfma_f32_16x16x32_bf16 v[212:215], v[60:63], v[68:71], v[212:215]
    v_mfma_f32_16x16x32_bf16 v[216:219], v[60:63], v[72:75], v[216:219]
    v_mfma_f32_16x16x32_bf16 v[220:223], v[60:63], v[76:79], v[220:223]
    v_mfma_f32_16x16x32_bf16 v[224:227], v[60:63], v[80:83], v[224:227]
    ds_read_b128 v[60:63], v27 offset:14336
    s_waitcnt lgkmcnt(12)
    v_mfma_f32_16x16x32_bf16 v[228:231], v[64:67], v[68:71], v[228:231]
    v_mfma_f32_16x16x32_bf16 v[232:235], v[64:67], v[72:75], v[232:235]
    v_mfma_f32_16x16x32_bf16 v[236:239], v[64:67], v[76:79], v[236:239]
    v_mfma_f32_16x16x32_bf16 v[240:243], v[64:67], v[80:83], v[240:243]
    ds_read_b128 v[64:67], v27 offset:16384
    s_add_u32 s54, s54, 1
    s_cmp_eq_u32 s54, 10
    s_cbranch_scc1 parallel_sum__ssm_conv_s5__geglu_ffn__prompt_kernel_tail_s
    s_waitcnt lgkmcnt(8)
    v_mfma_f32_16x16x32_bf16 v[100:103], v[32:35], v[84:87], v[100:103]
    s_add_u32 s53, s53, 51200
    s_cmp_eq_u32 s53, 153600
    v_mfma_f32_16x16x32_bf16 v[104:107], v[32:35], v[88:91], v[104:107]
    s_cselect_b32 s53, 0, s53
    v_add_u32 v26, s53, v20
    v_mfma_f32_16x16x32_bf16 v[108:111], v[32:35], v[92:95], v[108:111]
    v_add_u32 v27, s53, v21
    v_add_u32 v28, s53, v22
    v_mfma_f32_16x16x32_bf16 v[112:115], v[32:35], v[96:99], v[112:115]
    v_add_u32 v29, s53, v23
    s_waitcnt lgkmcnt(7)
    v_mfma_f32_16x16x32_bf16 v[116:119], v[36:39], v[84:87], v[116:119]
    v_mfma_f32_16x16x32_bf16 v[120:123], v[36:39], v[88:91], v[120:123]
    v_mfma_f32_16x16x32_bf16 v[124:127], v[36:39], v[92:95], v[124:127]
    v_mfma_f32_16x16x32_bf16 v[128:131], v[36:39], v[96:99], v[128:131]
    s_waitcnt vmcnt(0) lgkmcnt(0)
    s_barrier
    v_mfma_f32_16x16x32_bf16 v[132:135], v[40:43], v[84:87], v[132:135]
    ds_read_b128 v[32:35], v26 offset:0
    v_mfma_f32_16x16x32_bf16 v[136:139], v[40:43], v[88:91], v[136:139]
    ds_read_b128 v[36:39], v26 offset:2048
    v_mfma_f32_16x16x32_bf16 v[140:143], v[40:43], v[92:95], v[140:143]
    ds_read_b128 v[68:71], v28 offset:0
    v_mfma_f32_16x16x32_bf16 v[144:147], v[40:43], v[96:99], v[144:147]
    ds_read_b128 v[72:75], v28 offset:2048
    v_mfma_f32_16x16x32_bf16 v[148:151], v[44:47], v[84:87], v[148:151]
    ds_read_b128 v[76:79], v28 offset:8192
    v_mfma_f32_16x16x32_bf16 v[152:155], v[44:47], v[88:91], v[152:155]
    ds_read_b128 v[80:83], v28 offset:10240
    v_mfma_f32_16x16x32_bf16 v[156:159], v[44:47], v[92:95], v[156:159]
    ds_read_b128 v[40:43], v26 offset:4096
    v_mfma_f32_16x16x32_bf16 v[160:163], v[44:47], v[96:99], v[160:163]
    ds_read_b128 v[44:47], v26 offset:6144
    v_mfma_f32_16x16x32_bf16 v[164:167], v[48:51], v[84:87], v[164:167]
    v_mfma_f32_16x16x32_bf16 v[168:171], v[48:51], v[88:91], v[168:171]
    v_mfma_f32_16x16x32_bf16 v[172:175], v[48:51], v[92:95], v[172:175]
    v_mfma_f32_16x16x32_bf16 v[176:179], v[48:51], v[96:99], v[176:179]
    ds_read_b128 v[48:51], v26 offset:8192
    v_mfma_f32_16x16x32_bf16 v[180:183], v[52:55], v[84:87], v[180:183]
    v_mfma_f32_16x16x32_bf16 v[184:187], v[52:55], v[88:91], v[184:187]
    v_mfma_f32_16x16x32_bf16 v[188:191], v[52:55], v[92:95], v[188:191]
    v_mfma_f32_16x16x32_bf16 v[192:195], v[52:55], v[96:99], v[192:195]
    ds_read_b128 v[52:55], v26 offset:10240
    v_mfma_f32_16x16x32_bf16 v[196:199], v[56:59], v[84:87], v[196:199]
    v_mfma_f32_16x16x32_bf16 v[200:203], v[56:59], v[88:91], v[200:203]
    v_mfma_f32_16x16x32_bf16 v[204:207], v[56:59], v[92:95], v[204:207]
    v_mfma_f32_16x16x32_bf16 v[208:211], v[56:59], v[96:99], v[208:211]
    ds_read_b128 v[56:59], v26 offset:12288
    v_mfma_f32_16x16x32_bf16 v[212:215], v[60:63], v[84:87], v[212:215]
    v_mfma_f32_16x16x32_bf16 v[216:219], v[60:63], v[88:91], v[216:219]
    v_mfma_f32_16x16x32_bf16 v[220:223], v[60:63], v[92:95], v[220:223]
    v_mfma_f32_16x16x32_bf16 v[224:227], v[60:63], v[96:99], v[224:227]
    ds_read_b128 v[60:63], v26 offset:14336
    v_mfma_f32_16x16x32_bf16 v[228:231], v[64:67], v[84:87], v[228:231]
    v_mfma_f32_16x16x32_bf16 v[232:235], v[64:67], v[88:91], v[232:235]
    v_mfma_f32_16x16x32_bf16 v[236:239], v[64:67], v[92:95], v[236:239]
    v_mfma_f32_16x16x32_bf16 v[240:243], v[64:67], v[96:99], v[240:243]
    ds_read_b128 v[64:67], v26 offset:16384
    s_branch parallel_sum__ssm_conv_s5__geglu_ffn__prompt_kernel_loop_s
parallel_sum__ssm_conv_s5__geglu_ffn__prompt_kernel_tail_s:
    s_waitcnt vmcnt(0)
    s_mov_b32 s5, 0
parallel_sum__ssm_conv_s5__geglu_ffn__prompt_kernel_tc_44:
    v_cmp_eq_u32 vcc, 0, v252
    s_add_u32 s5, s5, 1
    s_nop 3
    s_cbranch_vccz parallel_sum__ssm_conv_s5__geglu_ffn__prompt_kernel_tco_45
    s_cmp_ge_u32 s5, 0x20000
    s_cbranch_scc1 parallel_sum__ssm_conv_s5__geglu_ffn__prompt_kernel_tco_45
    s_sleep 2
    buffer_load_dword v252, v30, s[40:43], 0 offen sc1
    s_waitcnt vmcnt(0)
    s_branch parallel_sum__ssm_conv_s5__geglu_ffn__prompt_kernel_tc_44
parallel_sum__ssm_conv_s5__geglu_ffn__prompt_kernel_tco_45:
    s_waitcnt lgkmcnt(8)
    v_mfma_f32_16x16x32_bf16 v[100:103], v[32:35], v[84:87], v[100:103]
    v_lshlrev_b32 v246, 16, v246
    v_lshlrev_b32 v247, 16, v247
    v_mfma_f32_16x16x32_bf16 v[104:107], v[32:35], v[88:91], v[104:107]
    v_lshlrev_b32 v248, 16, v248
    v_mul_f32 v248, 0x3fb8aa3b, v248
    v_mfma_f32_16x16x32_bf16 v[108:111], v[32:35], v[92:95], v[108:111]
    v_exp_f32 v248, v248
    s_nop 0
    v_mfma_f32_16x16x32_bf16 v[112:115], v[32:35], v[96:99], v[112:115]
    v_cvt_pk_bf16_f32 v248, v248, v248
    v_lshlrev_b32 v248, 16, v248
    s_waitcnt lgkmcnt(7)
    v_mfma_f32_16x16x32_bf16 v[116:119], v[36:39], v[84:87], v[116:119]
    v_mul_f32 v6, v248, v246
    v_mul_f32 v7, v248, v247
    v_mfma_f32_16x16x32_bf16 v[120:123], v[36:39], v[88:91], v[120:123]
    v_mul_f32 v6, 0x3fb8aa3b, v6
    v_mul_f32 v7, 0.15915494, v7
    v_mfma_f32_16x16x32_bf16 v[124:127], v[36:39], v[92:95], v[124:127]
    v_exp_f32 v244, v6
    v_rndne_f32 v245, v7
    v_mfma_f32_16x16x32_bf16 v[128:131], v[36:39], v[96:99], v[128:131]
    v_sub_f32 v245, v7, v245
    v_cos_f32 v8, v245
    s_waitcnt lgkmcnt(6)
    v_mfma_f32_16x16x32_bf16 v[132:135], v[40:43], v[84:87], v[132:135]
    v_sin_f32 v9, v245
    s_nop 0
    v_mfma_f32_16x16x32_bf16 v[136:139], v[40:43], v[88:91], v[136:139]
    v_mul_f32 v8, v8, v244
    v_mul_f32 v9, v9, v244
    v_mfma_f32_16x16x32_bf16 v[140:143], v[40:43], v[92:95], v[140:143]
    v_mul_f32 v244, 0x41900000, v6
    v_mul_f32 v245, 0x41900000, v7
    v_mfma_f32_16x16x32_bf16 v[144:147], v[40:43], v[96:99], v[144:147]
    v_exp_f32 v244, v244
    v_fract_f32 v245, v245
    s_waitcnt lgkmcnt(5)
    v_mfma_f32_16x16x32_bf16 v[148:151], v[44:47], v[84:87], v[148:151]
    v_cos_f32 v16, v245
    v_sin_f32 v17, v245
    v_mfma_f32_16x16x32_bf16 v[152:155], v[44:47], v[88:91], v[152:155]
    s_nop 0
    v_mul_f32 v16, v16, v244
    v_mfma_f32_16x16x32_bf16 v[156:159], v[44:47], v[92:95], v[156:159]
    v_mul_f32 v17, v17, v244
    v_mul_f32 v18, v16, v16
    v_mfma_f32_16x16x32_bf16 v[160:163], v[44:47], v[96:99], v[160:163]
    v_mul_f32 v19, v16, v17
    v_fma_f32 v18, -v17, v17, v18
    s_waitcnt lgkmcnt(4)
    v_mfma_f32_16x16x32_bf16 v[164:167], v[48:51], v[84:87], v[164:167]
    v_fmac_f32 v19, v17, v16
    v_mul_f32 v244, v246, v246
    v_mfma_f32_16x16x32_bf16 v[168:171], v[48:51], v[88:91], v[168:171]
    v_fmac_f32 v244, v247, v247
    v_rcp_f32 v244, v244
    v_mfma_f32_16x16x32_bf16 v[172:175], v[48:51], v[92:95], v[172:175]
    v_add_f32 v245, -1.0, v8
    v_mul_f32 v10, v245, v246
    v_mfma_f32_16x16x32_bf16 v[176:179], v[48:51], v[96:99], v[176:179]
    v_fmac_f32 v10, v9, v247
    v_mul_f32 v11, v9, v246
    s_waitcnt lgkmcnt(3)
    v_mfma_f32_16x16x32_bf16 v[180:183], v[52:55], v[84:87], v[180:183]
    v_fma_f32 v11, -v245, v247, v11
    v_add_f32 v244, v244, v244
    v_mfma_f32_16x16x32_bf16 v[184:187], v[52:55], v[88:91], v[184:187]
    v_mul_f32 v10, v10, v244
    v_mul_f32 v11, v11, v244
    v_mfma_f32_16x16x32_bf16 v[188:191], v[52:55], v[92:95], v[188:191]
    v_mov_b32 v68, v6
    v_mov_b32 v69, v7
    v_mfma_f32_16x16x32_bf16 v[192:195], v[52:55], v[96:99], v[192:195]
    v_mov_b32 v70, v8
    v_mov_b32 v71, v9
    s_waitcnt vmcnt(0) lgkmcnt(0)
    s_barrier
    v_mfma_f32_16x16x32_bf16 v[196:199], v[56:59], v[84:87], v[196:199]
    ds_read2_b32 v[12:13], v24 offset0:0 offset1:16
    v_mov_b32 v72, v10
    v_mov_b32 v73, v11
    v_mfma_f32_16x16x32_bf16 v[200:203], v[56:59], v[88:91], v[200:203]
    ds_read2_b32 v[14:15], v24 offset0:32 offset1:48
    v_mov_b32 v74, v16
    v_mov_b32 v75, v17
    v_mfma_f32_16x16x32_bf16 v[204:207], v[56:59], v[92:95], v[204:207]
    ds_read_b128 v[32:35], v31 offset:0
    v_mov_b32 v76, v18
    v_mov_b32 v77, v19
    v_mfma_f32_16x16x32_bf16 v[208:211], v[56:59], v[96:99], v[208:211]
    ds_read_b128 v[36:39], v31 offset:576
    s_nop 1
    v_permlane16_swap_b32 v6, v68
    v_mfma_f32_16x16x32_bf16 v[212:215], v[60:63], v[84:87], v[212:215]
    ds_read_b128 v[40:43], v31 offset:16
    v_permlane16_swap_b32 v7, v69
    v_permlane16_swap_b32 v8, v70
    v_mfma_f32_16x16x32_bf16 v[216:219], v[60:63], v[88:91], v[216:219]
    ds_read_b128 v[44:47], v31 offset:592
    v_permlane16_swap_b32 v9, v71
    v_permlane16_swap_b32 v10, v72
    v_mfma_f32_16x16x32_bf16 v[220:223], v[60:63], v[92:95], v[220:223]
    ds_read_b128 v[48:51], v31 offset:32
    v_permlane16_swap_b32 v11, v73
    v_permlane16_swap_b32 v16, v74
    v_mfma_f32_16x16x32_bf16 v[224:227], v[60:63], v[96:99], v[224:227]
    ds_read_b128 v[52:55], v31 offset:608
    v_permlane16_swap_b32 v17, v75
    v_permlane16_swap_b32 v18, v76
    v_mfma_f32_16x16x32_bf16 v[228:231], v[64:67], v[84:87], v[228:231]
    v_permlane16_swap_b32 v19, v77
    v_mfma_f32_16x16x32_bf16 v[232:235], v[64:67], v[88:91], v[232:235]
    v_mfma_f32_16x16x32_bf16 v[236:239], v[64:67], v[92:95], v[236:239]
    v_mfma_f32_16x16x32_bf16 v[240:243], v[64:67], v[96:99], v[240:243]
    s_nop 0
    ds_read_b128 v[56:59], v31 offset:48
    ds_read_b128 v[60:63], v31 offset:624
    ds_read_b128 v[84:87], v31 offset:64
    ds_read_b128 v[88:91], v31 offset:640
    ds_read_b128 v[92:95], v31 offset:80
    ds_read_b128 v[96:99], v31 offset:656
    s_waitcnt lgkmcnt(10)
    s_nop 0
    v_pk_fma_f32 v[100:101], v[32:33], v[12:13], v[100:101] op_sel:[0,0,0] op_sel_hi:[1,0,1] neg_lo:[1,0,0] neg_hi:[1,0,0]
    v_pk_fma_f32 v[102:103], v[34:35], v[12:13], v[102:103] op_sel:[0,0,0] op_sel_hi:[1,0,1] neg_lo:[1,0,0] neg_hi:[1,0,0]
    v_pk_fma_f32 v[104:105], v[12:13], v[32:33], v[104:105] op_sel:[1,0,0] op_sel_hi:[1,1,1] neg_lo:[0,1,0] neg_hi:[0,1,0]
    v_pk_fma_f32 v[106:107], v[12:13], v[34:35], v[106:107] op_sel:[1,0,0] op_sel_hi:[1,1,1] neg_lo:[0,1,0] neg_hi:[0,1,0]
    v_pk_fma_f32 v[108:109], v[32:33], v[14:15], v[108:109] op_sel:[0,0,0] op_sel_hi:[1,0,1] neg_lo:[1,0,0] neg_hi:[1,0,0]
    v_pk_fma_f32 v[110:111], v[34:35], v[14:15], v[110:111] op_sel:[0,0,0] op_sel_hi:[1,0,1] neg_lo:[1,0,0] neg_hi:[1,0,0]
    v_pk_fma_f32 v[112:113], v[14:15], v[32:33], v[112:113] op_sel:[1,0,0] op_sel_hi:[1,1,1] neg_lo:[0,1,0] neg_hi:[0,1,0]
    v_pk_fma_f32 v[114:115], v[14:15], v[34:35], v[114:115] op_sel:[1,0,0] op_sel_hi:[1,1,1] neg_lo:[0,1,0] neg_hi:[0,1,0]
    v_pk_mul_f32 v[100:101], v[100:101], v[36:37] op_sel:[0,0] op_sel_hi:[1,1]
    v_pk_mul_f32 v[102:103], v[102:103], v[38:39] op_sel:[0,0] op_sel_hi:[1,1]
    v_pk_mul_f32 v[104:105], v[104:105], v[36:37] op_sel:[0,0] op_sel_hi:[1,1]
    v_pk_mul_f32 v[106:107], v[106:107], v[38:39] op_sel:[0,0] op_sel_hi:[1,1]
    v_pk_mul_f32 v[108:109], v[108:109], v[36:37] op_sel:[0,0] op_sel_hi:[1,1]
    v_pk_mul_f32 v[110:111], v[110:111], v[38:39] op_sel:[0,0] op_sel_hi:[1,1]
    v_pk_mul_f32 v[112:113], v[112:113], v[36:37] op_sel:[0,0] op_sel_hi:[1,1]
    v_pk_mul_f32 v[114:115], v[114:115], v[38:39] op_sel:[0,0] op_sel_hi:[1,1]
    ds_read_b128 v[32:35], v31 offset:96
    ds_read_b128 v[36:39], v31 offset:672
    v_pk_fma_f32 v[102:103], v[100:101], v[8:9], v[102:103] op_sel:[0,0,0] op_sel_hi:[1,0,1]
    v_pk_fma_f32 v[110:111], v[108:109], v[8:9], v[110:111] op_sel:[0,0,0] op_sel_hi:[1,0,1]
    v_pk_fma_f32 v[106:107], v[104:105], v[70:71], v[106:107] op_sel:[0,0,0] op_sel_hi:[1,0,1]
    v_pk_fma_f32 v[114:115], v[112:113], v[70:71], v[114:115] op_sel:[0,0,0] op_sel_hi:[1,0,1]
    v_pk_fma_f32 v[102:103], v[8:9], v[108:109], v[102:103] op_sel:[1,0,0] op_sel_hi:[1,1,1] neg_lo:[0,1,0] neg_hi:[0,1,0]
    v_pk_fma_f32 v[110:111], v[8:9], v[100:101], v[110:111] op_sel:[1,0,0] op_sel_hi:[1,1,1]
    v_pk_fma_f32 v[106:107], v[70:71], v[112:113], v[106:107] op_sel:[1,0,0] op_sel_hi:[1,1,1] neg_lo:[0,1,0] neg_hi:[0,1,0]
    v_pk_fma_f32 v[114:115], v[70:71], v[104:105], v[114:115] op_sel:[1,0,0] op_sel_hi:[1,1,1]
    s_waitcnt lgkmcnt(10)
    s_nop 0
    v_pk_fma_f32 v[116:117], v[40:41], v[12:13], v[116:117] op_sel:[0,0,0] op_sel_hi:[1,0,1] neg_lo:[1,0,0] neg_hi:[1,0,0]
    v_pk_fma_f32 v[118:119], v[42:43], v[12:13], v[118:119] op_sel:[0,0,0] op_sel_hi:[1,0,1] neg_lo:[1,0,0] neg_hi:[1,0,0]
    v_pk_fma_f32 v[120:121], v[12:13], v[40:41], v[120:121] op_sel:[1,0,0] op_sel_hi:[1,1,1] neg_lo:[0,1,0] neg_hi:[0,1,0]
    v_pk_fma_f32 v[122:123], v[12:13], v[42:43], v[122:123] op_sel:[1,0,0] op_sel_hi:[1,1,1] neg_lo:[0,1,0] neg_hi:[0,1,0]
    v_pk_fma_f32 v[124:125], v[40:41], v[14:15], v[124:125] op_sel:[0,0,0] op_sel_hi:[1,0,1] neg_lo:[1,0,0] neg_hi:[1,0,0]
    v_pk_fma_f32 v[126:127], v[42:43], v[14:15], v[126:127] op_sel:[0,0,0] op_sel_hi:[1,0,1] neg_lo:[1,0,0] neg_hi:[1,0,0]
    v_pk_fma_f32 v[128:129], v[14:15], v[40:41], v[128:129] op_sel:[1,0,0] op_sel_hi:[1,1,1] neg_lo:[0,1,0] neg_hi:[0,1,0]
    v_pk_fma_f32 v[130:131], v[14:15], v[42:43], v[130:131] op_sel:[1,0,0] op_sel_hi:[1,1,1] neg_lo:[0,1,0] neg_hi:[0,1,0]
    v_pk_mul_f32 v[116:117], v[116:117], v[44:45] op_sel:[0,0] op_sel_hi:[1,1]
    v_pk_mul_f32 v[118:119], v[118:119], v[46:47] op_sel:[0,0] op_sel_hi:[1,1]
    v_pk_mul_f32 v[120:121], v[120:121], v[44:45] op_sel:[0,0] op_sel_hi:[1,1]
    v_pk_mul_f32 v[122:123], v[122:123], v[46:47] op_sel:[0,0] op_sel_hi:[1,1]
    v_pk_mul_f32 v[124:125], v[124:125], v[44:45] op_sel:[0,0] op_sel_hi:[1,1]
    v_pk_mul_f32 v[126:127], v[126:127], v[46:47] op_sel:[0,0] op_sel_hi:[1,1]
    v_pk_mul_f32 v[128:129], v[128:129], v[44:45] op_sel:[0,0] op_sel_hi:[1,1]
    v_pk_mul_f32 v[130:131], v[130:131], v[46:47] op_sel:[0,0] op_sel_hi:[1,1]
    ds_read_b128 v[40:43], v31 offset:112
    ds_read_b128 v[44:47], v31 offset:688
    v_pk_fma_f32 v[116:117], v[102:103], v[8:9], v[116:117] op_sel:[0,0,0] op_sel_hi:[1,0,1]
    v_pk_fma_f32 v[124:125], v[110:111], v[8:9], v[124:125] op_sel:[0,0,0] op_sel_hi:[1,0,1]
    v_pk_fma_f32 v[120:121], v[106:107], v[70:71], v[120:121] op_sel:[0,0,0] op_sel_hi:[1,0,1]
    v_pk_fma_f32 v[128:129], v[114:115], v[70:71], v[128:129] op_sel:[0,0,0] op_sel_hi:[1,0,1]
    v_pk_fma_f32 v[116:117], v[8:9], v[110:111], v[116:117] op_sel:[1,0,0] op_sel_hi:[1,1,1] neg_lo:[0,1,0] neg_hi:[0,1,0]
    v_pk_fma_f32 v[124:125], v[8:9], v[102:103], v[124:125] op_sel:[1,0,0] op_sel_hi:[1,1,1]
    v_pk_fma_f32 v[120:121], v[70:71], v[114:115], v[120:121] op_sel:[1,0,0] op_sel_hi:[1,1,1] neg_lo:[0,1,0] neg_hi:[0,1,0]
    v_pk_fma_f32 v[128:129], v[70:71], v[106:107], v[128:129] op_sel:[1,0,0] op_sel_hi:[1,1,1]
    v_pk_fma_f32 v[118:119], v[116:117], v[8:9], v[118:119] op_sel:[0,0,0] op_sel_hi:[1,0,1]
    v_pk_fma_f32 v[126:127], v[124:125], v[8:9], v[126:127] op_sel:[0,0,0] op_sel_hi:[1,0,1]
    v_pk_fma_f32 v[122:123], v[120:121], v[70:71], v[122:123] op_sel:[0,0,0] op_sel_hi:[1,0,1]
    v_pk_fma_f32 v[130:131], v[128:129], v[70:71], v[130:131] op_sel:[0,0,0] op_sel_hi:[1,0,1]
    v_pk_fma_f32 v[118:119], v[8:9], v[124:125], v[118:119] op_sel:[1,0,0] op_sel_hi:[1,1,1] neg_lo:[0,1,0] neg_hi:[0,1,0]
    v_pk_fma_f32 v[126:127], v[8:9], v[116:117], v[126:127] op_sel:[1,0,0] op_sel_hi:[1,1,1]
    v_pk_fma_f32 v[122:123], v[70:71], v[128:129], v[122:123] op_sel:[1,0,0] op_sel_hi:[1,1,1] neg_lo:[0,1,0] neg_hi:[0,1,0]
    v_pk_fma_f32 v[130:131], v[70:71], v[120:121], v[130:131] op_sel:[1,0,0] op_sel_hi:[1,1,1]
    s_waitcnt lgkmcnt(10)
    s_nop 0
    v_pk_fma_f32 v[132:133], v[48:49], v[12:13], v[132:133] op_sel:[0,0,0] op_sel_hi:[1,0,1] neg_lo:[1,0,0] neg_hi:[1,0,0]
    v_pk_fma_f32 v[134:135], v[50:51], v[12:13], v[134:135] op_sel:[0,0,0] op_sel_hi:[1,0,1] neg_lo:[1,0,0] neg_hi:[1,0,0]
    v_pk_fma_f32 v[136:137], v[12:13], v[48:49], v[136:137] op_sel:[1,0,0] op_sel_hi:[1,1,1] neg_lo:[0,1,0] neg_hi:[0,1,0]
    v_pk_fma_f32 v[138:139], v[12:13], v[50:51], v[138:139] op_sel:[1,0,0] op_sel_hi:[1,1,1] neg_lo:[0,1,0] neg_hi:[0,1,0]
    v_pk_fma_f32 v[140:141], v[48:49], v[14:15], v[140:141] op_sel:[0,0,0] op_sel_hi:[1,0,1] neg_lo:[1,0,0] neg_hi:[1,0,0]
    v_pk_fma_f32 v[142:143], v[50:51], v[14:15], v[142:143] op_sel:[0,0,0] op_sel_hi:[1,0,1] neg_lo:[1,0,0] neg_hi:[1,0,0]
    v_pk_fma_f32 v[144:145], v[14:15], v[48:49], v[144:145] op_sel:[1,0,0] op_sel_hi:[1,1,1] neg_lo:[0,1,0] neg_hi:[0,1,0]
    v_pk_fma_f32 v[146:147], v[14:15], v[50:51], v[146:147] op_sel:[1,0,0] op_sel_hi:[1,1,1] neg_lo:[0,1,0] neg_hi:[0,1,0]
    v_pk_mul_f32 v[132:133], v[132:133], v[52:53] op_sel:[0,0] op_sel_hi:[1,1]
    v_pk_mul_f32 v[134:135], v[134:135], v[54:55] op_sel:[0,0] op_sel_hi:[1,1]
    v_pk_mul_f32 v[136:137], v[136:137], v[52:53] op_sel:[0,0] op_sel_hi:[1,1]
    v_pk_mul_f32 v[138:139], v[138:139], v[54:55] op_sel:[0,0] op_sel_hi:[1,1]
    v_pk_mul_f32 v[140:141], v[140:141], v[52:53] op_sel:[0,0] op_sel_hi:[1,1]
    v_pk_mul_f32 v[142:143], v[142:143], v[54:55] op_sel:[0,0] op_sel_hi:[1,1]
    v_pk_mul_f32 v[144:145], v[144:145], v[52:53] op_sel:[0,0] op_sel_hi:[1,1]
    v_pk_mul_f32 v[146:147], v[146:147], v[54:55] op_sel:[0,0] op_sel_hi:[1,1]
    ds_read_b128 v[48:51], v31 offset:128
    ds_read_b128 v[52:55], v31 offset:704
    v_pk_fma_f32 v[132:133], v[118:119], v[8:9], v[132:133] op_sel:[0,0,0] op_sel_hi:[1,0,1]
    v_pk_fma_f32 v[140:141], v[126:127], v[8:9], v[140:141] op_sel:[0,0,0] op_sel_hi:[1,0,1]
    v_pk_fma_f32 v[136:137], v[122:123], v[70:71], v[136:137] op_sel:[0,0,0] op_sel_hi:[1,0,1]
    v_pk_fma_f32 v[144:145], v[130:131], v[70:71], v[144:145] op_sel:[0,0,0] op_sel_hi:[1,0,1]
    v_pk_fma_f32 v[132:133], v[8:9], v[126:127], v[132:133] op_sel:[1,0,0] op_sel_hi:[1,1,1] neg_lo:[0,1,0] neg_hi:[0,1,0]
    v_pk_fma_f32 v[140:141], v[8:9], v[118:119], v[140:141] op_sel:[1,0,0] op_sel_hi:[1,1,1]
    v_pk_fma_f32 v[136:137], v[70:71], v[130:131], v[136:137] op_sel:[1,0,0] op_sel_hi:[1,1,1] neg_lo:[0,1,0] neg_hi:[0,1,0]
    v_pk_fma_f32 v[144:145], v[70:71], v[122:123], v[144:145] op_sel:[1,0,0] op_sel_hi:[1,1,1]
    v_pk_fma_f32 v[134:135], v[132:133], v[8:9], v[134:135] op_sel:[0,0,0] op_sel_hi:[1,0,1]
    v_pk_fma_f32 v[142:143], v[140:141], v[8:9], v[142:143] op_sel:[0,0,0] op_sel_hi:[1,0,1]
    v_pk_fma_f32 v[138:139], v[136:137], v[70:71], v[138:139] op_sel:[0,0,0] op_sel_hi:[1,0,1]
    v_pk_fma_f32 v[146:147], v[144:145], v[70:71], v[146:147] op_sel:[0,0,0] op_sel_hi:[1,0,1]
    v_pk_fma_f32 v[134:135], v[8:9], v[140:141], v[134:135] op_sel:[1,0,0] op_sel_hi:[1,1,1] neg_lo:[0,1,0] neg_hi:[0,1,0]
    v_pk_fma_f32 v[142:143], v[8:9], v[132:133], v[142:143] op_sel:[1,0,0] op_sel_hi:[1,1,1]
    v_pk_fma_f32 v[138:139], v[70:71], v[144:145], v[138:139] op_sel:[1,0,0] op_sel_hi:[1,1,1] neg_lo:[0,1,0] neg_hi:[0,1,0]
    v_pk_fma_f32 v[146:147], v[70:71], v[136:137], v[146:147] op_sel:[1,0,0] op_sel_hi:[1,1,1]
    s_waitcnt lgkmcnt(10)
    s_nop 0
    v_pk_fma_f32 v[148:149], v[56:57], v[12:13], v[148:149] op_sel:[0,0,0] op_sel_hi:[1,0,1] neg_lo:[1,0,0] neg_hi:[1,0,0]
    v_pk_fma_f32 v[150:151], v[58:59], v[12:13], v[150:151] op_sel:[0,0,0] op_sel_hi:[1,0,1] neg_lo:[1,0,0] neg_hi:[1,0,0]
    v_pk_fma_f32 v[152:153], v[12:13], v[56:57], v[152:153] op_sel:[1,0,0] op_sel_hi:[1,1,1] neg_lo:[0,1,0] neg_hi:[0,1,0]
    v_pk_fma_f32 v[154:155], v[12:13], v[58:59], v[154:155] op_sel:[1,0,0] op_sel_hi:[1,1,1] neg_lo:[0,1,0] neg_hi:[0,1,0]
    v_pk_fma_f32 v[156:157], v[56:57], v[14:15], v[156:157] op_sel:[0,0,0] op_sel_hi:[1,0,1] neg_lo:[1,0,0] neg_hi:[1,0,0]
    v_pk_fma_f32 v[158:159], v[58:59], v[14:15], v[158:159] op_sel:[0,0,0] op_sel_hi:[1,0,1] neg_lo:[1,0,0] neg_hi:[1,0,0]
    v_pk_fma_f32 v[160:161], v[14:15], v[56:57], v[160:161] op_sel:[1,0,0] op_sel_hi:[1,1,1] neg_lo:[0,1,0] neg_hi:[0,1,0]
    v_pk_fma_f32 v[162:163], v[14:15], v[58:59], v[162:163] op_sel:[1,0,0] op_sel_hi:[1,1,1] neg_lo:[0,1,0] neg_hi:[0,1,0]
    v_pk_mul_f32 v[148:149], v[148:149], v[60:61] op_sel:[0,0] op_sel_hi:[1,1]
    v_pk_mul_f32 v[150:151], v[150:151], v[62:63] op_sel:[0,0] op_sel_hi:[1,1]
    v_pk_mul_f32 v[152:153], v[152:153], v[60:61] op_sel:[0,0] op_sel_hi:[1,1]
    v_pk_mul_f32 v[154:155], v[154:155], v[62:63] op_sel:[0,0] op_sel_hi:[1,1]
    v_pk_mul_f32 v[156:157], v[156:157], v[60:61] op_sel:[0,0] op_sel_hi:[1,1]
    v_pk_mul_f32 v[158:159], v[158:159], v[62:63] op_sel:[0,0] op_sel_hi:[1,1]
    v_pk_mul_f32 v[160:161], v[160:161], v[60:61] op_sel:[0,0] op_sel_hi:[1,1]
    v_pk_mul_f32 v[162:163], v[162:163], v[62:63] op_sel:[0,0] op_sel_hi:[1,1]
    v_pk_fma_f32 v[148:149], v[134:135], v[8:9], v[148:149] op_sel:[0,0,0] op_sel_hi:[1,0,1]
    v_pk_fma_f32 v[156:157], v[142:143], v[8:9], v[156:157] op_sel:[0,0,0] op_sel_hi:[1,0,1]
    v_pk_fma_f32 v[152:153], v[138:139], v[70:71], v[152:153] op_sel:[0,0,0] op_sel_hi:[1,0,1]
    v_pk_fma_f32 v[160:161], v[146:147], v[70:71], v[160:161] op_sel:[0,0,0] op_sel_hi:[1,0,1]
    v_pk_fma_f32 v[148:149], v[8:9], v[142:143], v[148:149] op_sel:[1,0,0] op_sel_hi:[1,1,1] neg_lo:[0,1,0] neg_hi:[0,1,0]
    v_pk_fma_f32 v[156:157], v[8:9], v[134:135], v[156:157] op_sel:[1,0,0] op_sel_hi:[1,1,1]
    v_pk_fma_f32 v[152:153], v[70:71], v[146:147], v[152:153] op_sel:[1,0,0] op_sel_hi:[1,1,1] neg_lo:[0,1,0] neg_hi:[0,1,0]
    v_pk_fma_f32 v[160:161], v[70:71], v[138:139], v[160:161] op_sel:[1,0,0] op_sel_hi:[1,1,1]
    v_pk_fma_f32 v[150:151], v[148:149], v[8:9], v[150:151] op_sel:[0,0,0] op_sel_hi:[1,0,1]
    v_pk_fma_f32 v[158:159], v[156:157], v[8:9], v[158:159] op_sel:[0,0,0] op_sel_hi:[1,0,1]
    v_pk_fma_f32 v[154:155], v[152:153], v[70:71], v[154:155] op_sel:[0,0,0] op_sel_hi:[1,0,1]
    v_pk_fma_f32 v[162:163], v[160:161], v[70:71], v[162:163] op_sel:[0,0,0] op_sel_hi:[1,0,1]
    v_pk_fma_f32 v[150:151], v[8:9], v[156:157], v[150:151] op_sel:[1,0,0] op_sel_hi:[1,1,1] neg_lo:[0,1,0] neg_hi:[0,1,0]
    v_pk_fma_f32 v[158:159], v[8:9], v[148:149], v[158:159] op_sel:[1,0,0] op_sel_hi:[1,1,1]
    v_pk_fma_f32 v[154:155], v[70:71], v[160:161], v[154:155] op_sel:[1,0,0] op_sel_hi:[1,1,1] neg_lo:[0,1,0] neg_hi:[0,1,0]
    v_pk_fma_f32 v[162:163], v[70:71], v[152:153], v[162:163] op_sel:[1,0,0] op_sel_hi:[1,1,1]
    s_waitcnt lgkmcnt(8)
    s_nop 0
    v_pk_fma_f32 v[164:165], v[84:85], v[12:13], v[164:165] op_sel:[0,0,0] op_sel_hi:[1,0,1] neg_lo:[1,0,0] neg_hi:[1,0,0]
    v_pk_fma_f32 v[166:167], v[86:87], v[12:13], v[166:167] op_sel:[0,0,0] op_sel_hi:[1,0,1] neg_lo:[1,0,0] neg_hi:[1,0,0]
    v_pk_fma_f32 v[168:169], v[12:13], v[84:85], v[168:169] op_sel:[1,0,0] op_sel_hi:[1,1,1] neg_lo:[0,1,0] neg_hi:[0,1,0]
    v_pk_fma_f32 v[170:171], v[12:13], v[86:87], v[170:171] op_sel:[1,0,0] op_sel_hi:[1,1,1] neg_lo:[0,1,0] neg_hi:[0,1,0]
    v_pk_fma_f32 v[172:173], v[84:85], v[14:15], v[172:173] op_sel:[0,0,0] op_sel_hi:[1,0,1] neg_lo:[1,0,0] neg_hi:[1,0,0]
    v_pk_fma_f32 v[174:175], v[86:87], v[14:15], v[174:175] op_sel:[0,0,0] op_sel_hi:[1,0,1] neg_lo:[1,0,0] neg_hi:[1,0,0]
    v_pk_fma_f32 v[176:177], v[14:15], v[84:85], v[176:177] op_sel:[1,0,0] op_sel_hi:[1,1,1] neg_lo:[0,1,0] neg_hi:[0,1,0]
    v_pk_fma_f32 v[178:179], v[14:15], v[86:87], v[178:179] op_sel:[1,0,0] op_sel_hi:[1,1,1] neg_lo:[0,1,0] neg_hi:[0,1,0]
    v_pk_mul_f32 v[164:165], v[164:165], v[88:89] op_sel:[0,0] op_sel_hi:[1,1]
    v_pk_mul_f32 v[166:167], v[166:167], v[90:91] op_sel:[0,0] op_sel_hi:[1,1]
    v_pk_mul_f32 v[168:169], v[168:169], v[88:89] op_sel:[0,0] op_sel_hi:[1,1]
    v_pk_mul_f32 v[170:171], v[170:171], v[90:91] op_sel:[0,0] op_sel_hi:[1,1]
    v_pk_mul_f32 v[172:173], v[172:173], v[88:89] op_sel:[0,0] op_sel_hi:[1,1]
    v_pk_mul_f32 v[174:175], v[174:175], v[90:91] op_sel:[0,0] op_sel_hi:[1,1]
    v_pk_mul_f32 v[176:177], v[176:177], v[88:89] op_sel:[0,0] op_sel_hi:[1,1]
    v_pk_mul_f32 v[178:179], v[178:179], v[90:91] op_sel:[0,0] op_sel_hi:[1,1]
    v_pk_fma_f32 v[164:165], v[150:151], v[8:9], v[164:165] op_sel:[0,0,0] op_sel_hi:[1,0,1]
    v_pk_fma_f32 v[172:173], v[158:159], v[8:9], v[172:173] op_sel:[0,0,0] op_sel_hi:[1,0,1]
    v_pk_fma_f32 v[168:169], v[154:155], v[70:71], v[168:169] op_sel:[0,0,0] op_sel_hi:[1,0,1]
    v_pk_fma_f32 v[176:177], v[162:163], v[70:71], v[176:177] op_sel:[0,0,0] op_sel_hi:[1,0,1]
    v_pk_fma_f32 v[164:165], v[8:9], v[158:159], v[164:165] op_sel:[1,0,0] op_sel_hi:[1,1,1] neg_lo:[0,1,0] neg_hi:[0,1,0]
    v_pk_fma_f32 v[172:173], v[8:9], v[150:151], v[172:173] op_sel:[1,0,0] op_sel_hi:[1,1,1]
    v_pk_fma_f32 v[168:169], v[70:71], v[162:163], v[168:169] op_sel:[1,0,0] op_sel_hi:[1,1,1] neg_lo:[0,1,0] neg_hi:[0,1,0]
    v_pk_fma_f32 v[176:177], v[70:71], v[154:155], v[176:177] op_sel:[1,0,0] op_sel_hi:[1,1,1]
    v_pk_fma_f32 v[166:167], v[164:165], v[8:9], v[166:167] op_sel:[0,0,0] op_sel_hi:[1,0,1]
    v_pk_fma_f32 v[174:175], v[172:173], v[8:9], v[174:175] op_sel:[0,0,0] op_sel_hi:[1,0,1]
    v_pk_fma_f32 v[170:171], v[168:169], v[70:71], v[170:171] op_sel:[0,0,0] op_sel_hi:[1,0,1]
    v_pk_fma_f32 v[178:179], v[176:177], v[70:71], v[178:179] op_sel:[0,0,0] op_sel_hi:[1,0,1]
    v_pk_fma_f32 v[166:167], v[8:9], v[172:173], v[166:167] op_sel:[1,0,0] op_sel_hi:[1,1,1] neg_lo:[0,1,0] neg_hi:[0,1,0]
    v_pk_fma_f32 v[174:175], v[8:9], v[164:165], v[174:175] op_sel:[1,0,0] op_sel_hi:[1,1,1]
    v_pk_fma_f32 v[170:171], v[70:71], v[176:177], v[170:171] op_sel:[1,0,0] op_sel_hi:[1,1,1] neg_lo:[0,1,0] neg_hi:[0,1,0]
    v_pk_fma_f32 v[178:179], v[70:71], v[168:169], v[178:179] op_sel:[1,0,0] op_sel_hi:[1,1,1]
    s_waitcnt lgkmcnt(6)
    s_nop 0
    v_pk_fma_f32 v[180:181], v[92:93], v[12:13], v[180:181] op_sel:[0,0,0] op_sel_hi:[1,0,1] neg_lo:[1,0,0] neg_hi:[1,0,0]
    v_pk_fma_f32 v[182:183], v[94:95], v[12:13], v[182:183] op_sel:[0,0,0] op_sel_hi:[1,0,1] neg_lo:[1,0,0] neg_hi:[1,0,0]
    v_pk_fma_f32 v[184:185], v[12:13], v[92:93], v[184:185] op_sel:[1,0,0] op_sel_hi:[1,1,1] neg_lo:[0,1,0] neg_hi:[0,1,0]
    v_pk_fma_f32 v[186:187], v[12:13], v[94:95], v[186:187] op_sel:[1,0,0] op_sel_hi:[1,1,1] neg_lo:[0,1,0] neg_hi:[0,1,0]
    v_pk_fma_f32 v[188:189], v[92:93], v[14:15], v[188:189] op_sel:[0,0,0] op_sel_hi:[1,0,1] neg_lo:[1,0,0] neg_hi:[1,0,0]
    v_pk_fma_f32 v[190:191], v[94:95], v[14:15], v[190:191] op_sel:[0,0,0] op_sel_hi:[1,0,1] neg_lo:[1,0,0] neg_hi:[1,0,0]
    v_pk_fma_f32 v[192:193], v[14:15], v[92:93], v[192:193] op_sel:[1,0,0] op_sel_hi:[1,1,1] neg_lo:[0,1,0] neg_hi:[0,1,0]
    v_pk_fma_f32 v[194:195], v[14:15], v[94:95], v[194:195] op_sel:[1,0,0] op_sel_hi:[1,1,1] neg_lo:[0,1,0] neg_hi:[0,1,0]
    v_pk_mul_f32 v[180:181], v[180:181], v[96:97] op_sel:[0,0] op_sel_hi:[1,1]
    v_pk_mul_f32 v[182:183], v[182:183], v[98:99] op_sel:[0,0] op_sel_hi:[1,1]
    v_pk_mul_f32 v[184:185], v[184:185], v[96:97] op_sel:[0,0] op_sel_hi:[1,1]
    v_pk_mul_f32 v[186:187], v[186:187], v[98:99] op_sel:[0,0] op_sel_hi:[1,1]
    v_pk_mul_f32 v[188:189], v[188:189], v[96:97] op_sel:[0,0] op_sel_hi:[1,1]
    v_pk_mul_f32 v[190:191], v[190:191], v[98:99] op_sel:[0,0] op_sel_hi:[1,1]
    v_pk_mul_f32 v[192:193], v[192:193], v[96:97] op_sel:[0,0] op_sel_hi:[1,1]
    v_pk_mul_f32 v[194:195], v[194:195], v[98:99] op_sel:[0,0] op_sel_hi:[1,1]
    v_pk_fma_f32 v[180:181], v[166:167], v[8:9], v[180:181] op_sel:[0,0,0] op_sel_hi:[1,0,1]
    v_pk_fma_f32 v[188:189], v[174:175], v[8:9], v[188:189] op_sel:[0,0,0] op_sel_hi:[1,0,1]
    v_pk_fma_f32 v[184:185], v[170:171], v[70:71], v[184:185] op_sel:[0,0,0] op_sel_hi:[1,0,1]
    v_pk_fma_f32 v[192:193], v[178:179], v[70:71], v[192:193] op_sel:[0,0,0] op_sel_hi:[1,0,1]
    v_pk_fma_f32 v[180:181], v[8:9], v[174:175], v[180:181] op_sel:[1,0,0] op_sel_hi:[1,1,1] neg_lo:[0,1,0] neg_hi:[0,1,0]
    v_pk_fma_f32 v[188:189], v[8:9], v[166:167], v[188:189] op_sel:[1,0,0] op_sel_hi:[1,1,1]
    v_pk_fma_f32 v[184:185], v[70:71], v[178:179], v[184:185] op_sel:[1,0,0] op_sel_hi:[1,1,1] neg_lo:[0,1,0] neg_hi:[0,1,0]
    v_pk_fma_f32 v[192:193], v[70:71], v[170:171], v[192:193] op_sel:[1,0,0] op_sel_hi:[1,1,1]
    v_pk_fma_f32 v[182:183], v[180:181], v[8:9], v[182:183] op_sel:[0,0,0] op_sel_hi:[1,0,1]
    v_pk_fma_f32 v[190:191], v[188:189], v[8:9], v[190:191] op_sel:[0,0,0] op_sel_hi:[1,0,1]
    v_pk_fma_f32 v[186:187], v[184:185], v[70:71], v[186:187] op_sel:[0,0,0] op_sel_hi:[1,0,1]
    v_pk_fma_f32 v[194:195], v[192:193], v[70:71], v[194:195] op_sel:[0,0,0] op_sel_hi:[1,0,1]
    v_pk_fma_f32 v[182:183], v[8:9], v[188:189], v[182:183] op_sel:[1,0,0] op_sel_hi:[1,1,1] neg_lo:[0,1,0] neg_hi:[0,1,0]
    v_pk_fma_f32 v[190:191], v[8:9], v[180:181], v[190:191] op_sel:[1,0,0] op_sel_hi:[1,1,1]
    v_pk_fma_f32 v[186:187], v[70:71], v[192:193], v[186:187] op_sel:[1,0,0] op_sel_hi:[1,1,1] neg_lo:[0,1,0] neg_hi:[0,1,0]
    v_pk_fma_f32 v[194:195], v[70:71], v[184:185], v[194:195] op_sel:[1,0,0] op_sel_hi:[1,1,1]
    s_waitcnt lgkmcnt(4)
    s_nop 0
    v_pk_fma_f32 v[196:197], v[32:33], v[12:13], v[196:197] op_sel:[0,0,0] op_sel_hi:[1,0,1] neg_lo:[1,0,0] neg_hi:[1,0,0]
    v_pk_fma_f32 v[198:199], v[34:35], v[12:13], v[198:199] op_sel:[0,0,0] op_sel_hi:[1,0,1] neg_lo:[1,0,0] neg_hi:[1,0,0]
    v_pk_fma_f32 v[200:201], v[12:13], v[32:33], v[200:201] op_sel:[1,0,0] op_sel_hi:[1,1,1] neg_lo:[0,1,0] neg_hi:[0,1,0]
    v_pk_fma_f32 v[202:203], v[12:13], v[34:35], v[202:203] op_sel:[1,0,0] op_sel_hi:[1,1,1] neg_lo:[0,1,0] neg_hi:[0,1,0]
    v_pk_fma_f32 v[204:205], v[32:33], v[14:15], v[204:205] op_sel:[0,0,0] op_sel_hi:[1,0,1] neg_lo:[1,0,0] neg_hi:[1,0,0]
    v_pk_fma_f32 v[206:207], v[34:35], v[14:15], v[206:207] op_sel:[0,0,0] op_sel_hi:[1,0,1] neg_lo:[1,0,0] neg_hi:[1,0,0]
    v_pk_fma_f32 v[208:209], v[14:15], v[32:33], v[208:209] op_sel:[1,0,0] op_sel_hi:[1,1,1] neg_lo:[0,1,0] neg_hi:[0,1,0]
    v_pk_fma_f32 v[210:211], v[14:15], v[34:35], v[210:211] op_sel:[1,0,0] op_sel_hi:[1,1,1] neg_lo:[0,1,0] neg_hi:[0,1,0]
    v_pk_mul_f32 v[196:197], v[196:197], v[36:37] op_sel:[0,0] op_sel_hi:[1,1]
    v_pk_mul_f32 v[198:199], v[198:199], v[38:39] op_sel:[0,0] op_sel_hi:[1,1]
    v_pk_mul_f32 v[200:201], v[200:201], v[36:37] op_sel:[0,0] op_sel_hi:[1,1]
    v_pk_mul_f32 v[202:203], v[202:203], v[38:39] op_sel:[0,0] op_sel_hi:[1,1]
    v_pk_mul_f32 v[204:205], v[204:205], v[36:37] op_sel:[0,0] op_sel_hi:[1,1]
    v_pk_mul_f32 v[206:207], v[206:207], v[38:39] op_sel:[0,0] op_sel_hi:[1,1]
    v_pk_mul_f32 v[208:209], v[208:209], v[36:37] op_sel:[0,0] op_sel_hi:[1,1]
    v_pk_mul_f32 v[210:211], v[210:211], v[38:39] op_sel:[0,0] op_sel_hi:[1,1]
    v_pk_fma_f32 v[196:197], v[182:183], v[8:9], v[196:197] op_sel:[0,0,0] op_sel_hi:[1,0,1]
    v_pk_fma_f32 v[204:205], v[190:191], v[8:9], v[204:205] op_sel:[0,0,0] op_sel_hi:[1,0,1]
    v_pk_fma_f32 v[200:201], v[186:187], v[70:71], v[200:201] op_sel:[0,0,0] op_sel_hi:[1,0,1]
    v_pk_fma_f32 v[208:209], v[194:195], v[70:71], v[208:209] op_sel:[0,0,0] op_sel_hi:[1,0,1]
    v_pk_fma_f32 v[196:197], v[8:9], v[190:191], v[196:197] op_sel:[1,0,0] op_sel_hi:[1,1,1] neg_lo:[0,1,0] neg_hi:[0,1,0]
    v_pk_fma_f32 v[204:205], v[8:9], v[182:183], v[204:205] op_sel:[1,0,0] op_sel_hi:[1,1,1]
    v_pk_fma_f32 v[200:201], v[70:71], v[194:195], v[200:201] op_sel:[1,0,0] op_sel_hi:[1,1,1] neg_lo:[0,1,0] neg_hi:[0,1,0]
    v_pk_fma_f32 v[208:209], v[70:71], v[186:187], v[208:209] op_sel:[1,0,0] op_sel_hi:[1,1,1]
    v_pk_fma_f32 v[198:199], v[196:197], v[8:9], v[198:199] op_sel:[0,0,0] op_sel_hi:[1,0,1]
    v_pk_fma_f32 v[206:207], v[204:205], v[8:9], v[206:207] op_sel:[0,0,0] op_sel_hi:[1,0,1]
    v_pk_fma_f32 v[202:203], v[200:201], v[70:71], v[202:203] op_sel:[0,0,0] op_sel_hi:[1,0,1]
    v_pk_fma_f32 v[210:211], v[208:209], v[70:71], v[210:211] op_sel:[0,0,0] op_sel_hi:[1,0,1]
    v_pk_fma_f32 v[198:199], v[8:9], v[204:205], v[198:199] op_sel:[1,0,0] op_sel_hi:[1,1,1] neg_lo:[0,1,0] neg_hi:[0,1,0]
    v_pk_fma_f32 v[206:207], v[8:9], v[196:197], v[206:207] op_sel:[1,0,0] op_sel_hi:[1,1,1]
    v_pk_fma_f32 v[202:203], v[70:71], v[208:209], v[202:203] op_sel:[1,0,0] op_sel_hi:[1,1,1] neg_lo:[0,1,0] neg_hi:[0,1,0]
    v_pk_fma_f32 v[210:211], v[70:71], v[200:201], v[210:211] op_sel:[1,0,0] op_sel_hi:[1,1,1]
    s_waitcnt lgkmcnt(2)
    s_nop 0
    v_pk_fma_f32 v[212:213], v[40:41], v[12:13], v[212:213] op_sel:[0,0,0] op_sel_hi:[1,0,1] neg_lo:[1,0,0] neg_hi:[1,0,0]
    v_pk_fma_f32 v[214:215], v[42:43], v[12:13], v[214:215] op_sel:[0,0,0] op_sel_hi:[1,0,1] neg_lo:[1,0,0] neg_hi:[1,0,0]
    v_pk_fma_f32 v[216:217], v[12:13], v[40:41], v[216:217] op_sel:[1,0,0] op_sel_hi:[1,1,1] neg_lo:[0,1,0] neg_hi:[0,1,0]
    v_pk_fma_f32 v[218:219], v[12:13], v[42:43], v[218:219] op_sel:[1,0,0] op_sel_hi:[1,1,1] neg_lo:[0,1,0] neg_hi:[0,1,0]
    v_pk_fma_f32 v[220:221], v[40:41], v[14:15], v[220:221] op_sel:[0,0,0] op_sel_hi:[1,0,1] neg_lo:[1,0,0] neg_hi:[1,0,0]
    v_pk_fma_f32 v[222:223], v[42:43], v[14:15], v[222:223] op_sel:[0,0,0] op_sel_hi:[1,0,1] neg_lo:[1,0,0] neg_hi:[1,0,0]
    v_pk_fma_f32 v[224:225], v[14:15], v[40:41], v[224:225] op_sel:[1,0,0] op_sel_hi:[1,1,1] neg_lo:[0,1,0] neg_hi:[0,1,0]
    v_pk_fma_f32 v[226:227], v[14:15], v[42:43], v[226:227] op_sel:[1,0,0] op_sel_hi:[1,1,1] neg_lo:[0,1,0] neg_hi:[0,1,0]
    v_pk_mul_f32 v[212:213], v[212:213], v[44:45] op_sel:[0,0] op_sel_hi:[1,1]
    v_pk_mul_f32 v[214:215], v[214:215], v[46:47] op_sel:[0,0] op_sel_hi:[1,1]
    v_pk_mul_f32 v[216:217], v[216:217], v[44:45] op_sel:[0,0] op_sel_hi:[1,1]
    v_pk_mul_f32 v[218:219], v[218:219], v[46:47] op_sel:[0,0] op_sel_hi:[1,1]
    v_pk_mul_f32 v[220:221], v[220:221], v[44:45] op_sel:[0,0] op_sel_hi:[1,1]
    v_pk_mul_f32 v[222:223], v[222:223], v[46:47] op_sel:[0,0] op_sel_hi:[1,1]
    v_pk_mul_f32 v[224:225], v[224:225], v[44:45] op_sel:[0,0] op_sel_hi:[1,1]
    v_pk_mul_f32 v[226:227], v[226:227], v[46:47] op_sel:[0,0] op_sel_hi:[1,1]
    v_pk_fma_f32 v[212:213], v[198:199], v[8:9], v[212:213] op_sel:[0,0,0] op_sel_hi:[1,0,1]
    v_pk_fma_f32 v[220:221], v[206:207], v[8:9], v[220:221] op_sel:[0,0,0] op_sel_hi:[1,0,1]
    v_pk_fma_f32 v[216:217], v[202:203], v[70:71], v[216:217] op_sel:[0,0,0] op_sel_hi:[1,0,1]
    v_pk_fma_f32 v[224:225], v[210:211], v[70:71], v[224:225] op_sel:[0,0,0] op_sel_hi:[1,0,1]
    v_pk_fma_f32 v[212:213], v[8:9], v[206:207], v[212:213] op_sel:[1,0,0] op_sel_hi:[1,1,1] neg_lo:[0,1,0] neg_hi:[0,1,0]
    v_pk_fma_f32 v[220:221], v[8:9], v[198:199], v[220:221] op_sel:[1,0,0] op_sel_hi:[1,1,1]
    v_pk_fma_f32 v[216:217], v[70:71], v[210:211], v[216:217] op_sel:[1,0,0] op_sel_hi:[1,1,1] neg_lo:[0,1,0] neg_hi:[0,1,0]
    v_pk_fma_f32 v[224:225], v[70:71], v[202:203], v[224:225] op_sel:[1,0,0] op_sel_hi:[1,1,1]
    v_pk_fma_f32 v[214:215], v[212:213], v[8:9], v[214:215] op_sel:[0,0,0] op_sel_hi:[1,0,1]
    v_pk_fma_f32 v[222:223], v[220:221], v[8:9], v[222:223] op_sel:[0,0,0] op_sel_hi:[1,0,1]
    v_pk_fma_f32 v[218:219], v[216:217], v[70:71], v[218:219] op_sel:[0,0,0] op_sel_hi:[1,0,1]
    v_pk_fma_f32 v[226:227], v[224:225], v[70:71], v[226:227] op_sel:[0,0,0] op_sel_hi:[1,0,1]
    v_pk_fma_f32 v[214:215], v[8:9], v[220:221], v[214:215] op_sel:[1,0,0] op_sel_hi:[1,1,1] neg_lo:[0,1,0] neg_hi:[0,1,0]
    v_pk_fma_f32 v[222:223], v[8:9], v[212:213], v[222:223] op_sel:[1,0,0] op_sel_hi:[1,1,1]
    v_pk_fma_f32 v[218:219], v[70:71], v[224:225], v[218:219] op_sel:[1,0,0] op_sel_hi:[1,1,1] neg_lo:[0,1,0] neg_hi:[0,1,0]
    v_pk_fma_f32 v[226:227], v[70:71], v[216:217], v[226:227] op_sel:[1,0,0] op_sel_hi:[1,1,1]
    s_waitcnt lgkmcnt(0)
    s_nop 0
    v_pk_fma_f32 v[228:229], v[48:49], v[12:13], v[228:229] op_sel:[0,0,0] op_sel_hi:[1,0,1] neg_lo:[1,0,0] neg_hi:[1,0,0]
    v_pk_fma_f32 v[230:231], v[50:51], v[12:13], v[230:231] op_sel:[0,0,0] op_sel_hi:[1,0,1] neg_lo:[1,0,0] neg_hi:[1,0,0]
    v_pk_fma_f32 v[232:233], v[12:13], v[48:49], v[232:233] op_sel:[1,0,0] op_sel_hi:[1,1,1] neg_lo:[0,1,0] neg_hi:[0,1,0]
    v_pk_fma_f32 v[234:235], v[12:13], v[50:51], v[234:235] op_sel:[1,0,0] op_sel_hi:[1,1,1] neg_lo:[0,1,0] neg_hi:[0,1,0]
    v_pk_fma_f32 v[236:237], v[48:49], v[14:15], v[236:237] op_sel:[0,0,0] op_sel_hi:[1,0,1] neg_lo:[1,0,0] neg_hi:[1,0,0]
    v_pk_fma_f32 v[238:239], v[50:51], v[14:15], v[238:239] op_sel:[0,0,0] op_sel_hi:[1,0,1] neg_lo:[1,0,0] neg_hi:[1,0,0]
    v_pk_fma_f32 v[240:241], v[14:15], v[48:49], v[240:241] op_sel:[1,0,0] op_sel_hi:[1,1,1] neg_lo:[0,1,0] neg_hi:[0,1,0]
    v_pk_fma_f32 v[242:243], v[14:15], v[50:51], v[242:243] op_sel:[1,0,0] op_sel_hi:[1,1,1] neg_lo:[0,1,0] neg_hi:[0,1,0]
    v_pk_mul_f32 v[228:229], v[228:229], v[52:53] op_sel:[0,0] op_sel_hi:[1,1]
    v_pk_mul_f32 v[230:231], v[230:231], v[54:55] op_sel:[0,0] op_sel_hi:[1,1]
    v_pk_mul_f32 v[232:233], v[232:233], v[52:53] op_sel:[0,0] op_sel_hi:[1,1]
    v_pk_mul_f32 v[234:235], v[234:235], v[54:55] op_sel:[0,0] op_sel_hi:[1,1]
    v_pk_mul_f32 v[236:237], v[236:237], v[52:53] op_sel:[0,0] op_sel_hi:[1,1]
    v_pk_mul_f32 v[238:239], v[238:239], v[54:55] op_sel:[0,0] op_sel_hi:[1,1]
    v_pk_mul_f32 v[240:241], v[240:241], v[52:53] op_sel:[0,0] op_sel_hi:[1,1]
    v_pk_mul_f32 v[242:243], v[242:243], v[54:55] op_sel:[0,0] op_sel_hi:[1,1]
    v_pk_fma_f32 v[228:229], v[214:215], v[8:9], v[228:229] op_sel:[0,0,0] op_sel_hi:[1,0,1]
    v_pk_fma_f32 v[236:237], v[222:223], v[8:9], v[236:237] op_sel:[0,0,0] op_sel_hi:[1,0,1]
    v_pk_fma_f32 v[232:233], v[218:219], v[70:71], v[232:233] op_sel:[0,0,0] op_sel_hi:[1,0,1]
    v_pk_fma_f32 v[240:241], v[226:227], v[70:71], v[240:241] op_sel:[0,0,0] op_sel_hi:[1,0,1]
    v_pk_fma_f32 v[228:229], v[8:9], v[222:223], v[228:229] op_sel:[1,0,0] op_sel_hi:[1,1,1] neg_lo:[0,1,0] neg_hi:[0,1,0]
    v_pk_fma_f32 v[236:237], v[8:9], v[214:215], v[236:237] op_sel:[1,0,0] op_sel_hi:[1,1,1]
    v_pk_fma_f32 v[232:233], v[70:71], v[226:227], v[232:233] op_sel:[1,0,0] op_sel_hi:[1,1,1] neg_lo:[0,1,0] neg_hi:[0,1,0]
    v_pk_fma_f32 v[240:241], v[70:71], v[218:219], v[240:241] op_sel:[1,0,0] op_sel_hi:[1,1,1]
    v_pk_fma_f32 v[230:231], v[228:229], v[8:9], v[230:231] op_sel:[0,0,0] op_sel_hi:[1,0,1]
    v_pk_fma_f32 v[238:239], v[236:237], v[8:9], v[238:239] op_sel:[0,0,0] op_sel_hi:[1,0,1]
    v_pk_fma_f32 v[234:235], v[232:233], v[70:71], v[234:235] op_sel:[0,0,0] op_sel_hi:[1,0,1]
    v_pk_fma_f32 v[242:243], v[240:241], v[70:71], v[242:243] op_sel:[0,0,0] op_sel_hi:[1,0,1]
    v_pk_fma_f32 v[230:231], v[8:9], v[236:237], v[230:231] op_sel:[1,0,0] op_sel_hi:[1,1,1] neg_lo:[0,1,0] neg_hi:[0,1,0]
    v_pk_fma_f32 v[238:239], v[8:9], v[228:229], v[238:239] op_sel:[1,0,0] op_sel_hi:[1,1,1]
    v_pk_fma_f32 v[234:235], v[70:71], v[240:241], v[234:235] op_sel:[1,0,0] op_sel_hi:[1,1,1] neg_lo:[0,1,0] neg_hi:[0,1,0]
    v_pk_fma_f32 v[242:243], v[70:71], v[232:233], v[242:243] op_sel:[1,0,0] op_sel_hi:[1,1,1]
    s_mul_i32 s8, s22, 9472
    s_add_u32 s8, s8, 122880
    v_lshl_add_u32 v80, v4, 5, s8
    v_lshl_add_u32 v81, v5, 3, v80
    v_fma_f32 v20, v16, v230, v231
    v_fma_f32 v21, v16, v238, v239
    v_fma_f32 v20, -v17, v238, v20
    v_fmac_f32_e64 v21, v17, v230
    ds_write_b64 v81, v[20:21] offset:0
    v_fma_f32 v22, v74, v234, v235
    v_fma_f32 v23, v74, v242, v243
    v_fma_f32 v22, -v75, v242, v22
    v_fmac_f32 v23, v75, v234
    ds_write_b64 v81, v[22:23] offset:512
    v_mov_b32 v82, v230
    v_mov_b32 v83, v238
    v_mov_b32 v84, v234
    v_mov_b32 v85, v242
    s_waitcnt lgkmcnt(0)
    ds_read_b128 v[24:27], v80 offset:0
    ds_read_b128 v[28:31], v80 offset:16
    ds_read_b128 v[32:35], v80 offset:512
    ds_read_b128 v[36:39], v80 offset:528
    v_lshlrev_b32_e64 v3, 4, v3
    v_lshl_add_u32 v81, v5, 8, v3
    s_mul_i32 s9, s18, 10240
    s_add_u32 s9, s9, 0xf30000
    v_mov_b32 v57, v252
    v_mov_b32 v59, v252
    s_mov_b32 vcc_lo, 0xffff0000
    s_mov_b32 vcc_hi, 0
    s_waitcnt lgkmcnt(0)
    v_fma_f32 v40, v18, v24, v26
    v_fma_f32 v41, v18, v25, v27
    v_fma_f32 v40, -v19, v25, v40
    v_fmac_f32_e64 v41, v19, v24
    v_fma_f32 v48, v76, v32, v34
    v_fma_f32 v49, v76, v33, v35
    v_fma_f32 v48, -v77, v33, v48
    v_fmac_f32_e64 v49, v77, v32
    v_fma_f32 v42, v18, v40, v28
    v_fma_f32 v43, v18, v41, v29
    v_fma_f32 v42, -v19, v41, v42
    v_fmac_f32_e64 v43, v19, v40
    v_fma_f32 v50, v76, v48, v36
    v_fma_f32 v51, v76, v49, v37
    v_fma_f32 v50, -v77, v49, v50
    v_fmac_f32_e64 v51, v77, v48
    v_fma_f32 v44, v18, v42, v30
    v_fma_f32 v45, v18, v43, v31
    v_fma_f32 v44, -v19, v43, v44
    v_fmac_f32_e64 v45, v19, v42
    v_fma_f32 v52, v76, v50, v38
    v_fma_f32 v53, v76, v51, v39
    v_fma_f32 v52, -v77, v51, v52
    v_fmac_f32 v53, v77, v50
    v_cndmask_b32 v56, v44, v52, vcc
    v_cndmask_b32 v58, v45, v53, vcc
    s_mov_b32 exec_hi, 0
    buffer_store_dwordx4 v[56:59], v81, s[28:31], s9 offen sc1
    s_mov_b32 exec_hi, -1
    v_cndmask_b32 v86, 0, v24, vcc
    v_cndmask_b32 v87, 0, v25, vcc
    v_cndmask_b32 v88, 0, v32, vcc
    v_cndmask_b32 v89, 0, v33, vcc
    s_mov_b32 vcc_lo, 0
    s_mov_b32 vcc_hi, 0xffff
    v_cndmask_b32 v86, v86, v40, vcc
    v_cndmask_b32 v87, v87, v41, vcc
    v_cndmask_b32 v88, v88, v48, vcc
    v_cndmask_b32 v89, v89, v49, vcc
    s_mov_b32 vcc_lo, 0
    s_mov_b32 vcc_hi, 0xffff0000
    v_cndmask_b32 v86, v86, v42, vcc
    v_cndmask_b32 v87, v87, v43, vcc
    v_cndmask_b32 v88, v88, v50, vcc
    v_cndmask_b32 v89, v89, v51, vcc
    v_mul_u32_u24 v80, 36, v5
    v_cvt_f32_u32 v80, v80
    v_mul_f32 v78, v80, v6
    v_mul_f32 v79, v80, v7
    v_exp_f32 v78, v78
    v_fract_f32 v79, v79
    v_cos_f32 v90, v79
    v_sin_f32 v91, v79
    s_nop 0
    v_mul_f32 v90, v90, v78
    v_mul_f32 v91, v91, v78
    v_mul_f32 v78, v80, v68
    v_mul_f32 v79, v80, v69
    v_exp_f32 v78, v78
    v_fract_f32 v79, v79
    v_cos_f32 v92, v79
    v_sin_f32 v93, v79
    s_nop 0
    v_mul_f32 v92, v92, v78
    v_mul_f32_e64 v93, v93, v78
    s_mov_b32 s11, 0xf30000
    v_mov_b32 v80, 0x7f000000
    v_add_u32 v81, 0, v5
    v_mul_u32_u24 v12, 10240, v81
    v_add_u32 v12, v12, v3
    v_cmp_gt_u32 vcc, s18, v81
    v_sub_u32 v81, s18, v81
    v_add_u32 v81, -1, v81
    v_cndmask_b32 v12, v80, v12, vcc
    v_cndmask_b32 v94, 0, v252, vcc
    v_max_i32 v81, 0, v81
    v_mul_u32_u24 v81, 144, v81
    v_cvt_f32_u32 v244, v81
    v_add_u32 v81, 4, v5
    v_mul_u32_u24 v13, 10240, v81
    v_add_u32 v13, v13, v3
    v_cmp_gt_u32 vcc, s18, v81
    v_sub_u32 v81, s18, v81
    v_add_u32 v81, -1, v81
    v_cndmask_b32 v13, v80, v13, vcc
    v_cndmask_b32 v95, 0, v252, vcc
    v_max_i32 v81, 0, v81
    v_mul_u32_u24 v81, 144, v81
    v_cvt_f32_u32 v245, v81
    v_add_u32 v81, 8, v5
    v_mul_u32_u24 v14, 10240, v81
    v_add_u32 v14, v14, v3
    v_cmp_gt_u32 vcc, s18, v81
    v_sub_u32 v81, s18, v81
    v_add_u32 v81, -1, v81
    v_cndmask_b32 v14, v80, v14, vcc
    v_cndmask_b32 v96, 0, v252, vcc
    v_max_i32 v81, 0, v81
    v_mul_u32_u24 v81, 144, v81
    v_cvt_f32_u32 v246, v81
    v_add_u32 v81, 12, v5
    v_mul_u32_u24 v15, 10240, v81
    v_add_u32 v15, v15, v3
    v_cmp_gt_u32 vcc, s18, v81
    v_sub_u32 v81, s18, v81
    v_add_u32 v81, -1, v81
    v_cndmask_b32 v15, v80, v15, vcc
    v_cndmask_b32 v97, 0, v252, vcc
    v_max_i32 v81, 0, v81
    v_mul_u32_u24 v81, 144, v81
    v_cvt_f32_u32 v247, v81
    v_mul_f32 v78, v244, v6
    v_mul_f32 v79, v244, v7
    v_exp_f32 v78, v78
    v_fract_f32 v79, v79
    v_cos_f32 v52, v79
    v_sin_f32 v53, v79
    s_nop 0
    v_mul_f32 v52, v52, v78
    v_mul_f32 v53, v53, v78
    v_mul_f32 v78, v245, v6
    v_mul_f32 v79, v245, v7
    v_exp_f32 v78, v78
    v_fract_f32 v79, v79
    v_cos_f32 v54, v79
    v_sin_f32 v55, v79
    s_nop 0
    v_mul_f32 v54, v54, v78
    v_mul_f32 v55, v55, v78
    v_mul_f32 v78, v246, v6
    v_mul_f32 v79, v246, v7
    v_exp_f32 v78, v78
    v_fract_f32 v79, v79
    v_cos_f32 v56, v79
    v_sin_f32 v57, v79
    s_nop 0
    v_mul_f32 v56, v56, v78
    v_mul_f32 v57, v57, v78
    v_mul_f32 v78, v247, v6
    v_mul_f32 v79, v247, v7
    v_exp_f32 v78, v78
    v_fract_f32 v79, v79
    v_cos_f32 v58, v79
    v_sin_f32 v59, v79
    s_nop 0
    v_mul_f32 v58, v58, v78
    v_mul_f32 v59, v59, v78
    v_mul_f32 v78, v244, v68
    v_mul_f32 v79, v244, v69
    v_exp_f32 v78, v78
    v_fract_f32 v79, v79
    v_cos_f32 v60, v79
    v_sin_f32 v61, v79
    s_nop 0
    v_mul_f32 v60, v60, v78
    v_mul_f32 v61, v61, v78
    v_mul_f32 v78, v245, v68
    v_mul_f32 v79, v245, v69
    v_exp_f32 v78, v78
    v_fract_f32 v79, v79
    v_cos_f32 v62, v79
    v_sin_f32 v63, v79
    s_nop 0
    v_mul_f32 v62, v62, v78
    v_mul_f32 v63, v63, v78
    v_mul_f32 v78, v246, v68
    v_mul_f32 v79, v246, v69
    v_exp_f32 v78, v78
    v_fract_f32 v79, v79
    v_cos_f32 v64, v79
    v_sin_f32 v65, v79
    s_nop 0
    v_mul_f32 v64, v64, v78
    v_mul_f32 v65, v65, v78
    v_mul_f32 v78, v247, v68
    v_mul_f32 v79, v247, v69
    v_exp_f32 v78, v78
    v_fract_f32 v79, v79
    v_cos_f32 v66, v79
    v_sin_f32 v67, v79
    s_nop 0
    v_mul_f32 v66, v66, v78
    v_mul_f32 v67, v67, v78
    v_pk_mul_f32 v[248:249], v[10:11], v[108:109] op_sel:[1,0] op_sel_hi:[1,1]
    v_pk_mul_f32 v[108:109], v[108:109], v[10:11] op_sel:[0,0] op_sel_hi:[1,0] neg_lo:[1,0] neg_hi:[1,0]
    v_pk_mul_f32 v[250:251], v[10:11], v[110:111] op_sel:[1,0] op_sel_hi:[1,1]
    v_pk_mul_f32 v[110:111], v[110:111], v[10:11] op_sel:[0,0] op_sel_hi:[1,0] neg_lo:[1,0] neg_hi:[1,0]
    v_pk_fma_f32 v[108:109], v[10:11], v[100:101], v[108:109] op_sel:[1,0,0] op_sel_hi:[1,1,1] neg_lo:[0,1,0] neg_hi:[0,1,0]
    v_pk_fma_f32 v[100:101], v[100:101], v[10:11], v[248:249] op_sel:[0,0,0] op_sel_hi:[1,0,1] neg_lo:[0,0,1] neg_hi:[0,0,1]
    v_pk_fma_f32 v[110:111], v[10:11], v[102:103], v[110:111] op_sel:[1,0,0] op_sel_hi:[1,1,1] neg_lo:[0,1,0] neg_hi:[0,1,0]
    v_pk_fma_f32 v[102:103], v[102:103], v[10:11], v[250:251] op_sel:[0,0,0] op_sel_hi:[1,0,1] neg_lo:[0,0,1] neg_hi:[0,0,1]
    v_pk_mul_f32 v[248:249], v[72:73], v[112:113] op_sel:[1,0] op_sel_hi:[1,1]
    v_pk_mul_f32 v[112:113], v[112:113], v[72:73] op_sel:[0,0] op_sel_hi:[1,0] neg_lo:[1,0] neg_hi:[1,0]
    v_pk_mul_f32 v[250:251], v[72:73], v[114:115] op_sel:[1,0] op_sel_hi:[1,1]
    v_pk_mul_f32 v[114:115], v[114:115], v[72:73] op_sel:[0,0] op_sel_hi:[1,0] neg_lo:[1,0] neg_hi:[1,0]
    v_pk_fma_f32 v[112:113], v[72:73], v[104:105], v[112:113] op_sel:[1,0,0] op_sel_hi:[1,1,1] neg_lo:[0,1,0] neg_hi:[0,1,0]
    v_pk_fma_f32 v[104:105], v[104:105], v[72:73], v[248:249] op_sel:[0,0,0] op_sel_hi:[1,0,1] neg_lo:[0,0,1] neg_hi:[0,0,1]
    v_pk_fma_f32 v[114:115], v[72:73], v[106:107], v[114:115] op_sel:[1,0,0] op_sel_hi:[1,1,1] neg_lo:[0,1,0] neg_hi:[0,1,0]
    v_pk_fma_f32 v[106:107], v[106:107], v[72:73], v[250:251] op_sel:[0,0,0] op_sel_hi:[1,0,1] neg_lo:[0,0,1] neg_hi:[0,0,1]
    v_pk_mul_f32 v[248:249], v[10:11], v[124:125] op_sel:[1,0] op_sel_hi:[1,1]
    v_pk_mul_f32 v[124:125], v[124:125], v[10:11] op_sel:[0,0] op_sel_hi:[1,0] neg_lo:[1,0] neg_hi:[1,0]
    v_pk_mul_f32 v[250:251], v[10:11], v[126:127] op_sel:[1,0] op_sel_hi:[1,1]
    v_pk_mul_f32 v[126:127], v[126:127], v[10:11] op_sel:[0,0] op_sel_hi:[1,0] neg_lo:[1,0] neg_hi:[1,0]
    v_pk_fma_f32 v[124:125], v[10:11], v[116:117], v[124:125] op_sel:[1,0,0] op_sel_hi:[1,1,1] neg_lo:[0,1,0] neg_hi:[0,1,0]
    v_pk_fma_f32 v[116:117], v[116:117], v[10:11], v[248:249] op_sel:[0,0,0] op_sel_hi:[1,0,1] neg_lo:[0,0,1] neg_hi:[0,0,1]
    v_pk_fma_f32 v[126:127], v[10:11], v[118:119], v[126:127] op_sel:[1,0,0] op_sel_hi:[1,1,1] neg_lo:[0,1,0] neg_hi:[0,1,0]
    v_pk_fma_f32 v[118:119], v[118:119], v[10:11], v[250:251] op_sel:[0,0,0] op_sel_hi:[1,0,1] neg_lo:[0,0,1] neg_hi:[0,0,1]
    v_pk_mul_f32 v[248:249], v[72:73], v[128:129] op_sel:[1,0] op_sel_hi:[1,1]
    v_pk_mul_f32 v[128:129], v[128:129], v[72:73] op_sel:[0,0] op_sel_hi:[1,0] neg_lo:[1,0] neg_hi:[1,0]
    v_pk_mul_f32 v[250:251], v[72:73], v[130:131] op_sel:[1,0] op_sel_hi:[1,1]
    v_pk_mul_f32 v[130:131], v[130:131], v[72:73] op_sel:[0,0] op_sel_hi:[1,0] neg_lo:[1,0] neg_hi:[1,0]
    v_pk_fma_f32 v[128:129], v[72:73], v[120:121], v[128:129] op_sel:[1,0,0] op_sel_hi:[1,1,1] neg_lo:[0,1,0] neg_hi:[0,1,0]
    v_pk_fma_f32 v[120:121], v[120:121], v[72:73], v[248:249] op_sel:[0,0,0] op_sel_hi:[1,0,1] neg_lo:[0,0,1] neg_hi:[0,0,1]
    v_pk_fma_f32 v[130:131], v[72:73], v[122:123], v[130:131] op_sel:[1,0,0] op_sel_hi:[1,1,1] neg_lo:[0,1,0] neg_hi:[0,1,0]
    v_pk_fma_f32 v[122:123], v[122:123], v[72:73], v[250:251] op_sel:[0,0,0] op_sel_hi:[1,0,1] neg_lo:[0,0,1] neg_hi:[0,0,1]
    v_pk_mul_f32 v[248:249], v[10:11], v[140:141] op_sel:[1,0] op_sel_hi:[1,1]
    v_pk_mul_f32 v[140:141], v[140:141], v[10:11] op_sel:[0,0] op_sel_hi:[1,0] neg_lo:[1,0] neg_hi:[1,0]
    v_pk_mul_f32 v[250:251], v[10:11], v[142:143] op_sel:[1,0] op_sel_hi:[1,1]
    v_pk_mul_f32 v[142:143], v[142:143], v[10:11] op_sel:[0,0] op_sel_hi:[1,0] neg_lo:[1,0] neg_hi:[1,0]
    v_pk_fma_f32 v[140:141], v[10:11], v[132:133], v[140:141] op_sel:[1,0,0] op_sel_hi:[1,1,1] neg_lo:[0,1,0] neg_hi:[0,1,0]
    v_pk_fma_f32 v[132:133], v[132:133], v[10:11], v[248:249] op_sel:[0,0,0] op_sel_hi:[1,0,1] neg_lo:[0,0,1] neg_hi:[0,0,1]
    v_pk_fma_f32 v[142:143], v[10:11], v[134:135], v[142:143] op_sel:[1,0,0] op_sel_hi:[1,1,1] neg_lo:[0,1,0] neg_hi:[0,1,0]
    v_pk_fma_f32 v[134:135], v[134:135], v[10:11], v[250:251] op_sel:[0,0,0] op_sel_hi:[1,0,1] neg_lo:[0,0,1] neg_hi:[0,0,1]
    v_pk_mul_f32 v[248:249], v[72:73], v[144:145] op_sel:[1,0] op_sel_hi:[1,1]
    v_pk_mul_f32 v[144:145], v[144:145], v[72:73] op_sel:[0,0] op_sel_hi:[1,0] neg_lo:[1,0] neg_hi:[1,0]
    v_pk_mul_f32 v[250:251], v[72:73], v[146:147] op_sel:[1,0] op_sel_hi:[1,1]
    v_pk_mul_f32 v[146:147], v[146:147], v[72:73] op_sel:[0,0] op_sel_hi:[1,0] neg_lo:[1,0] neg_hi:[1,0]
    v_pk_fma_f32 v[144:145], v[72:73], v[136:137], v[144:145] op_sel:[1,0,0] op_sel_hi:[1,1,1] neg_lo:[0,1,0] neg_hi:[0,1,0]
    v_pk_fma_f32 v[136:137], v[136:137], v[72:73], v[248:249] op_sel:[0,0,0] op_sel_hi:[1,0,1] neg_lo:[0,0,1] neg_hi:[0,0,1]
    v_pk_fma_f32 v[146:147], v[72:73], v[138:139], v[146:147] op_sel:[1,0,0] op_sel_hi:[1,1,1] neg_lo:[0,1,0] neg_hi:[0,1,0]
    v_pk_fma_f32 v[138:139], v[138:139], v[72:73], v[250:251] op_sel:[0,0,0] op_sel_hi:[1,0,1] neg_lo:[0,0,1] neg_hi:[0,0,1]
    buffer_load_dwordx4 v[20:23], v12, s[28:31], s11 offen offset:0 sc1
    buffer_load_dwordx4 v[24:27], v13, s[28:31], s11 offen offset:0 sc1
    buffer_load_dwordx4 v[28:31], v14, s[28:31], s11 offen offset:0 sc1
    buffer_load_dwordx4 v[32:35], v15, s[28:31], s11 offen offset:0 sc1
    buffer_load_dwordx4 v[36:39], v12, s[28:31], s11 offen offset:256 sc1
    buffer_load_dwordx4 v[40:43], v13, s[28:31], s11 offen offset:256 sc1
    buffer_load_dwordx4 v[44:47], v14, s[28:31], s11 offen offset:256 sc1
    buffer_load_dwordx4 v[48:51], v15, s[28:31], s11 offen offset:256 sc1
    v_pk_mul_f32 v[248:249], v[10:11], v[156:157] op_sel:[1,0] op_sel_hi:[1,1]
    v_pk_mul_f32 v[156:157], v[156:157], v[10:11] op_sel:[0,0] op_sel_hi:[1,0] neg_lo:[1,0] neg_hi:[1,0]
    v_pk_mul_f32 v[250:251], v[10:11], v[158:159] op_sel:[1,0] op_sel_hi:[1,1]
    v_pk_mul_f32 v[158:159], v[158:159], v[10:11] op_sel:[0,0] op_sel_hi:[1,0] neg_lo:[1,0] neg_hi:[1,0]
    v_pk_fma_f32 v[156:157], v[10:11], v[148:149], v[156:157] op_sel:[1,0,0] op_sel_hi:[1,1,1] neg_lo:[0,1,0] neg_hi:[0,1,0]
    v_pk_fma_f32 v[148:149], v[148:149], v[10:11], v[248:249] op_sel:[0,0,0] op_sel_hi:[1,0,1] neg_lo:[0,0,1] neg_hi:[0,0,1]
    v_pk_fma_f32 v[158:159], v[10:11], v[150:151], v[158:159] op_sel:[1,0,0] op_sel_hi:[1,1,1] neg_lo:[0,1,0] neg_hi:[0,1,0]
    v_pk_fma_f32 v[150:151], v[150:151], v[10:11], v[250:251] op_sel:[0,0,0] op_sel_hi:[1,0,1] neg_lo:[0,0,1] neg_hi:[0,0,1]
    v_pk_mul_f32 v[248:249], v[72:73], v[160:161] op_sel:[1,0] op_sel_hi:[1,1]
    v_pk_mul_f32 v[160:161], v[160:161], v[72:73] op_sel:[0,0] op_sel_hi:[1,0] neg_lo:[1,0] neg_hi:[1,0]
    v_pk_mul_f32 v[250:251], v[72:73], v[162:163] op_sel:[1,0] op_sel_hi:[1,1]
    v_pk_mul_f32 v[162:163], v[162:163], v[72:73] op_sel:[0,0] op_sel_hi:[1,0] neg_lo:[1,0] neg_hi:[1,0]
    v_pk_fma_f32 v[160:161], v[72:73], v[152:153], v[160:161] op_sel:[1,0,0] op_sel_hi:[1,1,1] neg_lo:[0,1,0] neg_hi:[0,1,0]
    v_pk_fma_f32 v[152:153], v[152:153], v[72:73], v[248:249] op_sel:[0,0,0] op_sel_hi:[1,0,1] neg_lo:[0,0,1] neg_hi:[0,0,1]
    v_pk_fma_f32 v[162:163], v[72:73], v[154:155], v[162:163] op_sel:[1,0,0] op_sel_hi:[1,1,1] neg_lo:[0,1,0] neg_hi:[0,1,0]
    v_pk_fma_f32 v[154:155], v[154:155], v[72:73], v[250:251] op_sel:[0,0,0] op_sel_hi:[1,0,1] neg_lo:[0,0,1] neg_hi:[0,0,1]
    v_pk_mul_f32 v[248:249], v[10:11], v[172:173] op_sel:[1,0] op_sel_hi:[1,1]
    v_pk_mul_f32 v[172:173], v[172:173], v[10:11] op_sel:[0,0] op_sel_hi:[1,0] neg_lo:[1,0] neg_hi:[1,0]
    v_pk_mul_f32 v[250:251], v[10:11], v[174:175] op_sel:[1,0] op_sel_hi:[1,1]
    v_pk_mul_f32 v[174:175], v[174:175], v[10:11] op_sel:[0,0] op_sel_hi:[1,0] neg_lo:[1,0] neg_hi:[1,0]
    v_pk_fma_f32 v[172:173], v[10:11], v[164:165], v[172:173] op_sel:[1,0,0] op_sel_hi:[1,1,1] neg_lo:[0,1,0] neg_hi:[0,1,0]
    v_pk_fma_f32 v[164:165], v[164:165], v[10:11], v[248:249] op_sel:[0,0,0] op_sel_hi:[1,0,1] neg_lo:[0,0,1] neg_hi:[0,0,1]
    v_pk_fma_f32 v[174:175], v[10:11], v[166:167], v[174:175] op_sel:[1,0,0] op_sel_hi:[1,1,1] neg_lo:[0,1,0] neg_hi:[0,1,0]
    v_pk_fma_f32 v[166:167], v[166:167], v[10:11], v[250:251] op_sel:[0,0,0] op_sel_hi:[1,0,1] neg_lo:[0,0,1] neg_hi:[0,0,1]
    v_pk_mul_f32 v[248:249], v[72:73], v[176:177] op_sel:[1,0] op_sel_hi:[1,1]
    v_pk_mul_f32 v[176:177], v[176:177], v[72:73] op_sel:[0,0] op_sel_hi:[1,0] neg_lo:[1,0] neg_hi:[1,0]
    v_pk_mul_f32 v[250:251], v[72:73], v[178:179] op_sel:[1,0] op_sel_hi:[1,1]
    v_pk_mul_f32 v[178:179], v[178:179], v[72:73] op_sel:[0,0] op_sel_hi:[1,0] neg_lo:[1,0] neg_hi:[1,0]
    v_pk_fma_f32 v[176:177], v[72:73], v[168:169], v[176:177] op_sel:[1,0,0] op_sel_hi:[1,1,1] neg_lo:[0,1,0] neg_hi:[0,1,0]
    v_pk_fma_f32 v[168:169], v[168:169], v[72:73], v[248:249] op_sel:[0,0,0] op_sel_hi:[1,0,1] neg_lo:[0,0,1] neg_hi:[0,0,1]
    v_pk_fma_f32 v[178:179], v[72:73], v[170:171], v[178:179] op_sel:[1,0,0] op_sel_hi:[1,1,1] neg_lo:[0,1,0] neg_hi:[0,1,0]
    v_pk_fma_f32 v[170:171], v[170:171], v[72:73], v[250:251] op_sel:[0,0,0] op_sel_hi:[1,0,1] neg_lo:[0,0,1] neg_hi:[0,0,1]
    v_pk_mul_f32 v[248:249], v[10:11], v[188:189] op_sel:[1,0] op_sel_hi:[1,1]
    v_pk_mul_f32 v[188:189], v[188:189], v[10:11] op_sel:[0,0] op_sel_hi:[1,0] neg_lo:[1,0] neg_hi:[1,0]
    v_pk_mul_f32 v[250:251], v[10:11], v[190:191] op_sel:[1,0] op_sel_hi:[1,1]
    v_pk_mul_f32 v[190:191], v[190:191], v[10:11] op_sel:[0,0] op_sel_hi:[1,0] neg_lo:[1,0] neg_hi:[1,0]
    v_pk_fma_f32 v[188:189], v[10:11], v[180:181], v[188:189] op_sel:[1,0,0] op_sel_hi:[1,1,1] neg_lo:[0,1,0] neg_hi:[0,1,0]
    v_pk_fma_f32 v[180:181], v[180:181], v[10:11], v[248:249] op_sel:[0,0,0] op_sel_hi:[1,0,1] neg_lo:[0,0,1] neg_hi:[0,0,1]
    v_pk_fma_f32 v[190:191], v[10:11], v[182:183], v[190:191] op_sel:[1,0,0] op_sel_hi:[1,1,1] neg_lo:[0,1,0] neg_hi:[0,1,0]
    v_pk_fma_f32 v[182:183], v[182:183], v[10:11], v[250:251] op_sel:[0,0,0] op_sel_hi:[1,0,1] neg_lo:[0,0,1] neg_hi:[0,0,1]
    v_pk_mul_f32 v[248:249], v[72:73], v[192:193] op_sel:[1,0] op_sel_hi:[1,1]
    v_pk_mul_f32 v[192:193], v[192:193], v[72:73] op_sel:[0,0] op_sel_hi:[1,0] neg_lo:[1,0] neg_hi:[1,0]
    v_pk_mul_f32 v[250:251], v[72:73], v[194:195] op_sel:[1,0] op_sel_hi:[1,1]
    v_pk_mul_f32 v[194:195], v[194:195], v[72:73] op_sel:[0,0] op_sel_hi:[1,0] neg_lo:[1,0] neg_hi:[1,0]
    v_pk_fma_f32 v[192:193], v[72:73], v[184:185], v[192:193] op_sel:[1,0,0] op_sel_hi:[1,1,1] neg_lo:[0,1,0] neg_hi:[0,1,0]
    v_pk_fma_f32 v[184:185], v[184:185], v[72:73], v[248:249] op_sel:[0,0,0] op_sel_hi:[1,0,1] neg_lo:[0,0,1] neg_hi:[0,0,1]
    v_pk_fma_f32 v[194:195], v[72:73], v[186:187], v[194:195] op_sel:[1,0,0] op_sel_hi:[1,1,1] neg_lo:[0,1,0] neg_hi:[0,1,0]
    v_pk_fma_f32 v[186:187], v[186:187], v[72:73], v[250:251] op_sel:[0,0,0] op_sel_hi:[1,0,1] neg_lo:[0,0,1] neg_hi:[0,0,1]
    v_pk_mul_f32 v[248:249], v[10:11], v[204:205] op_sel:[1,0] op_sel_hi:[1,1]
    v_pk_mul_f32 v[204:205], v[204:205], v[10:11] op_sel:[0,0] op_sel_hi:[1,0] neg_lo:[1,0] neg_hi:[1,0]
    v_pk_mul_f32 v[250:251], v[10:11], v[206:207] op_sel:[1,0] op_sel_hi:[1,1]
    v_pk_mul_f32 v[206:207], v[206:207], v[10:11] op_sel:[0,0] op_sel_hi:[1,0] neg_lo:[1,0] neg_hi:[1,0]
    v_pk_fma_f32 v[204:205], v[10:11], v[196:197], v[204:205] op_sel:[1,0,0] op_sel_hi:[1,1,1] neg_lo:[0,1,0] neg_hi:[0,1,0]
    v_pk_fma_f32 v[196:197], v[196:197], v[10:11], v[248:249] op_sel:[0,0,0] op_sel_hi:[1,0,1] neg_lo:[0,0,1] neg_hi:[0,0,1]
    v_pk_fma_f32 v[206:207], v[10:11], v[198:199], v[206:207] op_sel:[1,0,0] op_sel_hi:[1,1,1] neg_lo:[0,1,0] neg_hi:[0,1,0]
    v_pk_fma_f32 v[198:199], v[198:199], v[10:11], v[250:251] op_sel:[0,0,0] op_sel_hi:[1,0,1] neg_lo:[0,0,1] neg_hi:[0,0,1]
    v_pk_mul_f32 v[248:249], v[72:73], v[208:209] op_sel:[1,0] op_sel_hi:[1,1]
    v_pk_mul_f32 v[208:209], v[208:209], v[72:73] op_sel:[0,0] op_sel_hi:[1,0] neg_lo:[1,0] neg_hi:[1,0]
    v_pk_mul_f32 v[250:251], v[72:73], v[210:211] op_sel:[1,0] op_sel_hi:[1,1]
    v_pk_mul_f32 v[210:211], v[210:211], v[72:73] op_sel:[0,0] op_sel_hi:[1,0] neg_lo:[1,0] neg_hi:[1,0]
    v_pk_fma_f32 v[208:209], v[72:73], v[200:201], v[208:209] op_sel:[1,0,0] op_sel_hi:[1,1,1] neg_lo:[0,1,0] neg_hi:[0,1,0]
    v_pk_fma_f32 v[200:201], v[200:201], v[72:73], v[248:249] op_sel:[0,0,0] op_sel_hi:[1,0,1] neg_lo:[0,0,1] neg_hi:[0,0,1]
    v_pk_fma_f32 v[210:211], v[72:73], v[202:203], v[210:211] op_sel:[1,0,0] op_sel_hi:[1,1,1] neg_lo:[0,1,0] neg_hi:[0,1,0]
    v_pk_fma_f32 v[202:203], v[202:203], v[72:73], v[250:251] op_sel:[0,0,0] op_sel_hi:[1,0,1] neg_lo:[0,0,1] neg_hi:[0,0,1]
    v_pk_mul_f32 v[248:249], v[10:11], v[220:221] op_sel:[1,0] op_sel_hi:[1,1]
    v_pk_mul_f32 v[220:221], v[220:221], v[10:11] op_sel:[0,0] op_sel_hi:[1,0] neg_lo:[1,0] neg_hi:[1,0]
    v_pk_mul_f32 v[250:251], v[10:11], v[222:223] op_sel:[1,0] op_sel_hi:[1,1]
    v_pk_mul_f32 v[222:223], v[222:223], v[10:11] op_sel:[0,0] op_sel_hi:[1,0] neg_lo:[1,0] neg_hi:[1,0]
    v_pk_fma_f32 v[220:221], v[10:11], v[212:213], v[220:221] op_sel:[1,0,0] op_sel_hi:[1,1,1] neg_lo:[0,1,0] neg_hi:[0,1,0]
    v_pk_fma_f32 v[212:213], v[212:213], v[10:11], v[248:249] op_sel:[0,0,0] op_sel_hi:[1,0,1] neg_lo:[0,0,1] neg_hi:[0,0,1]
    v_pk_fma_f32 v[222:223], v[10:11], v[214:215], v[222:223] op_sel:[1,0,0] op_sel_hi:[1,1,1] neg_lo:[0,1,0] neg_hi:[0,1,0]
    v_pk_fma_f32 v[214:215], v[214:215], v[10:11], v[250:251] op_sel:[0,0,0] op_sel_hi:[1,0,1] neg_lo:[0,0,1] neg_hi:[0,0,1]
    v_pk_mul_f32 v[248:249], v[72:73], v[224:225] op_sel:[1,0] op_sel_hi:[1,1]
    v_pk_mul_f32 v[224:225], v[224:225], v[72:73] op_sel:[0,0] op_sel_hi:[1,0] neg_lo:[1,0] neg_hi:[1,0]
    v_pk_mul_f32 v[250:251], v[72:73], v[226:227] op_sel:[1,0] op_sel_hi:[1,1]
    v_pk_mul_f32 v[226:227], v[226:227], v[72:73] op_sel:[0,0] op_sel_hi:[1,0] neg_lo:[1,0] neg_hi:[1,0]
    v_pk_fma_f32 v[224:225], v[72:73], v[216:217], v[224:225] op_sel:[1,0,0] op_sel_hi:[1,1,1] neg_lo:[0,1,0] neg_hi:[0,1,0]
    v_pk_fma_f32 v[216:217], v[216:217], v[72:73], v[248:249] op_sel:[0,0,0] op_sel_hi:[1,0,1] neg_lo:[0,0,1] neg_hi:[0,0,1]
    v_pk_fma_f32 v[226:227], v[72:73], v[218:219], v[226:227] op_sel:[1,0,0] op_sel_hi:[1,1,1] neg_lo:[0,1,0] neg_hi:[0,1,0]
    v_pk_fma_f32 v[218:219], v[218:219], v[72:73], v[250:251] op_sel:[0,0,0] op_sel_hi:[1,0,1] neg_lo:[0,0,1] neg_hi:[0,0,1]
    v_pk_mul_f32 v[248:249], v[10:11], v[236:237] op_sel:[1,0] op_sel_hi:[1,1]
    v_pk_mul_f32 v[236:237], v[236:237], v[10:11] op_sel:[0,0] op_sel_hi:[1,0] neg_lo:[1,0] neg_hi:[1,0]
    v_pk_mul_f32 v[250:251], v[10:11], v[238:239] op_sel:[1,0] op_sel_hi:[1,1]
    v_pk_mul_f32 v[238:239], v[238:239], v[10:11] op_sel:[0,0] op_sel_hi:[1,0] neg_lo:[1,0] neg_hi:[1,0]
    v_pk_fma_f32 v[236:237], v[10:11], v[228:229], v[236:237] op_sel:[1,0,0] op_sel_hi:[1,1,1] neg_lo:[0,1,0] neg_hi:[0,1,0]
    v_pk_fma_f32 v[228:229], v[228:229], v[10:11], v[248:249] op_sel:[0,0,0] op_sel_hi:[1,0,1] neg_lo:[0,0,1] neg_hi:[0,0,1]
    v_pk_fma_f32 v[238:239], v[10:11], v[230:231], v[238:239] op_sel:[1,0,0] op_sel_hi:[1,1,1] neg_lo:[0,1,0] neg_hi:[0,1,0]
    v_pk_fma_f32 v[230:231], v[230:231], v[10:11], v[250:251] op_sel:[0,0,0] op_sel_hi:[1,0,1] neg_lo:[0,0,1] neg_hi:[0,0,1]
    v_pk_mul_f32 v[248:249], v[72:73], v[240:241] op_sel:[1,0] op_sel_hi:[1,1]
    v_pk_mul_f32 v[240:241], v[240:241], v[72:73] op_sel:[0,0] op_sel_hi:[1,0] neg_lo:[1,0] neg_hi:[1,0]
    v_pk_mul_f32 v[250:251], v[72:73], v[242:243] op_sel:[1,0] op_sel_hi:[1,1]
    v_pk_mul_f32 v[242:243], v[242:243], v[72:73] op_sel:[0,0] op_sel_hi:[1,0] neg_lo:[1,0] neg_hi:[1,0]
    v_pk_fma_f32 v[240:241], v[72:73], v[232:233], v[240:241] op_sel:[1,0,0] op_sel_hi:[1,1,1] neg_lo:[0,1,0] neg_hi:[0,1,0]
    v_pk_fma_f32 v[232:233], v[232:233], v[72:73], v[248:249] op_sel:[0,0,0] op_sel_hi:[1,0,1] neg_lo:[0,0,1] neg_hi:[0,0,1]
    v_pk_fma_f32 v[242:243], v[72:73], v[234:235], v[242:243] op_sel:[1,0,0] op_sel_hi:[1,1,1] neg_lo:[0,1,0] neg_hi:[0,1,0]
    v_pk_fma_f32 v[234:235], v[234:235], v[72:73], v[250:251] op_sel:[0,0,0] op_sel_hi:[1,0,1] neg_lo:[0,0,1] neg_hi:[0,0,1]
    v_mul_f32 v6, v10, v8
    v_mul_f32 v7, v10, v9
    v_fma_f32 v6, -v11, v9, v6
    v_fmac_f32 v7, v11, v8
    v_mul_f32 v78, v8, v8
    v_mul_f32 v79, v8, v9
    v_fma_f32 v78, -v9, v9, v78
    v_fmac_f32 v79, v9, v8
    v_mul_f32 v18, v6, v8
    v_mul_f32 v19, v6, v9
    v_fma_f32 v18, -v7, v9, v18
    v_fmac_f32 v19, v7, v8
    v_mul_f32 v246, v78, v8
    v_mul_f32 v247, v78, v9
    v_fma_f32 v246, -v79, v9, v246
    v_fmac_f32 v247, v79, v8
    v_mul_f32 v244, v6, v78
    v_mul_f32 v245, v6, v79
    v_fma_f32 v244, -v7, v79, v244
    v_fmac_f32 v245, v7, v78
    v_mul_f32 v68, v72, v70
    v_mul_f32 v69, v72, v71
    v_fma_f32 v68, -v73, v71, v68
    v_fmac_f32 v69, v73, v70
    v_mul_f32 v78, v70, v70
    v_mul_f32 v79, v70, v71
    v_fma_f32 v78, -v71, v71, v78
    v_fmac_f32 v79, v71, v70
    v_mul_f32 v76, v68, v70
    v_mul_f32 v77, v68, v71
    v_fma_f32 v76, -v69, v71, v76
    v_fmac_f32 v77, v69, v70
    v_mul_f32 v250, v78, v70
    v_mul_f32 v251, v78, v71
    v_fma_f32 v250, -v79, v71, v250
    v_fmac_f32 v251, v79, v70
    v_mul_f32 v248, v68, v78
    v_mul_f32 v249, v68, v79
    v_fma_f32 v248, -v69, v79, v248
    v_fmac_f32 v249, v69, v78
    v_mul_u32_u24 v80, 296, v4
    v_mul_u32_u24 v81, 72, v5
    v_add3_u32 v98, v80, v81, s8
    v_lshrrev_b32_e64 v80, 2, v4
    v_lshl_add_u32 v80, v5, 3, v80
    v_mul_u32_u24 v80, 296, v80
    v_and_b32 v81, 3, v4
    v_lshl_add_u32 v80, v81, 3, v80
    v_add_u32 v99, s8, v80
    v_add_u32 v3, 4736, v98
    v_lshlrev_b32 v4, 4, v2
    s_waitcnt vmcnt(0)
    s_mov_b32 s5, 0
parallel_sum__ssm_conv_s5__geglu_ffn__prompt_kernel_gp_46:
    v_xor_b32 v80, v94, v21
    v_bitop3_b32 v80, v80, v94, v23 bitop3:0xf6
    v_bitop3_b32 v80, v80, v95, v25 bitop3:0xf6
    v_bitop3_b32 v80, v80, v95, v27 bitop3:0xf6
    v_bitop3_b32 v80, v80, v96, v29 bitop3:0xf6
    v_bitop3_b32 v80, v80, v96, v31 bitop3:0xf6
    v_bitop3_b32 v80, v80, v97, v33 bitop3:0xf6
    v_bitop3_b32 v80, v80, v97, v35 bitop3:0xf6
    v_bitop3_b32 v80, v80, v94, v37 bitop3:0xf6
    v_bitop3_b32 v80, v80, v94, v39 bitop3:0xf6
    v_bitop3_b32 v80, v80, v95, v41 bitop3:0xf6
    v_bitop3_b32 v80, v80, v95, v43 bitop3:0xf6
    v_bitop3_b32 v80, v80, v96, v45 bitop3:0xf6
    v_bitop3_b32 v80, v80, v96, v47 bitop3:0xf6
    v_bitop3_b32 v80, v80, v97, v49 bitop3:0xf6
    v_bitop3_b32 v80, v80, v97, v51 bitop3:0xf6
    v_cmp_ne_u32 vcc, 0, v80
    s_add_u32 s5, s5, 1
    s_nop 3
    s_cbranch_vccz parallel_sum__ssm_conv_s5__geglu_ffn__prompt_kernel_gpo_47
    s_cmp_ge_u32 s5, 0x20000
    s_cbranch_scc1 parallel_sum__ssm_conv_s5__geglu_ffn__prompt_kernel_gpo_47
    s_sleep 1
    buffer_load_dwordx4 v[20:23], v12, s[28:31], s11 offen offset:0 sc1
    buffer_load_dwordx4 v[24:27], v13, s[28:31], s11 offen offset:0 sc1
    buffer_load_dwordx4 v[28:31], v14, s[28:31], s11 offen offset:0 sc1
    buffer_load_dwordx4 v[32:35], v15, s[28:31], s11 offen offset:0 sc1
    buffer_load_dwordx4 v[36:39], v12, s[28:31], s11 offen offset:256 sc1
    buffer_load_dwordx4 v[40:43], v13, s[28:31], s11 offen offset:256 sc1
    buffer_load_dwordx4 v[44:47], v14, s[28:31], s11 offen offset:256 sc1
    buffer_load_dwordx4 v[48:51], v15, s[28:31], s11 offen offset:256 sc1
    s_waitcnt vmcnt(0)
    s_branch parallel_sum__ssm_conv_s5__geglu_ffn__prompt_kernel_gp_46
parallel_sum__ssm_conv_s5__geglu_ffn__prompt_kernel_gpo_47:
    v_mul_f32 v12, v52, v20
    v_mul_f32 v13, v52, v22
    v_fma_f32 v12, -v53, v22, v12
    v_fmac_f32 v13, v53, v20
    v_mul_f32 v14, v60, v36
    v_mul_f32 v15, v60, v38
    v_fma_f32 v14, -v61, v38, v14
    v_fmac_f32 v15, v61, v36
    v_fma_f32 v12, v54, v24, v12
    v_fma_f32 v13, v54, v26, v13
    v_fma_f32 v12, -v55, v26, v12
    v_fmac_f32_e64 v13, v55, v24
    v_fma_f32 v14, v62, v40, v14
    v_fma_f32 v15, v62, v42, v15
    v_fma_f32 v14, -v63, v42, v14
    v_fmac_f32_e64 v15, v63, v40
    v_fma_f32 v12, v56, v28, v12
    v_fma_f32 v13, v56, v30, v13
    v_fma_f32 v12, -v57, v30, v12
    v_fmac_f32_e64 v13, v57, v28
    v_fma_f32 v14, v64, v44, v14
    v_fma_f32 v15, v64, v46, v15
    v_fma_f32 v14, -v65, v46, v14
    v_fmac_f32_e64 v15, v65, v44
    v_fma_f32 v12, v58, v32, v12
    v_fma_f32 v13, v58, v34, v13
    v_fma_f32 v12, -v59, v34, v12
    v_fmac_f32_e64 v13, v59, v32
    v_fma_f32 v14, v66, v48, v14
    v_fma_f32 v15, v66, v50, v15
    v_fma_f32 v14, -v67, v50, v14
    v_fmac_f32 v15, v67, v48
    v_mov_b32 v94, v12
    v_mov_b32 v95, v13
    v_mov_b32 v96, v14
    v_mov_b32_e64 v97, v15
    s_nop 0
    v_permlane32_swap_b32 v12, v94
    v_permlane32_swap_b32 v13, v95
    v_permlane32_swap_b32 v14, v96
    v_permlane32_swap_b32 v15, v97
    s_nop 0
    v_pk_add_f32 v[12:13], v[12:13], v[94:95] op_sel:[0,0] op_sel_hi:[1,1]
    v_pk_add_f32 v[14:15], v[14:15], v[96:97] op_sel:[0,0] op_sel_hi:[1,1]
    v_mov_b32 v94, v12
    v_mov_b32 v95, v13
    v_mov_b32 v96, v14
    v_mov_b32 v97, v15
    s_nop 0
    v_permlane16_swap_b32 v12, v94
    v_permlane16_swap_b32 v13, v95
    v_permlane16_swap_b32 v14, v96
    v_permlane16_swap_b32 v15, v97
    s_nop 0
    v_pk_add_f32 v[12:13], v[12:13], v[94:95] op_sel:[0,0] op_sel_hi:[1,1]
    v_pk_add_f32 v[14:15], v[14:15], v[96:97] op_sel:[0,0] op_sel_hi:[1,1]
    v_fma_f32 v20, v90, v12, v86
    v_fma_f32 v22, v90, v13, v87
    v_fma_f32 v20, -v91, v13, v20
    v_fmac_f32_e64 v22, v91, v12
    v_fma_f32 v44, v92, v14, v88
    v_fma_f32 v46, v92, v15, v89
    v_fma_f32 v44, -v93, v15, v44
    v_fmac_f32_e64 v46, v93, v14
    v_fma_f32 v21, v16, v20, v82
    v_fma_f32 v23, v16, v22, v83
    v_fma_f32 v21, -v17, v22, v21
    v_fmac_f32_e64 v23, v17, v20
    v_fma_f32 v45, v74, v44, v84
    v_fma_f32 v47, v74, v46, v85
    v_fma_f32 v45, -v75, v46, v45
    v_fmac_f32_e64 v47, v75, v44
    v_pk_mul_f32 v[24:25], v[20:21], v[246:247] op_sel:[0,0] op_sel_hi:[1,0]
    v_pk_mul_f32 v[26:27], v[22:23], v[246:247] op_sel:[0,0] op_sel_hi:[1,0]
    v_pk_mul_f32 v[48:49], v[44:45], v[250:251] op_sel:[0,0] op_sel_hi:[1,0]
    v_pk_mul_f32 v[50:51], v[46:47], v[250:251] op_sel:[0,0] op_sel_hi:[1,0]
    v_pk_fma_f32 v[24:25], v[246:247], v[22:23], v[24:25] op_sel:[1,0,0] op_sel_hi:[1,1,1] neg_lo:[0,1,0] neg_hi:[0,1,0]
    v_pk_fma_f32 v[26:27], v[246:247], v[20:21], v[26:27] op_sel:[1,0,0] op_sel_hi:[1,1,1]
    v_pk_fma_f32 v[48:49], v[250:251], v[46:47], v[48:49] op_sel:[1,0,0] op_sel_hi:[1,1,1] neg_lo:[0,1,0] neg_hi:[0,1,0]
    v_pk_fma_f32 v[50:51], v[250:251], v[44:45], v[50:51] op_sel:[1,0,0] op_sel_hi:[1,1,1]
    v_pk_mul_f32 v[28:29], v[24:25], v[246:247] op_sel:[0,0] op_sel_hi:[1,0]
    v_pk_mul_f32 v[30:31], v[26:27], v[246:247] op_sel:[0,0] op_sel_hi:[1,0]
    v_pk_mul_f32 v[52:53], v[48:49], v[250:251] op_sel:[0,0] op_sel_hi:[1,0]
    v_pk_mul_f32 v[54:55], v[50:51], v[250:251] op_sel:[0,0] op_sel_hi:[1,0]
    v_pk_fma_f32 v[28:29], v[246:247], v[26:27], v[28:29] op_sel:[1,0,0] op_sel_hi:[1,1,1] neg_lo:[0,1,0] neg_hi:[0,1,0]
    v_pk_fma_f32 v[30:31], v[246:247], v[24:25], v[30:31] op_sel:[1,0,0] op_sel_hi:[1,1,1]
    v_pk_fma_f32 v[52:53], v[250:251], v[50:51], v[52:53] op_sel:[1,0,0] op_sel_hi:[1,1,1] neg_lo:[0,1,0] neg_hi:[0,1,0]
    v_pk_fma_f32 v[54:55], v[250:251], v[48:49], v[54:55] op_sel:[1,0,0] op_sel_hi:[1,1,1]
    v_pk_mul_f32 v[32:33], v[28:29], v[246:247] op_sel:[0,0] op_sel_hi:[1,0]
    v_pk_mul_f32 v[34:35], v[30:31], v[246:247] op_sel:[0,0] op_sel_hi:[1,0]
    v_pk_mul_f32 v[56:57], v[52:53], v[250:251] op_sel:[0,0] op_sel_hi:[1,0]
    v_pk_mul_f32 v[58:59], v[54:55], v[250:251] op_sel:[0,0] op_sel_hi:[1,0]
    v_pk_fma_f32 v[32:33], v[246:247], v[30:31], v[32:33] op_sel:[1,0,0] op_sel_hi:[1,1,1] neg_lo:[0,1,0] neg_hi:[0,1,0]
    v_pk_fma_f32 v[34:35], v[246:247], v[28:29], v[34:35] op_sel:[1,0,0] op_sel_hi:[1,1,1]
    v_pk_fma_f32 v[56:57], v[250:251], v[54:55], v[56:57] op_sel:[1,0,0] op_sel_hi:[1,1,1] neg_lo:[0,1,0] neg_hi:[0,1,0]
    v_pk_fma_f32 v[58:59], v[250:251], v[52:53], v[58:59] op_sel:[1,0,0] op_sel_hi:[1,1,1]
    v_pk_mul_f32 v[36:37], v[32:33], v[246:247] op_sel:[0,0] op_sel_hi:[1,0]
    v_pk_mul_f32 v[38:39], v[34:35], v[246:247] op_sel:[0,0] op_sel_hi:[1,0]
    v_pk_mul_f32 v[60:61], v[56:57], v[250:251] op_sel:[0,0] op_sel_hi:[1,0]
    v_pk_mul_f32 v[62:63], v[58:59], v[250:251] op_sel:[0,0] op_sel_hi:[1,0]
    v_pk_fma_f32 v[36:37], v[246:247], v[34:35], v[36:37] op_sel:[1,0,0] op_sel_hi:[1,1,1] neg_lo:[0,1,0] neg_hi:[0,1,0]
    v_pk_fma_f32 v[38:39], v[246:247], v[32:33], v[38:39] op_sel:[1,0,0] op_sel_hi:[1,1,1]
    v_pk_fma_f32 v[60:61], v[250:251], v[58:59], v[60:61] op_sel:[1,0,0] op_sel_hi:[1,1,1] neg_lo:[0,1,0] neg_hi:[0,1,0]
    v_pk_fma_f32 v[62:63], v[250:251], v[56:57], v[62:63] op_sel:[1,0,0] op_sel_hi:[1,1,1]
    v_pk_mul_f32 v[40:41], v[36:37], v[246:247] op_sel:[0,0] op_sel_hi:[1,0]
    v_pk_mul_f32 v[42:43], v[38:39], v[246:247] op_sel:[0,0] op_sel_hi:[1,0]
    v_pk_mul_f32 v[64:65], v[60:61], v[250:251] op_sel:[0,0] op_sel_hi:[1,0]
    v_pk_mul_f32 v[66:67], v[62:63], v[250:251] op_sel:[0,0] op_sel_hi:[1,0]
    v_pk_fma_f32 v[40:41], v[246:247], v[38:39], v[40:41] op_sel:[1,0,0] op_sel_hi:[1,1,1] neg_lo:[0,1,0] neg_hi:[0,1,0]
    v_pk_fma_f32 v[42:43], v[246:247], v[36:37], v[42:43] op_sel:[1,0,0] op_sel_hi:[1,1,1]
    v_pk_fma_f32 v[64:65], v[250:251], v[62:63], v[64:65] op_sel:[1,0,0] op_sel_hi:[1,1,1] neg_lo:[0,1,0] neg_hi:[0,1,0]
    v_pk_fma_f32 v[66:67], v[250:251], v[60:61], v[66:67] op_sel:[1,0,0] op_sel_hi:[1,1,1]
    v_pk_fma_f32 v[100:101], v[20:21], v[6:7], v[100:101] op_sel:[0,0,0] op_sel_hi:[1,0,1]
    v_pk_fma_f32 v[102:103], v[20:21], v[18:19], v[102:103] op_sel:[0,0,0] op_sel_hi:[1,0,1]
    v_pk_fma_f32 v[104:105], v[44:45], v[68:69], v[104:105] op_sel:[0,0,0] op_sel_hi:[1,0,1]
    v_pk_fma_f32 v[106:107], v[44:45], v[76:77], v[106:107] op_sel:[0,0,0] op_sel_hi:[1,0,1]
    v_pk_fma_f32 v[100:101], v[6:7], v[22:23], v[100:101] op_sel:[1,0,0] op_sel_hi:[1,1,1] neg_lo:[0,1,0] neg_hi:[0,1,0]
    v_pk_fma_f32 v[102:103], v[18:19], v[22:23], v[102:103] op_sel:[1,0,0] op_sel_hi:[1,1,1] neg_lo:[0,1,0] neg_hi:[0,1,0]
    v_pk_fma_f32 v[104:105], v[68:69], v[46:47], v[104:105] op_sel:[1,0,0] op_sel_hi:[1,1,1] neg_lo:[0,1,0] neg_hi:[0,1,0]
    v_pk_fma_f32 v[106:107], v[76:77], v[46:47], v[106:107] op_sel:[1,0,0] op_sel_hi:[1,1,1] neg_lo:[0,1,0] neg_hi:[0,1,0]
    v_cvt_pk_bf16_f32 v100, v100, v102
    v_cvt_pk_bf16_f32 v103, v101, v103
    v_cvt_pk_bf16_f32 v104, v104, v106
    v_cvt_pk_bf16_f32 v107, v105, v107
    v_pk_fma_f32 v[116:117], v[20:21], v[244:245], v[116:117] op_sel:[0,0,0] op_sel_hi:[1,0,1]
    v_pk_fma_f32 v[118:119], v[24:25], v[6:7], v[118:119] op_sel:[0,0,0] op_sel_hi:[1,0,1]
    v_pk_fma_f32 v[120:121], v[44:45], v[248:249], v[120:121] op_sel:[0,0,0] op_sel_hi:[1,0,1]
    v_pk_fma_f32 v[122:123], v[48:49], v[68:69], v[122:123] op_sel:[0,0,0] op_sel_hi:[1,0,1]
    v_pk_fma_f32 v[116:117], v[244:245], v[22:23], v[116:117] op_sel:[1,0,0] op_sel_hi:[1,1,1] neg_lo:[0,1,0] neg_hi:[0,1,0]
    v_pk_fma_f32 v[118:119], v[6:7], v[26:27], v[118:119] op_sel:[1,0,0] op_sel_hi:[1,1,1] neg_lo:[0,1,0] neg_hi:[0,1,0]
    v_pk_fma_f32 v[120:121], v[248:249], v[46:47], v[120:121] op_sel:[1,0,0] op_sel_hi:[1,1,1] neg_lo:[0,1,0] neg_hi:[0,1,0]
    v_pk_fma_f32 v[122:123], v[68:69], v[50:51], v[122:123] op_sel:[1,0,0] op_sel_hi:[1,1,1] neg_lo:[0,1,0] neg_hi:[0,1,0]
    v_cvt_pk_bf16_f32 v101, v116, v118
    v_cvt_pk_bf16_f32 v118, v117, v119
    v_cvt_pk_bf16_f32 v105, v120, v122
    v_cvt_pk_bf16_f32 v122, v121, v123
    ds_write_b64 v98, v[100:101] offset:0
    ds_write_b64 v3, v[104:105] offset:0
    v_pk_fma_f32 v[132:133], v[24:25], v[18:19], v[132:133] op_sel:[0,0,0] op_sel_hi:[1,0,1]
    v_pk_fma_f32 v[134:135], v[24:25], v[244:245], v[134:135] op_sel:[0,0,0] op_sel_hi:[1,0,1]
    v_pk_fma_f32 v[136:137], v[48:49], v[76:77], v[136:137] op_sel:[0,0,0] op_sel_hi:[1,0,1]
    v_pk_fma_f32 v[138:139], v[48:49], v[248:249], v[138:139] op_sel:[0,0,0] op_sel_hi:[1,0,1]
    v_pk_fma_f32 v[132:133], v[18:19], v[26:27], v[132:133] op_sel:[1,0,0] op_sel_hi:[1,1,1] neg_lo:[0,1,0] neg_hi:[0,1,0]
    v_pk_fma_f32 v[134:135], v[244:245], v[26:27], v[134:135] op_sel:[1,0,0] op_sel_hi:[1,1,1] neg_lo:[0,1,0] neg_hi:[0,1,0]
    v_pk_fma_f32 v[136:137], v[76:77], v[50:51], v[136:137] op_sel:[1,0,0] op_sel_hi:[1,1,1] neg_lo:[0,1,0] neg_hi:[0,1,0]
    v_pk_fma_f32 v[138:139], v[248:249], v[50:51], v[138:139] op_sel:[1,0,0] op_sel_hi:[1,1,1] neg_lo:[0,1,0] neg_hi:[0,1,0]
    v_cvt_pk_bf16_f32 v132, v132, v134
    v_cvt_pk_bf16_f32 v119, v133, v135
    v_cvt_pk_bf16_f32 v136, v136, v138
    v_cvt_pk_bf16_f32 v123, v137, v139
    ds_write_b64 v98, v[118:119] offset:40
    ds_write_b64 v3, v[122:123] offset:40
    v_pk_fma_f32 v[148:149], v[28:29], v[6:7], v[148:149] op_sel:[0,0,0] op_sel_hi:[1,0,1]
    v_pk_fma_f32 v[150:151], v[28:29], v[18:19], v[150:151] op_sel:[0,0,0] op_sel_hi:[1,0,1]
    v_pk_fma_f32 v[152:153], v[52:53], v[68:69], v[152:153] op_sel:[0,0,0] op_sel_hi:[1,0,1]
    v_pk_fma_f32 v[154:155], v[52:53], v[76:77], v[154:155] op_sel:[0,0,0] op_sel_hi:[1,0,1]
    v_pk_fma_f32 v[148:149], v[6:7], v[30:31], v[148:149] op_sel:[1,0,0] op_sel_hi:[1,1,1] neg_lo:[0,1,0] neg_hi:[0,1,0]
    v_pk_fma_f32 v[150:151], v[18:19], v[30:31], v[150:151] op_sel:[1,0,0] op_sel_hi:[1,1,1] neg_lo:[0,1,0] neg_hi:[0,1,0]
    v_pk_fma_f32 v[152:153], v[68:69], v[54:55], v[152:153] op_sel:[1,0,0] op_sel_hi:[1,1,1] neg_lo:[0,1,0] neg_hi:[0,1,0]
    v_pk_fma_f32 v[154:155], v[76:77], v[54:55], v[154:155] op_sel:[1,0,0] op_sel_hi:[1,1,1] neg_lo:[0,1,0] neg_hi:[0,1,0]
    v_cvt_pk_bf16_f32 v133, v148, v150
    v_cvt_pk_bf16_f32 v150, v149, v151
    v_cvt_pk_bf16_f32 v137, v152, v154
    v_cvt_pk_bf16_f32 v154, v153, v155
    ds_write_b64 v98, v[132:133] offset:8
    ds_write_b64 v3, v[136:137] offset:8
    v_pk_fma_f32 v[164:165], v[28:29], v[244:245], v[164:165] op_sel:[0,0,0] op_sel_hi:[1,0,1]
    v_pk_fma_f32 v[166:167], v[32:33], v[6:7], v[166:167] op_sel:[0,0,0] op_sel_hi:[1,0,1]
    v_pk_fma_f32 v[168:169], v[52:53], v[248:249], v[168:169] op_sel:[0,0,0] op_sel_hi:[1,0,1]
    v_pk_fma_f32 v[170:171], v[56:57], v[68:69], v[170:171] op_sel:[0,0,0] op_sel_hi:[1,0,1]
    v_pk_fma_f32 v[164:165], v[244:245], v[30:31], v[164:165] op_sel:[1,0,0] op_sel_hi:[1,1,1] neg_lo:[0,1,0] neg_hi:[0,1,0]
    v_pk_fma_f32 v[166:167], v[6:7], v[34:35], v[166:167] op_sel:[1,0,0] op_sel_hi:[1,1,1] neg_lo:[0,1,0] neg_hi:[0,1,0]
    v_pk_fma_f32 v[168:169], v[248:249], v[54:55], v[168:169] op_sel:[1,0,0] op_sel_hi:[1,1,1] neg_lo:[0,1,0] neg_hi:[0,1,0]
    v_pk_fma_f32 v[170:171], v[68:69], v[58:59], v[170:171] op_sel:[1,0,0] op_sel_hi:[1,1,1] neg_lo:[0,1,0] neg_hi:[0,1,0]
    v_cvt_pk_bf16_f32 v164, v164, v166
    v_cvt_pk_bf16_f32 v151, v165, v167
    v_cvt_pk_bf16_f32 v168, v168, v170
    v_cvt_pk_bf16_f32 v155, v169, v171
    ds_write_b64 v98, v[150:151] offset:48
    ds_write_b64 v3, v[154:155] offset:48
    v_pk_fma_f32 v[180:181], v[32:33], v[18:19], v[180:181] op_sel:[0,0,0] op_sel_hi:[1,0,1]
    v_pk_fma_f32 v[182:183], v[32:33], v[244:245], v[182:183] op_sel:[0,0,0] op_sel_hi:[1,0,1]
    v_pk_fma_f32 v[184:185], v[56:57], v[76:77], v[184:185] op_sel:[0,0,0] op_sel_hi:[1,0,1]
    v_pk_fma_f32 v[186:187], v[56:57], v[248:249], v[186:187] op_sel:[0,0,0] op_sel_hi:[1,0,1]
    v_pk_fma_f32 v[180:181], v[18:19], v[34:35], v[180:181] op_sel:[1,0,0] op_sel_hi:[1,1,1] neg_lo:[0,1,0] neg_hi:[0,1,0]
    v_pk_fma_f32 v[182:183], v[244:245], v[34:35], v[182:183] op_sel:[1,0,0] op_sel_hi:[1,1,1] neg_lo:[0,1,0] neg_hi:[0,1,0]
    v_pk_fma_f32 v[184:185], v[76:77], v[58:59], v[184:185] op_sel:[1,0,0] op_sel_hi:[1,1,1] neg_lo:[0,1,0] neg_hi:[0,1,0]
    v_pk_fma_f32 v[186:187], v[248:249], v[58:59], v[186:187] op_sel:[1,0,0] op_sel_hi:[1,1,1] neg_lo:[0,1,0] neg_hi:[0,1,0]
    v_cvt_pk_bf16_f32 v165, v180, v182
    v_cvt_pk_bf16_f32 v182, v181, v183
    v_cvt_pk_bf16_f32 v169, v184, v186
    v_cvt_pk_bf16_f32 v186, v185, v187
    ds_write_b64 v98, v[164:165] offset:16
    ds_write_b64 v3, v[168:169] offset:16
    v_pk_fma_f32 v[196:197], v[36:37], v[6:7], v[196:197] op_sel:[0,0,0] op_sel_hi:[1,0,1]
    v_pk_fma_f32 v[198:199], v[36:37], v[18:19], v[198:199] op_sel:[0,0,0] op_sel_hi:[1,0,1]
    v_pk_fma_f32 v[200:201], v[60:61], v[68:69], v[200:201] op_sel:[0,0,0] op_sel_hi:[1,0,1]
    v_pk_fma_f32 v[202:203], v[60:61], v[76:77], v[202:203] op_sel:[0,0,0] op_sel_hi:[1,0,1]
    v_pk_fma_f32 v[196:197], v[6:7], v[38:39], v[196:197] op_sel:[1,0,0] op_sel_hi:[1,1,1] neg_lo:[0,1,0] neg_hi:[0,1,0]
    v_pk_fma_f32 v[198:199], v[18:19], v[38:39], v[198:199] op_sel:[1,0,0] op_sel_hi:[1,1,1] neg_lo:[0,1,0] neg_hi:[0,1,0]
    v_pk_fma_f32 v[200:201], v[68:69], v[62:63], v[200:201] op_sel:[1,0,0] op_sel_hi:[1,1,1] neg_lo:[0,1,0] neg_hi:[0,1,0]
    v_pk_fma_f32 v[202:203], v[76:77], v[62:63], v[202:203] op_sel:[1,0,0] op_sel_hi:[1,1,1] neg_lo:[0,1,0] neg_hi:[0,1,0]
    v_cvt_pk_bf16_f32 v196, v196, v198
    v_cvt_pk_bf16_f32 v183, v197, v199
    v_cvt_pk_bf16_f32 v200, v200, v202
    v_cvt_pk_bf16_f32 v187, v201, v203
    ds_write_b64 v98, v[182:183] offset:56
    ds_write_b64 v3, v[186:187] offset:56
    v_pk_fma_f32 v[212:213], v[36:37], v[244:245], v[212:213] op_sel:[0,0,0] op_sel_hi:[1,0,1]
    v_pk_fma_f32 v[214:215], v[40:41], v[6:7], v[214:215] op_sel:[0,0,0] op_sel_hi:[1,0,1]
    v_pk_fma_f32 v[216:217], v[60:61], v[248:249], v[216:217] op_sel:[0,0,0] op_sel_hi:[1,0,1]
    v_pk_fma_f32 v[218:219], v[64:65], v[68:69], v[218:219] op_sel:[0,0,0] op_sel_hi:[1,0,1]
    v_pk_fma_f32 v[212:213], v[244:245], v[38:39], v[212:213] op_sel:[1,0,0] op_sel_hi:[1,1,1] neg_lo:[0,1,0] neg_hi:[0,1,0]
    v_pk_fma_f32 v[214:215], v[6:7], v[42:43], v[214:215] op_sel:[1,0,0] op_sel_hi:[1,1,1] neg_lo:[0,1,0] neg_hi:[0,1,0]
    v_pk_fma_f32 v[216:217], v[248:249], v[62:63], v[216:217] op_sel:[1,0,0] op_sel_hi:[1,1,1] neg_lo:[0,1,0] neg_hi:[0,1,0]
    v_pk_fma_f32 v[218:219], v[68:69], v[66:67], v[218:219] op_sel:[1,0,0] op_sel_hi:[1,1,1] neg_lo:[0,1,0] neg_hi:[0,1,0]
    v_cvt_pk_bf16_f32 v197, v212, v214
    v_cvt_pk_bf16_f32 v214, v213, v215
    v_cvt_pk_bf16_f32 v201, v216, v218
    v_cvt_pk_bf16_f32 v218, v217, v219
    ds_write_b64 v98, v[196:197] offset:24
    ds_write_b64 v3, v[200:201] offset:24
    v_pk_fma_f32 v[228:229], v[40:41], v[18:19], v[228:229] op_sel:[0,0,0] op_sel_hi:[1,0,1]
    v_pk_fma_f32 v[230:231], v[40:41], v[244:245], v[230:231] op_sel:[0,0,0] op_sel_hi:[1,0,1]
    v_pk_fma_f32 v[232:233], v[64:65], v[76:77], v[232:233] op_sel:[0,0,0] op_sel_hi:[1,0,1]
    v_pk_fma_f32 v[234:235], v[64:65], v[248:249], v[234:235] op_sel:[0,0,0] op_sel_hi:[1,0,1]
    v_pk_fma_f32 v[228:229], v[18:19], v[42:43], v[228:229] op_sel:[1,0,0] op_sel_hi:[1,1,1] neg_lo:[0,1,0] neg_hi:[0,1,0]
    v_pk_fma_f32 v[230:231], v[244:245], v[42:43], v[230:231] op_sel:[1,0,0] op_sel_hi:[1,1,1] neg_lo:[0,1,0] neg_hi:[0,1,0]
    v_pk_fma_f32 v[232:233], v[76:77], v[66:67], v[232:233] op_sel:[1,0,0] op_sel_hi:[1,1,1] neg_lo:[0,1,0] neg_hi:[0,1,0]
    v_pk_fma_f32 v[234:235], v[248:249], v[66:67], v[234:235] op_sel:[1,0,0] op_sel_hi:[1,1,1] neg_lo:[0,1,0] neg_hi:[0,1,0]
    v_cvt_pk_bf16_f32 v102, v228, v230
    v_cvt_pk_bf16_f32 v215, v229, v231
    v_cvt_pk_bf16_f32 v106, v232, v234
    v_cvt_pk_bf16_f32 v219, v233, v235
    ds_write_b64 v98, v[214:215] offset:64
    ds_write_b64 v98, v[102:103] offset:32
    ds_write_b64 v3, v[218:219] offset:64
    ds_write_b64 v3, v[106:107] offset:32
    s_waitcnt lgkmcnt(0)
    s_nop 0
    ds_read_b64_tr_b16 v[100:101], v99 offset:0
    ds_read_b64_tr_b16 v[102:103], v99 offset:1184
    ds_read_b64_tr_b16 v[116:117], v99 offset:32
    ds_read_b64_tr_b16 v[118:119], v99 offset:1216
    ds_read_b64_tr_b16 v[132:133], v99 offset:64
    ds_read_b64_tr_b16 v[134:135], v99 offset:1248
    ds_read_b64_tr_b16 v[148:149], v99 offset:96
    ds_read_b64_tr_b16 v[150:151], v99 offset:1280
    ds_read_b64_tr_b16 v[164:165], v99 offset:128
    ds_read_b64_tr_b16 v[166:167], v99 offset:1312
    ds_read_b64_tr_b16 v[180:181], v99 offset:160
    ds_read_b64_tr_b16 v[182:183], v99 offset:1344
    ds_read_b64_tr_b16 v[196:197], v99 offset:192
    ds_read_b64_tr_b16 v[198:199], v99 offset:1376
    ds_read_b64_tr_b16 v[212:213], v99 offset:224
    ds_read_b64_tr_b16 v[214:215], v99 offset:1408
    ds_read_b64_tr_b16 v[228:229], v99 offset:256
    ds_read_b64_tr_b16 v[230:231], v99 offset:1440
    v_pk_fma_f32 v[108:109], v[22:23], v[6:7], v[108:109] op_sel:[0,0,0] op_sel_hi:[1,0,1] neg_lo:[1,0,0] neg_hi:[1,0,0]
    v_pk_fma_f32 v[110:111], v[22:23], v[18:19], v[110:111] op_sel:[0,0,0] op_sel_hi:[1,0,1] neg_lo:[1,0,0] neg_hi:[1,0,0]
    v_pk_fma_f32 v[112:113], v[46:47], v[68:69], v[112:113] op_sel:[0,0,0] op_sel_hi:[1,0,1] neg_lo:[1,0,0] neg_hi:[1,0,0]
    v_pk_fma_f32 v[114:115], v[46:47], v[76:77], v[114:115] op_sel:[0,0,0] op_sel_hi:[1,0,1] neg_lo:[1,0,0] neg_hi:[1,0,0]
    v_pk_fma_f32 v[108:109], v[6:7], v[20:21], v[108:109] op_sel:[1,0,0] op_sel_hi:[1,1,1] neg_lo:[0,1,0] neg_hi:[0,1,0]
    v_pk_fma_f32 v[110:111], v[18:19], v[20:21], v[110:111] op_sel:[1,0,0] op_sel_hi:[1,1,1] neg_lo:[0,1,0] neg_hi:[0,1,0]
    v_pk_fma_f32 v[112:113], v[68:69], v[44:45], v[112:113] op_sel:[1,0,0] op_sel_hi:[1,1,1] neg_lo:[0,1,0] neg_hi:[0,1,0]
    v_pk_fma_f32 v[114:115], v[76:77], v[44:45], v[114:115] op_sel:[1,0,0] op_sel_hi:[1,1,1] neg_lo:[0,1,0] neg_hi:[0,1,0]
    v_cvt_pk_bf16_f32 v108, v108, v110
    v_cvt_pk_bf16_f32 v111, v109, v111
    v_cvt_pk_bf16_f32 v112, v112, v114
    v_cvt_pk_bf16_f32 v115, v113, v115
    s_waitcnt lgkmcnt(0)
    buffer_store_dwordx4 v[100:103], v4, s[36:39], s55 offen sc1
    s_nop 0
    v_pk_fma_f32 v[124:125], v[22:23], v[244:245], v[124:125] op_sel:[0,0,0] op_sel_hi:[1,0,1] neg_lo:[1,0,0] neg_hi:[1,0,0]
    v_pk_fma_f32 v[126:127], v[26:27], v[6:7], v[126:127] op_sel:[0,0,0] op_sel_hi:[1,0,1] neg_lo:[1,0,0] neg_hi:[1,0,0]
    v_pk_fma_f32 v[128:129], v[46:47], v[248:249], v[128:129] op_sel:[0,0,0] op_sel_hi:[1,0,1] neg_lo:[1,0,0] neg_hi:[1,0,0]
    v_pk_fma_f32 v[130:131], v[50:51], v[68:69], v[130:131] op_sel:[0,0,0] op_sel_hi:[1,0,1] neg_lo:[1,0,0] neg_hi:[1,0,0]
    v_pk_fma_f32 v[124:125], v[244:245], v[20:21], v[124:125] op_sel:[1,0,0] op_sel_hi:[1,1,1] neg_lo:[0,1,0] neg_hi:[0,1,0]
    v_pk_fma_f32 v[126:127], v[6:7], v[24:25], v[126:127] op_sel:[1,0,0] op_sel_hi:[1,1,1] neg_lo:[0,1,0] neg_hi:[0,1,0]
    v_pk_fma_f32 v[128:129], v[248:249], v[44:45], v[128:129] op_sel:[1,0,0] op_sel_hi:[1,1,1] neg_lo:[0,1,0] neg_hi:[0,1,0]
    v_pk_fma_f32 v[130:131], v[68:69], v[48:49], v[130:131] op_sel:[1,0,0] op_sel_hi:[1,1,1] neg_lo:[0,1,0] neg_hi:[0,1,0]
    v_cvt_pk_bf16_f32 v109, v124, v126
    v_cvt_pk_bf16_f32 v126, v125, v127
    v_cvt_pk_bf16_f32 v113, v128, v130
    v_cvt_pk_bf16_f32 v130, v129, v131
    buffer_store_dwordx4 v[116:119], v4, s[36:39], s56 offen sc1
    ds_write_b64 v98, v[108:109] offset:0
    ds_write_b64 v3, v[112:113] offset:0
    v_pk_fma_f32 v[140:141], v[26:27], v[18:19], v[140:141] op_sel:[0,0,0] op_sel_hi:[1,0,1] neg_lo:[1,0,0] neg_hi:[1,0,0]
    v_pk_fma_f32 v[142:143], v[26:27], v[244:245], v[142:143] op_sel:[0,0,0] op_sel_hi:[1,0,1] neg_lo:[1,0,0] neg_hi:[1,0,0]
    v_pk_fma_f32 v[144:145], v[50:51], v[76:77], v[144:145] op_sel:[0,0,0] op_sel_hi:[1,0,1] neg_lo:[1,0,0] neg_hi:[1,0,0]
    v_pk_fma_f32 v[146:147], v[50:51], v[248:249], v[146:147] op_sel:[0,0,0] op_sel_hi:[1,0,1] neg_lo:[1,0,0] neg_hi:[1,0,0]
    v_pk_fma_f32 v[140:141], v[18:19], v[24:25], v[140:141] op_sel:[1,0,0] op_sel_hi:[1,1,1] neg_lo:[0,1,0] neg_hi:[0,1,0]
    v_pk_fma_f32 v[142:143], v[244:245], v[24:25], v[142:143] op_sel:[1,0,0] op_sel_hi:[1,1,1] neg_lo:[0,1,0] neg_hi:[0,1,0]
    v_pk_fma_f32 v[144:145], v[76:77], v[48:49], v[144:145] op_sel:[1,0,0] op_sel_hi:[1,1,1] neg_lo:[0,1,0] neg_hi:[0,1,0]
    v_pk_fma_f32 v[146:147], v[248:249], v[48:49], v[146:147] op_sel:[1,0,0] op_sel_hi:[1,1,1] neg_lo:[0,1,0] neg_hi:[0,1,0]
    v_cvt_pk_bf16_f32 v140, v140, v142
    v_cvt_pk_bf16_f32 v127, v141, v143
    v_cvt_pk_bf16_f32 v144, v144, v146
    v_cvt_pk_bf16_f32 v131, v145, v147
    buffer_store_dwordx4 v[132:135], v4, s[36:39], s57 offen sc1
    ds_write_b64 v98, v[126:127] offset:40
    ds_write_b64 v3, v[130:131] offset:40
    v_pk_fma_f32 v[156:157], v[30:31], v[6:7], v[156:157] op_sel:[0,0,0] op_sel_hi:[1,0,1] neg_lo:[1,0,0] neg_hi:[1,0,0]
    v_pk_fma_f32 v[158:159], v[30:31], v[18:19], v[158:159] op_sel:[0,0,0] op_sel_hi:[1,0,1] neg_lo:[1,0,0] neg_hi:[1,0,0]
    v_pk_fma_f32 v[160:161], v[54:55], v[68:69], v[160:161] op_sel:[0,0,0] op_sel_hi:[1,0,1] neg_lo:[1,0,0] neg_hi:[1,0,0]
    v_pk_fma_f32 v[162:163], v[54:55], v[76:77], v[162:163] op_sel:[0,0,0] op_sel_hi:[1,0,1] neg_lo:[1,0,0] neg_hi:[1,0,0]
    v_pk_fma_f32 v[156:157], v[6:7], v[28:29], v[156:157] op_sel:[1,0,0] op_sel_hi:[1,1,1] neg_lo:[0,1,0] neg_hi:[0,1,0]
    v_pk_fma_f32 v[158:159], v[18:19], v[28:29], v[158:159] op_sel:[1,0,0] op_sel_hi:[1,1,1] neg_lo:[0,1,0] neg_hi:[0,1,0]
    v_pk_fma_f32 v[160:161], v[68:69], v[52:53], v[160:161] op_sel:[1,0,0] op_sel_hi:[1,1,1] neg_lo:[0,1,0] neg_hi:[0,1,0]
    v_pk_fma_f32 v[162:163], v[76:77], v[52:53], v[162:163] op_sel:[1,0,0] op_sel_hi:[1,1,1] neg_lo:[0,1,0] neg_hi:[0,1,0]
    v_cvt_pk_bf16_f32 v141, v156, v158
    v_cvt_pk_bf16_f32 v158, v157, v159
    v_cvt_pk_bf16_f32 v145, v160, v162
    v_cvt_pk_bf16_f32 v162, v161, v163
    buffer_store_dwordx4 v[148:151], v4, s[36:39], s58 offen sc1
    ds_write_b64 v98, v[140:141] offset:8
    ds_write_b64 v3, v[144:145] offset:8
    v_pk_fma_f32 v[172:173], v[30:31], v[244:245], v[172:173] op_sel:[0,0,0] op_sel_hi:[1,0,1] neg_lo:[1,0,0] neg_hi:[1,0,0]
    v_pk_fma_f32 v[174:175], v[34:35], v[6:7], v[174:175] op_sel:[0,0,0] op_sel_hi:[1,0,1] neg_lo:[1,0,0] neg_hi:[1,0,0]
    v_pk_fma_f32 v[176:177], v[54:55], v[248:249], v[176:177] op_sel:[0,0,0] op_sel_hi:[1,0,1] neg_lo:[1,0,0] neg_hi:[1,0,0]
    v_pk_fma_f32 v[178:179], v[58:59], v[68:69], v[178:179] op_sel:[0,0,0] op_sel_hi:[1,0,1] neg_lo:[1,0,0] neg_hi:[1,0,0]
    v_pk_fma_f32 v[172:173], v[244:245], v[28:29], v[172:173] op_sel:[1,0,0] op_sel_hi:[1,1,1] neg_lo:[0,1,0] neg_hi:[0,1,0]
    v_pk_fma_f32 v[174:175], v[6:7], v[32:33], v[174:175] op_sel:[1,0,0] op_sel_hi:[1,1,1] neg_lo:[0,1,0] neg_hi:[0,1,0]
    v_pk_fma_f32 v[176:177], v[248:249], v[52:53], v[176:177] op_sel:[1,0,0] op_sel_hi:[1,1,1] neg_lo:[0,1,0] neg_hi:[0,1,0]
    v_pk_fma_f32 v[178:179], v[68:69], v[56:57], v[178:179] op_sel:[1,0,0] op_sel_hi:[1,1,1] neg_lo:[0,1,0] neg_hi:[0,1,0]
    v_cvt_pk_bf16_f32 v172, v172, v174
    v_cvt_pk_bf16_f32 v159, v173, v175
    v_cvt_pk_bf16_f32 v176, v176, v178
    v_cvt_pk_bf16_f32 v163, v177, v179
    buffer_store_dwordx4 v[164:167], v4, s[36:39], s59 offen sc1
    ds_write_b64 v98, v[158:159] offset:48
    ds_write_b64 v3, v[162:163] offset:48
    v_pk_fma_f32 v[188:189], v[34:35], v[18:19], v[188:189] op_sel:[0,0,0] op_sel_hi:[1,0,1] neg_lo:[1,0,0] neg_hi:[1,0,0]
    v_pk_fma_f32 v[190:191], v[34:35], v[244:245], v[190:191] op_sel:[0,0,0] op_sel_hi:[1,0,1] neg_lo:[1,0,0] neg_hi:[1,0,0]
    v_pk_fma_f32 v[192:193], v[58:59], v[76:77], v[192:193] op_sel:[0,0,0] op_sel_hi:[1,0,1] neg_lo:[1,0,0] neg_hi:[1,0,0]
    v_pk_fma_f32 v[194:195], v[58:59], v[248:249], v[194:195] op_sel:[0,0,0] op_sel_hi:[1,0,1] neg_lo:[1,0,0] neg_hi:[1,0,0]
    v_pk_fma_f32 v[188:189], v[18:19], v[32:33], v[188:189] op_sel:[1,0,0] op_sel_hi:[1,1,1] neg_lo:[0,1,0] neg_hi:[0,1,0]
    v_pk_fma_f32 v[190:191], v[244:245], v[32:33], v[190:191] op_sel:[1,0,0] op_sel_hi:[1,1,1] neg_lo:[0,1,0] neg_hi:[0,1,0]
    v_pk_fma_f32 v[192:193], v[76:77], v[56:57], v[192:193] op_sel:[1,0,0] op_sel_hi:[1,1,1] neg_lo:[0,1,0] neg_hi:[0,1,0]
    v_pk_fma_f32 v[194:195], v[248:249], v[56:57], v[194:195] op_sel:[1,0,0] op_sel_hi:[1,1,1] neg_lo:[0,1,0] neg_hi:[0,1,0]
    v_cvt_pk_bf16_f32 v173, v188, v190
    v_cvt_pk_bf16_f32 v190, v189, v191
    v_cvt_pk_bf16_f32 v177, v192, v194
    v_cvt_pk_bf16_f32 v194, v193, v195
    buffer_store_dwordx4 v[180:183], v4, s[36:39], s60 offen sc1
    ds_write_b64 v98, v[172:173] offset:16
    ds_write_b64 v3, v[176:177] offset:16
    v_pk_fma_f32 v[204:205], v[38:39], v[6:7], v[204:205] op_sel:[0,0,0] op_sel_hi:[1,0,1] neg_lo:[1,0,0] neg_hi:[1,0,0]
    v_pk_fma_f32 v[206:207], v[38:39], v[18:19], v[206:207] op_sel:[0,0,0] op_sel_hi:[1,0,1] neg_lo:[1,0,0] neg_hi:[1,0,0]
    v_pk_fma_f32 v[208:209], v[62:63], v[68:69], v[208:209] op_sel:[0,0,0] op_sel_hi:[1,0,1] neg_lo:[1,0,0] neg_hi:[1,0,0]
    v_pk_fma_f32 v[210:211], v[62:63], v[76:77], v[210:211] op_sel:[0,0,0] op_sel_hi:[1,0,1] neg_lo:[1,0,0] neg_hi:[1,0,0]
    v_pk_fma_f32 v[204:205], v[6:7], v[36:37], v[204:205] op_sel:[1,0,0] op_sel_hi:[1,1,1] neg_lo:[0,1,0] neg_hi:[0,1,0]
    v_pk_fma_f32 v[206:207], v[18:19], v[36:37], v[206:207] op_sel:[1,0,0] op_sel_hi:[1,1,1] neg_lo:[0,1,0] neg_hi:[0,1,0]
    v_pk_fma_f32 v[208:209], v[68:69], v[60:61], v[208:209] op_sel:[1,0,0] op_sel_hi:[1,1,1] neg_lo:[0,1,0] neg_hi:[0,1,0]
    v_pk_fma_f32 v[210:211], v[76:77], v[60:61], v[210:211] op_sel:[1,0,0] op_sel_hi:[1,1,1] neg_lo:[0,1,0] neg_hi:[0,1,0]
    v_cvt_pk_bf16_f32 v204, v204, v206
    v_cvt_pk_bf16_f32 v191, v205, v207
    v_cvt_pk_bf16_f32 v208, v208, v210
    v_cvt_pk_bf16_f32 v195, v209, v211
    buffer_store_dwordx4 v[196:199], v4, s[36:39], s61 offen sc1
    ds_write_b64 v98, v[190:191] offset:56
    ds_write_b64 v3, v[194:195] offset:56
    v_pk_fma_f32 v[220:221], v[38:39], v[244:245], v[220:221] op_sel:[0,0,0] op_sel_hi:[1,0,1] neg_lo:[1,0,0] neg_hi:[1,0,0]
    v_pk_fma_f32 v[222:223], v[42:43], v[6:7], v[222:223] op_sel:[0,0,0] op_sel_hi:[1,0,1] neg_lo:[1,0,0] neg_hi:[1,0,0]
    v_pk_fma_f32 v[224:225], v[62:63], v[248:249], v[224:225] op_sel:[0,0,0] op_sel_hi:[1,0,1] neg_lo:[1,0,0] neg_hi:[1,0,0]
    v_pk_fma_f32 v[226:227], v[66:67], v[68:69], v[226:227] op_sel:[0,0,0] op_sel_hi:[1,0,1] neg_lo:[1,0,0] neg_hi:[1,0,0]
    v_pk_fma_f32 v[220:221], v[244:245], v[36:37], v[220:221] op_sel:[1,0,0] op_sel_hi:[1,1,1] neg_lo:[0,1,0] neg_hi:[0,1,0]
    v_pk_fma_f32 v[222:223], v[6:7], v[40:41], v[222:223] op_sel:[1,0,0] op_sel_hi:[1,1,1] neg_lo:[0,1,0] neg_hi:[0,1,0]
    v_pk_fma_f32 v[224:225], v[248:249], v[60:61], v[224:225] op_sel:[1,0,0] op_sel_hi:[1,1,1] neg_lo:[0,1,0] neg_hi:[0,1,0]
    v_pk_fma_f32 v[226:227], v[68:69], v[64:65], v[226:227] op_sel:[1,0,0] op_sel_hi:[1,1,1] neg_lo:[0,1,0] neg_hi:[0,1,0]
    v_cvt_pk_bf16_f32 v205, v220, v222
    v_cvt_pk_bf16_f32 v222, v221, v223
    v_cvt_pk_bf16_f32 v209, v224, v226
    v_cvt_pk_bf16_f32 v226, v225, v227
    buffer_store_dwordx4 v[212:215], v4, s[36:39], s62 offen sc1
    ds_write_b64 v98, v[204:205] offset:24
    ds_write_b64 v3, v[208:209] offset:24
    v_pk_fma_f32 v[236:237], v[42:43], v[18:19], v[236:237] op_sel:[0,0,0] op_sel_hi:[1,0,1] neg_lo:[1,0,0] neg_hi:[1,0,0]
    v_pk_fma_f32 v[238:239], v[42:43], v[244:245], v[238:239] op_sel:[0,0,0] op_sel_hi:[1,0,1] neg_lo:[1,0,0] neg_hi:[1,0,0]
    v_pk_fma_f32 v[240:241], v[66:67], v[76:77], v[240:241] op_sel:[0,0,0] op_sel_hi:[1,0,1] neg_lo:[1,0,0] neg_hi:[1,0,0]
    v_pk_fma_f32 v[242:243], v[66:67], v[248:249], v[242:243] op_sel:[0,0,0] op_sel_hi:[1,0,1] neg_lo:[1,0,0] neg_hi:[1,0,0]
    v_pk_fma_f32 v[236:237], v[18:19], v[40:41], v[236:237] op_sel:[1,0,0] op_sel_hi:[1,1,1] neg_lo:[0,1,0] neg_hi:[0,1,0]
    v_pk_fma_f32 v[238:239], v[244:245], v[40:41], v[238:239] op_sel:[1,0,0] op_sel_hi:[1,1,1] neg_lo:[0,1,0] neg_hi:[0,1,0]
    v_pk_fma_f32 v[240:241], v[76:77], v[64:65], v[240:241] op_sel:[1,0,0] op_sel_hi:[1,1,1] neg_lo:[0,1,0] neg_hi:[0,1,0]
    v_pk_fma_f32 v[242:243], v[248:249], v[64:65], v[242:243] op_sel:[1,0,0] op_sel_hi:[1,1,1] neg_lo:[0,1,0] neg_hi:[0,1,0]
    v_cvt_pk_bf16_f32 v110, v236, v238
    v_cvt_pk_bf16_f32 v223, v237, v239
    v_cvt_pk_bf16_f32 v114, v240, v242
    v_cvt_pk_bf16_f32 v227, v241, v243
    buffer_store_dwordx4 v[228:231], v4, s[36:39], s63 offen sc1
    ds_write_b64 v98, v[222:223] offset:64
    ds_write_b64 v98, v[110:111] offset:32
    ds_write_b64 v3, v[226:227] offset:64
    ds_write_b64 v3, v[114:115] offset:32
    s_waitcnt lgkmcnt(0)
    s_nop 0
    ds_read_b64_tr_b16 v[108:109], v99 offset:0
    ds_read_b64_tr_b16 v[110:111], v99 offset:1184
    ds_read_b64_tr_b16 v[124:125], v99 offset:32
    ds_read_b64_tr_b16 v[126:127], v99 offset:1216
    ds_read_b64_tr_b16 v[140:141], v99 offset:64
    ds_read_b64_tr_b16 v[142:143], v99 offset:1248
    ds_read_b64_tr_b16 v[156:157], v99 offset:96
    ds_read_b64_tr_b16 v[158:159], v99 offset:1280
    ds_read_b64_tr_b16 v[172:173], v99 offset:128
    ds_read_b64_tr_b16 v[174:175], v99 offset:1312
    ds_read_b64_tr_b16 v[188:189], v99 offset:160
    ds_read_b64_tr_b16 v[190:191], v99 offset:1344
    ds_read_b64_tr_b16 v[204:205], v99 offset:192
    ds_read_b64_tr_b16 v[206:207], v99 offset:1376
    ds_read_b64_tr_b16 v[220:221], v99 offset:224
    ds_read_b64_tr_b16 v[222:223], v99 offset:1408
    ds_read_b64_tr_b16 v[236:237], v99 offset:256
    ds_read_b64_tr_b16 v[238:239], v99 offset:1440
    s_add_u32 s55, s55, 8192
    buffer_store_dwordx4 v[108:111], v4, s[36:39], s55 offen sc1
    s_waitcnt lgkmcnt(14)
    s_add_u32 s56, s56, 8192
    buffer_store_dwordx4 v[124:127], v4, s[36:39], s56 offen sc1
    s_waitcnt lgkmcnt(12)
    s_add_u32 s57, s57, 8192
    buffer_store_dwordx4 v[140:143], v4, s[36:39], s57 offen sc1
    s_waitcnt lgkmcnt(10)
    s_add_u32 s58, s58, 8192
    buffer_store_dwordx4 v[156:159], v4, s[36:39], s58 offen sc1
    s_waitcnt lgkmcnt(8)
    s_add_u32 s59, s59, 8192
    buffer_store_dwordx4 v[172:175], v4, s[36:39], s59 offen sc1
    s_waitcnt lgkmcnt(6)
    s_add_u32 s60, s60, 8192
    buffer_store_dwordx4 v[188:191], v4, s[36:39], s60 offen sc1
    s_waitcnt lgkmcnt(4)
    s_add_u32 s61, s61, 8192
    buffer_store_dwordx4 v[204:207], v4, s[36:39], s61 offen sc1
    s_waitcnt lgkmcnt(2)
    s_add_u32 s62, s62, 8192
    buffer_store_dwordx4 v[220:223], v4, s[36:39], s62 offen sc1
    s_waitcnt lgkmcnt(0)
    s_add_u32 s63, s63, 8192
    buffer_store_dwordx4 v[236:239], v4, s[36:39], s63 offen sc1
    s_barrier
parallel_sum__ssm_conv_s5__geglu_ffn__prompt_kernel_cp2:
    s_waitcnt vmcnt(0)
    s_mov_b32 exec_hi, 0
    buffer_store_dword v252, v1, s[28:31], s14 offen sc1
    s_endpgm
parallel_sum__ssm_conv_s5__geglu_ffn__prompt_kernel_cspare:
    s_waitcnt vmcnt(0)
    s_barrier
parallel_sum__ssm_conv_s5__geglu_ffn__prompt_kernel_end:
    s_endpgm
.section .rodata,"a"
.p2align 6
.amdhsa_kernel parallel_sum__ssm_conv_s5__geglu_ffn__prompt_kernel
  .amdhsa_next_free_vgpr 256
  .amdhsa_next_free_sgpr 102
  .amdhsa_accum_offset 256
  .amdhsa_group_segment_fixed_size 0
  .amdhsa_kernarg_size 128
  .amdhsa_user_sgpr_count 2
  .amdhsa_user_sgpr_kernarg_segment_ptr 1
  .amdhsa_system_sgpr_workgroup_id_x 1
.end_amdhsa_kernel
```
